```python
import torch

def _softmax(x, axis=-1):
    return torch.softmax(x, dim=axis)

def _gelu(x):
    return torch.nn.functional.gelu(x, approximate='tanh')

def _silu(x):
    return torch.nn.functional.silu(x)

def _sigmoid(x):
    return torch.sigmoid(x)

def _layernorm(x, axis=-1, eps=1e-05):
    m = x.mean(dim=axis, keepdim=True)
    v = x.var(dim=axis, keepdim=True, unbiased=False)
    return (x - m) / torch.sqrt(v + eps)

def _scatter_add(tgt, idx, src, axis=0):
    return tgt.clone().index_add_(axis, idx, src)

def _segment_sum(src, seg, n):
    out = torch.zeros((n,) + src.shape[1:], dtype=src.dtype)
    return out.index_add_(0, seg, src)

def _pad(x, pw):
    flat = tuple((v for pair in reversed(pw) for v in pair))
    return torch.nn.functional.pad(x, flat)
kernel_name = 'interleave_layers__memory_aug_recurrent_mem_tr__glu_gated_reglu__prompt'

def setup_inputs():

    _w = lambda a: (lambda t: t.to(torch.bfloat16) if t.is_floating_point() else t)(torch.as_tensor(a))

    def _A_setup():
        B, S, Dm = (1, 2048, 512)
        H, Dh = (32, 128)
        M, seg = (8, 32)
        seg = min(seg, S)
        S = S // seg * seg
        return {'x': _w((lambda *s: torch.randn(*s, dtype=torch.bfloat16) * 0.05)(B, S, Dm)), 'mem0': _w((lambda *s: torch.randn(*s, dtype=torch.bfloat16) * 0.2)(B, M, Dm)), 'Wq': _w((lambda *s: torch.randn(*s, dtype=torch.bfloat16) * 1.6)(Dm, H, Dh) * Dm ** (-0.5)), 'Wk': _w((lambda *s: torch.randn(*s, dtype=torch.bfloat16) * 1.6)(Dm, H, Dh) * Dm ** (-0.5)), 'Wv': _w((lambda *s: torch.randn(*s, dtype=torch.bfloat16) * 0.2)(Dm, H, Dh) * Dm ** (-0.5)), 'Wo': _w((lambda *s: torch.randn(*s, dtype=torch.bfloat16) * 0.2)(H, Dh, Dm) * (H * Dh) ** (-0.5)), 'seg_len': seg}
    _A_in = _A_setup()

    def _B_setup():
        B, S, D, F = (1, 2048, 512, 1792)
        return {'x': _w((lambda *s: torch.randn(*s, dtype=torch.bfloat16) * 0.05)(B, S, D)), 'W_gate': _w((lambda *s: torch.randn(*s, dtype=torch.bfloat16) * 0.2)(D, F) * (2.0 / D) ** 0.5), 'W_up': _w((lambda *s: torch.randn(*s, dtype=torch.bfloat16) * 0.2)(D, F) * (2.0 / D) ** 0.5), 'W_down': _w((lambda *s: torch.randn(*s, dtype=torch.bfloat16) * 0.2)(F, D) * (1.0 / F) ** 0.5)}
    _B_in = _B_setup()
    return {'A_x': _A_in['x'], 'A_mem0': _A_in['mem0'], 'A_Wq': _A_in['Wq'], 'A_Wk': _A_in['Wk'], 'A_Wv': _A_in['Wv'], 'A_Wo': _A_in['Wo'], 'A_seg_len': _A_in['seg_len'], 'B_x': _B_in['x'], 'B_W_gate': _B_in['W_gate'], 'B_W_up': _B_in['W_up'], 'B_W_down': _B_in['W_down']}

def reference(A_x, A_mem0, A_Wq, A_Wk, A_Wv, A_Wo, A_seg_len, B_x, B_W_gate, B_W_up, B_W_down):

    def _A_ref(x, mem0, Wq, Wk, Wv, Wo, seg_len):
        B, S, Dm = x.shape
        H, Dh = (Wq.shape[1], Wq.shape[2])
        M = mem0.shape[1]
        scale = Dh ** (-0.5)
        n_seg = S // seg_len
        L = M + seg_len
        idx = torch.arange(L)
        mask = (idx[:, None] < M) | (idx[:, None] >= idx[None, :])
        mem = mem0
        outs = []
        for s in range(n_seg):
            xs = x[:, s * seg_len:(s + 1) * seg_len, :].clone()
            h = torch.concatenate([mem, xs], axis=1)
            q = torch.einsum('btd,dhe->bhte', h, Wq)
            k = torch.einsum('btd,dhe->bhte', h, Wk)
            v = torch.einsum('btd,dhe->bhte', h, Wv)
            scores = torch.einsum('bhqe,bhke->bhqk', q, k) * scale
            scores = torch.where(mask[None, None], scores, -1000000000.0)
            p = _softmax(scores, axis=-1)
            o = torch.einsum('bhqk,bhke->bhqe', p, v)
            o = torch.einsum('bhte,hed->btd', o, Wo)
            mem = o[:, :M, :].clone()
            outs.append(o[:, M:, :])
        return torch.concatenate(outs, axis=1)

    def _B_ref(x, W_gate, W_up, W_down):
        gate = torch.einsum('bsd,df->bsf', x, W_gate)
        up = torch.einsum('bsd,df->bsf', x, W_up)
        gate = gate * (lambda x, dt: x.to(dt))(gate > 0, gate.dtype)
        h = gate * up
        return torch.einsum('bsf,fd->bsd', h, W_down)
    x = A_x
    x = x + _A_ref(_layernorm(x, axis=-1), A_mem0, A_Wq, A_Wk, A_Wv, A_Wo, A_seg_len)
    x = x + _B_ref(_layernorm(x, axis=-1), B_W_gate, B_W_up, B_W_down)
    x = x + _A_ref(_layernorm(x, axis=-1), A_mem0, A_Wq, A_Wk, A_Wv, A_Wo, A_seg_len)
    x = x + _B_ref(_layernorm(x, axis=-1), B_W_gate, B_W_up, B_W_down)
    return x
```

```asm
; @launch grid=(256,1,1) block=(256,1,1) lds=163840
.amdgcn_target "amdgcn-amd-amdhsa--gfx950"
.text
.globl interleave_layers__memory_aug_recurrent_mem_tr__glu_gated_reglu__prompt_kernel
.p2align 8
.type interleave_layers__memory_aug_recurrent_mem_tr__glu_gated_reglu__prompt_kernel,@function
interleave_layers__memory_aug_recurrent_mem_tr__glu_gated_reglu__prompt_kernel:
  s_cmp_ge_u32 s2, 256
  s_cbranch_scc1 L_END
  s_load_dwordx16 s[4:19], s[0:1], 0
  s_load_dwordx8 s[20:27], s[0:1], 64
  s_load_dwordx4 s[28:31], s[0:1], 96
  v_and_b32 v1, 63, v0
  v_lshrrev_b32 v3, 6, v0
  v_lshlrev_b32 v2, 4, v1
  v_readfirstlane_b32 s56, v3
  s_getreg_b32 s58, hwreg(HW_REG_XCC_ID)
  s_and_b32 s58, s58, 15
  s_mov_b32 s64, 0
  s_mov_b32 s65, 0
  s_mov_b32 s66, -1
  s_mov_b32 s67, 0
  s_waitcnt lgkmcnt(0)
  s_mov_b32 s32, s30
  s_and_b32 s33, s31, 0xffff
  s_mov_b32 s34, 268435456
  s_mov_b32 s35, 0x20000
  s_mov_b32 s36, s28
  s_and_b32 s37, s29, 0xffff
  s_mov_b32 s38, 256
  s_mov_b32 s39, 0x20000
  s_cmp_lg_u32 s56, 0
  s_cbranch_scc1 ZF_1
  s_and_b32 s60, s2, 7
  s_cmp_eq_u32 s60, 0
  s_cselect_b32 s60, 48, 0
  s_cmp_ge_u32 s2, 216
  s_cselect_b32 s60, s60, 0
  v_cmp_gt_u32 vcc, s60, v1
  s_nop 1
  v_cndmask_b32 v4, 0, 1, vcc
  v_cndmask_b32 v5, 0, 1, vcc
  v_cndmask_b32 v6, 0, 1, vcc
  v_cndmask_b32 v7, 0, 1, vcc
  s_lshl_b32 s60, s2, 10
  buffer_store_dwordx4 v[4:7], v2, s[32:35], s60 offen sc1
ZF_1:
  s_lshr_b32 s60, s2, 3
  s_and_b32 s61, s2, 7
  s_sub_u32 s62, s61, 2
  s_cmp_lt_u32 s61, 5
  s_cselect_b32 s68, 16, 14
  s_mul_i32 s69, s62, s68
  s_cselect_b32 s57, 0, 6
  s_add_u32 s57, s57, 128
  s_add_u32 s57, s57, s69
  s_add_u32 s57, s57, s60
  s_sub_u32 s60, s60, s68
  s_mul_i32 s69, s62, 6
  s_add_u32 s69, s69, s60
  s_add_u32 s69, s69, 218
  s_cmp_lt_u32 s60, 6
  s_cselect_b32 s57, s69, s57
  s_sub_u32 s68, 26, s68
  s_mul_i32 s69, s62, s68
  s_cmp_lt_u32 s61, 5
  s_cselect_b32 s68, 58, 52
  s_add_u32 s69, s69, s68
  s_add_u32 s69, s69, s60
  s_cmp_lt_u32 s69, 128
  s_cselect_b32 s69, s69, 255
  s_sub_u32 s60, s60, 6
  s_cmp_lt_u32 s60, 12
  s_cselect_b32 s57, s69, s57
  s_lshr_b32 s60, s2, 3
  s_lshl_b32 s69, s61, 5
  s_add_u32 s69, s69, s60
  s_cmp_lt_u32 s61, 2
  s_cselect_b32 s57, s69, s57
  s_cmp_lt_u32 s57, 64
  s_cbranch_scc1 L_CHAIN
  s_cmp_lt_u32 s57, 128
  s_cbranch_scc1 L_QKV
  s_cmp_lt_u32 s57, 176
  s_cbranch_scc1 L_AO
  s_cmp_lt_u32 s57, 218
  s_cbranch_scc1 L_FFN
  s_cmp_lt_u32 s57, 254
  s_cbranch_scc1 L_RED
  s_waitcnt vmcnt(0)
  s_barrier
  s_cmp_lg_u32 s56, 0
  s_cbranch_scc1 IA_2
  s_mov_b64 exec, 1
  v_mov_b32 v30, 1
  v_mov_b32 v31, 12
  buffer_atomic_add v30, v31, s[36:39], 0 offen
  s_mov_b64 exec, -1
IA_2:
  s_branch L_END
L_RED:
  s_mov_b32 s40, s4
  s_and_b32 s41, s5, 0xffff
  s_mov_b32 s42, 2097152
  s_mov_b32 s43, 0x20000
  s_mov_b32 s44, s26
  s_and_b32 s45, s27, 0xffff
  s_mov_b32 s46, 2097152
  s_mov_b32 s47, 0x20000
  s_sub_u32 s70, s57, 218
  s_mul_i32 s76, s70, 43
  s_lshr_b32 s76, s76, 8
  s_mul_i32 s60, s76, 6
  s_sub_u32 s70, s70, s60
  s_mul_i32 s60, s56, 6
  s_add_u32 s70, s70, s60
  s_cmp_lg_u32 s56, 0
  s_cbranch_scc1 GR_3
  s_mov_b64 exec, 1
  s_lshl_b32 s60, 1, s58
  v_mov_b32 v3, s60
  s_lshl_b32 s60, s76, 2
  v_mov_b32 v4, 32
  buffer_atomic_or v3, v4, s[36:39], s60 offen
  s_mov_b64 exec, -1
GR_3:
  s_cmp_ge_u32 s76, 3
  s_cselect_b32 s71, 1, 0
  s_cselect_b32 s60, 3, 0
  s_sub_u32 s76, s76, s60
  s_waitcnt vmcnt(0)
  s_barrier
  s_cmp_lg_u32 s56, 0
  s_cbranch_scc1 IA_4
  s_mov_b64 exec, 1
  v_mov_b32 v30, 1
  v_mov_b32 v31, 12
  buffer_atomic_add v30, v31, s[36:39], 0 offen
  s_mov_b64 exec, -1
IA_4:
  v_lshlrev_b32 v23, 3, v1
  v_lshrrev_b32 v3, 4, v1
  v_and_b32 v4, 15, v1
  v_lshrrev_b32 v5, 1, v3
  v_and_b32 v6, 1, v3
  v_lshrrev_b32 v7, 3, v4
  v_lshl_add_u32 v5, v5, 1, v7
  v_and_b32 v7, 3, v4
  v_lshl_add_u32 v5, v5, 2, v7
  v_bfe_u32 v7, v4, 2, 1
  v_lshlrev_b32 v18, 10, v7
  v_lshl_add_u32 v18, v6, 3, v18
  v_mov_b32 v22, v18
  v_lshl_add_u32 v18, v5, 4, v18
  v_xor_b32 v5, v5, v7
  v_mov_b32 v19, v5
  v_lshrrev_b32 v7, 3, v1
  v_and_b32 v5, 7, v1
  v_lshlrev_b32 v20, 10, v7
  v_lshl_add_u32 v20, v5, 4, v20
  s_lshl_b32 s60, s56, 12
  v_add_u32 v21, s60, v2
  v_lshrrev_b32 v5, 3, v4
  v_bfe_u32 v6, v4, 1, 2
  v_and_b32 v7, 1, v4
  v_mov_b32 v8, 0x3f80
  v_mov_b32 v9, 0x3f800000
  v_cmp_eq_u32 vcc, 1, v7
  s_nop 1
  v_cndmask_b32 v8, v8, v9, vcc
  v_add_u32 v9, 0, v5
  v_cmp_eq_u32 s[82:83], v9, v3
  v_cmp_eq_u32 vcc, 0, v6
  s_and_b64 vcc, vcc, s[82:83]
  s_nop 0
  v_cndmask_b32 v48, 0, v8, vcc
  v_cmp_eq_u32 vcc, 1, v6
  s_and_b64 vcc, vcc, s[82:83]
  s_nop 0
  v_cndmask_b32 v49, 0, v8, vcc
  v_cmp_eq_u32 vcc, 2, v6
  s_and_b64 vcc, vcc, s[82:83]
  s_nop 0
  v_cndmask_b32 v50, 0, v8, vcc
  v_cmp_eq_u32 vcc, 3, v6
  s_and_b64 vcc, vcc, s[82:83]
  s_nop 0
  v_cndmask_b32 v51, 0, v8, vcc
  v_add_u32 v9, 2, v5
  v_cmp_eq_u32 s[82:83], v9, v3
  v_cmp_eq_u32 vcc, 0, v6
  s_and_b64 vcc, vcc, s[82:83]
  s_nop 0
  v_cndmask_b32 v52, 0, v8, vcc
  v_cmp_eq_u32 vcc, 1, v6
  s_and_b64 vcc, vcc, s[82:83]
  s_nop 0
  v_cndmask_b32 v53, 0, v8, vcc
  v_cmp_eq_u32 vcc, 2, v6
  s_and_b64 vcc, vcc, s[82:83]
  s_nop 0
  v_cndmask_b32 v54, 0, v8, vcc
  v_cmp_eq_u32 vcc, 3, v6
  s_and_b64 vcc, vcc, s[82:83]
  s_nop 0
  v_cndmask_b32 v55, 0, v8, vcc
  s_mov_b32 s84, s76
  s_mov_b32 s85, s76
  s_mov_b32 s89, 0
  s_mov_b32 s90, 16384
  s_mov_b32 s73, 0
  s_sub_u32 s72, s57, 218
  s_lshl_b32 s72, s72, 2
  s_add_u32 s72, s72, s56
  s_lshl_b32 s72, s72, 1
  s_mov_b32 s75, 0
L_RED0:
  s_lshl_b32 s60, s72, 10
  buffer_load_dwordx2 v[56:57], v18, s[40:43], s60 offen offset:0
  buffer_load_dwordx2 v[58:59], v18, s[40:43], s60 offen offset:256
  buffer_load_dwordx2 v[60:61], v18, s[40:43], s60 offen offset:512
  buffer_load_dwordx2 v[62:63], v18, s[40:43], s60 offen offset:768
  s_waitcnt vmcnt(0)
  s_cmp_eq_u32 s89, 0
  s_cbranch_scc1 RSG_5
  v_mov_b32 v40, 1
  v_mov_b32 v41, 0
  buffer_store_dword v40, v41, s[32:35], s89 offen sc1
  s_mov_b32 s89, 0
RSG_5:
  v_lshlrev_b32 v24, 16, v56
  v_and_b32 v25, 0xffff0000, v56
  v_lshlrev_b32 v26, 16, v57
  v_and_b32 v27, 0xffff0000, v57
  v_lshlrev_b32 v28, 16, v58
  v_and_b32 v29, 0xffff0000, v58
  v_lshlrev_b32 v30, 16, v59
  v_and_b32 v31, 0xffff0000, v59
  v_lshlrev_b32 v32, 16, v60
  v_and_b32 v33, 0xffff0000, v60
  v_lshlrev_b32 v34, 16, v61
  v_and_b32 v35, 0xffff0000, v61
  v_lshlrev_b32 v36, 16, v62
  v_and_b32 v37, 0xffff0000, v62
  v_lshlrev_b32 v38, 16, v63
  v_and_b32 v39, 0xffff0000, v63
  v_pk_add_f32 v[192:193], v[24:25], v[26:27]
  v_pk_add_f32 v[194:195], v[28:29], v[30:31]
  v_pk_add_f32 v[196:197], v[32:33], v[34:35]
  v_pk_add_f32 v[198:199], v[36:37], v[38:39]
  v_pk_add_f32 v[192:193], v[192:193], v[194:195]
  v_pk_add_f32 v[196:197], v[196:197], v[198:199]
  v_pk_add_f32 v[192:193], v[192:193], v[196:197]
  v_add_f32 v40, v192, v193
  s_and_b32 s61, s72, 14
  v_xor_b32 v43, s61, v19
  v_lshl_add_u32 v43, v43, 4, v22
  v_add_f32_dpp v40, v40, v40 quad_perm:[1,0,3,2] row_mask:0xf bank_mask:0xf
  s_nop 1
  v_add_f32_dpp v40, v40, v40 quad_perm:[2,3,0,1] row_mask:0xf bank_mask:0xf
  s_nop 1
  v_add_f32_dpp v40, v40, v40 row_ror:8 row_mask:0xf bank_mask:0xf
  v_mov_b32 v41, v40
  s_nop 1
  v_permlane16_swap_b32 v40, v41
  v_add_f32 v40, v40, v41
  v_mov_b32 v41, v40
  s_nop 1
  v_permlane32_swap_b32 v40, v41
  v_add_f32 v40, v40, v41
  v_mul_f32 v42, 0x3b000000, v40
  v_pk_add_f32 v[192:193], v[24:25], v[42:43] op_sel_hi:[1,0] neg_lo:[0,1] neg_hi:[0,1]
  v_pk_add_f32 v[194:195], v[26:27], v[42:43] op_sel_hi:[1,0] neg_lo:[0,1] neg_hi:[0,1]
  v_pk_add_f32 v[196:197], v[28:29], v[42:43] op_sel_hi:[1,0] neg_lo:[0,1] neg_hi:[0,1]
  v_pk_add_f32 v[198:199], v[30:31], v[42:43] op_sel_hi:[1,0] neg_lo:[0,1] neg_hi:[0,1]
  v_pk_add_f32 v[200:201], v[32:33], v[42:43] op_sel_hi:[1,0] neg_lo:[0,1] neg_hi:[0,1]
  v_pk_add_f32 v[202:203], v[34:35], v[42:43] op_sel_hi:[1,0] neg_lo:[0,1] neg_hi:[0,1]
  v_pk_add_f32 v[204:205], v[36:37], v[42:43] op_sel_hi:[1,0] neg_lo:[0,1] neg_hi:[0,1]
  v_pk_add_f32 v[206:207], v[38:39], v[42:43] op_sel_hi:[1,0] neg_lo:[0,1] neg_hi:[0,1]
  v_cvt_pk_bf16_f32 v42, v42, v42
  v_and_b32 v42, 0xffff0000, v42
  v_pk_mul_f32 v[192:193], v[192:193], v[192:193]
  v_pk_mul_f32 v[194:195], v[194:195], v[194:195]
  v_pk_fma_f32 v[192:193], v[196:197], v[196:197], v[192:193]
  v_pk_fma_f32 v[194:195], v[198:199], v[198:199], v[194:195]
  v_pk_fma_f32 v[192:193], v[200:201], v[200:201], v[192:193]
  v_pk_fma_f32 v[194:195], v[202:203], v[202:203], v[194:195]
  v_pk_fma_f32 v[192:193], v[204:205], v[204:205], v[192:193]
  v_pk_fma_f32 v[194:195], v[206:207], v[206:207], v[194:195]
  v_pk_add_f32 v[192:193], v[192:193], v[194:195]
  v_add_f32 v40, v192, v193
  v_pk_add_f32 v[24:25], v[24:25], v[42:43] op_sel_hi:[1,0] neg_lo:[0,1] neg_hi:[0,1]
  v_pk_add_f32 v[26:27], v[26:27], v[42:43] op_sel_hi:[1,0] neg_lo:[0,1] neg_hi:[0,1]
  v_pk_add_f32 v[28:29], v[28:29], v[42:43] op_sel_hi:[1,0] neg_lo:[0,1] neg_hi:[0,1]
  v_pk_add_f32 v[30:31], v[30:31], v[42:43] op_sel_hi:[1,0] neg_lo:[0,1] neg_hi:[0,1]
  v_pk_add_f32 v[32:33], v[32:33], v[42:43] op_sel_hi:[1,0] neg_lo:[0,1] neg_hi:[0,1]
  v_pk_add_f32 v[34:35], v[34:35], v[42:43] op_sel_hi:[1,0] neg_lo:[0,1] neg_hi:[0,1]
  v_pk_add_f32 v[36:37], v[36:37], v[42:43] op_sel_hi:[1,0] neg_lo:[0,1] neg_hi:[0,1]
  v_pk_add_f32 v[38:39], v[38:39], v[42:43] op_sel_hi:[1,0] neg_lo:[0,1] neg_hi:[0,1]
  v_add_f32_dpp v40, v40, v40 quad_perm:[1,0,3,2] row_mask:0xf bank_mask:0xf
  s_nop 1
  v_add_f32_dpp v40, v40, v40 quad_perm:[2,3,0,1] row_mask:0xf bank_mask:0xf
  s_nop 1
  v_add_f32_dpp v40, v40, v40 row_ror:8 row_mask:0xf bank_mask:0xf
  v_mov_b32 v41, v40
  s_nop 1
  v_permlane16_swap_b32 v40, v41
  v_add_f32 v40, v40, v41
  v_mov_b32 v41, v40
  s_nop 1
  v_permlane32_swap_b32 v40, v41
  v_add_f32 v40, v40, v41
  v_mul_f32 v40, 0x3b000000, v40
  v_cvt_pk_bf16_f32 v40, v40, v40
  v_and_b32 v40, 0xffff0000, v40
  v_add_f32 v40, 0x3727c5ac, v40
  v_cvt_pk_bf16_f32 v40, v40, v40
  v_and_b32 v40, 0xffff0000, v40
  v_sqrt_f32 v40, v40
  v_cvt_pk_bf16_f32 v192, v24, v25
  v_cvt_pk_bf16_f32 v193, v26, v27
  v_cvt_pk_bf16_f32 v194, v28, v29
  v_cvt_pk_bf16_f32 v195, v30, v31
  v_cvt_pk_bf16_f32 v196, v32, v33
  v_cvt_pk_bf16_f32 v197, v34, v35
  v_cvt_pk_bf16_f32 v198, v36, v37
  v_cvt_pk_bf16_f32 v199, v38, v39
  v_cvt_pk_bf16_f32 v40, v40, v40
  v_and_b32 v40, 0xffff0000, v40
  v_rcp_f32 v42, v40
  v_lshlrev_b32 v24, 16, v192
  v_and_b32 v25, 0xffff0000, v192
  v_lshlrev_b32 v26, 16, v193
  v_and_b32 v27, 0xffff0000, v193
  v_lshlrev_b32 v28, 16, v194
  v_and_b32 v29, 0xffff0000, v194
  v_lshlrev_b32 v30, 16, v195
  v_and_b32 v31, 0xffff0000, v195
  v_lshlrev_b32 v32, 16, v196
  v_and_b32 v33, 0xffff0000, v196
  v_lshlrev_b32 v34, 16, v197
  v_and_b32 v35, 0xffff0000, v197
  v_lshlrev_b32 v36, 16, v198
  v_and_b32 v37, 0xffff0000, v198
  v_lshlrev_b32 v38, 16, v199
  v_and_b32 v39, 0xffff0000, v199
  s_lshl_b32 s60, s72, 10
  s_and_b32 s61, s73, 1
  s_lshl_b32 s61, s61, 21
  s_add_u32 s60, s60, s61
  s_add_u32 s60, s60, 4194304
  v_pk_mul_f32 v[24:25], v[24:25], v[42:43] op_sel_hi:[1,0]
  v_pk_mul_f32 v[26:27], v[26:27], v[42:43] op_sel_hi:[1,0]
  v_cvt_pk_bf16_f32 v192, v24, v25
  v_cvt_pk_bf16_f32 v193, v26, v27
  buffer_store_dwordx2 v[192:193], v43, s[32:35], s60 offen offset:0 sc1
  v_pk_mul_f32 v[28:29], v[28:29], v[42:43] op_sel_hi:[1,0]
  v_pk_mul_f32 v[30:31], v[30:31], v[42:43] op_sel_hi:[1,0]
  v_cvt_pk_bf16_f32 v194, v28, v29
  v_cvt_pk_bf16_f32 v195, v30, v31
  buffer_store_dwordx2 v[194:195], v43, s[32:35], s60 offen offset:256 sc1
  v_pk_mul_f32 v[32:33], v[32:33], v[42:43] op_sel_hi:[1,0]
  v_pk_mul_f32 v[34:35], v[34:35], v[42:43] op_sel_hi:[1,0]
  v_cvt_pk_bf16_f32 v196, v32, v33
  v_cvt_pk_bf16_f32 v197, v34, v35
  buffer_store_dwordx2 v[196:197], v43, s[32:35], s60 offen offset:512 sc1
  v_pk_mul_f32 v[36:37], v[36:37], v[42:43] op_sel_hi:[1,0]
  v_pk_mul_f32 v[38:39], v[38:39], v[42:43] op_sel_hi:[1,0]
  v_cvt_pk_bf16_f32 v198, v36, v37
  v_cvt_pk_bf16_f32 v199, v38, v39
  buffer_store_dwordx2 v[198:199], v43, s[32:35], s60 offen offset:768 sc1
  s_lshl_b32 s89, s73, 13
  s_lshl_b32 s61, s72, 1
  s_add_u32 s89, s89, s61
  s_add_u32 s89, s89, 221952
  s_cmp_lg_u32 s75, 0
  s_cbranch_scc1 L_RED0_S
  v_mov_b32 v41, 12
IW_6:
  buffer_load_dword v40, v41, s[36:39], 0 offen sc1
  s_waitcnt vmcnt(0)
  v_readfirstlane_b32 s60, v40
  s_cmp_ge_u32 s60, 256
  s_cbranch_scc1 IWD_7
  s_add_u32 s64, s64, 1
  s_cmp_lt_u32 s64, 131072
  s_cbranch_scc1 SPOK_8
  s_mov_b32 s63, 1
  s_branch L_ABORT
SPOK_8:
  s_sleep 8
  s_branch IW_6
IWD_7:
  s_mov_b32 s64, 0
  s_mov_b32 s75, 1
L_RED0_S:
  s_add_u32 s72, s72, 288
  s_cmp_lt_u32 s72, 2048
  s_cbranch_scc1 L_RED0
  s_waitcnt vmcnt(0)
  s_cmp_eq_u32 s89, 0
  s_cbranch_scc1 RSG_9
  v_mov_b32 v40, 1
  v_mov_b32 v41, 0
  buffer_store_dword v40, v41, s[32:35], s89 offen sc1
  s_mov_b32 s89, 0
RSG_9:
  s_sub_u32 s60, s70, 16
  s_lshl_b32 s60, s60, 1
  s_add_u32 s61, s76, 48
  s_cmp_ge_u32 s70, 16
  s_cselect_b32 s78, 1, 0
  s_cselect_b32 s70, s60, s70
  s_cselect_b32 s84, 128, s84
  s_cselect_b32 s85, s85, s61
L_RED_P0:
  s_cmp_lg_u32 s71, 0
  s_cbranch_scc1 L_RED_P1
  v_and_b32 v3, 31, v1
  v_cmp_gt_u32 vcc, 32, v3
  v_lshlrev_b32 v3, 3, v3
  s_nop 0
  v_cndmask_b32 v3, 0, v3, vcc
  v_mov_b32 v4, 155648
  v_mov_b32 v5, 172032
  v_cndmask_b32 v4, v4, v5, s[66:67]
  v_add_u32 v8, v3, v4
  v_mov_b32 v9, 256
  v_mov_b32 v10, 1
  v_mov_b32 v11, 0
  v_lshlrev_b32 v21, 7, v1
  s_lshl_b32 s60, s76, 21
  s_lshl_b32 s61, s76, 20
  s_add_u32 s61, s61, 6291456
  s_cmp_eq_u32 s78, 1
  s_cselect_b32 s60, s61, s60
  s_mov_b32 s62, 499712
  s_cselect_b32 s62, 8192, s62
  s_mov_b32 s63, 499712
  s_cselect_b32 s63, 466944, s63
  s_lshl_b32 s61, s70, 15
  s_add_u32 s60, s60, s61
  s_add_u32 s60, s60, 138412032
  buffer_load_dword v64, v21, s[32:35], s60 offen sc1
  s_add_u32 s60, s60, 8192
  buffer_load_dword v65, v21, s[32:35], s60 offen sc1
  s_add_u32 s60, s60, 8192
  buffer_load_dword v66, v21, s[32:35], s60 offen sc1
  s_add_u32 s60, s60, 8192
  buffer_load_dword v67, v21, s[32:35], s60 offen sc1
  s_add_u32 s60, s60, s62
  buffer_load_dword v68, v21, s[32:35], s60 offen sc1
  s_add_u32 s60, s60, 8192
  buffer_load_dword v69, v21, s[32:35], s60 offen sc1
  s_add_u32 s60, s60, 8192
  buffer_load_dword v70, v21, s[32:35], s60 offen sc1
  s_add_u32 s60, s60, 8192
  buffer_load_dword v71, v21, s[32:35], s60 offen sc1
  s_add_u32 s60, s60, s63
  buffer_load_dword v72, v21, s[32:35], s60 offen sc1
  s_add_u32 s60, s60, 8192
  buffer_load_dword v73, v21, s[32:35], s60 offen sc1
  s_add_u32 s60, s60, 8192
  buffer_load_dword v74, v21, s[32:35], s60 offen sc1
  s_add_u32 s60, s60, 8192
  buffer_load_dword v75, v21, s[32:35], s60 offen sc1
  s_add_u32 s60, s60, s62
  buffer_load_dword v76, v21, s[32:35], s60 offen sc1
  s_add_u32 s60, s60, 8192
  buffer_load_dword v77, v21, s[32:35], s60 offen sc1
  s_add_u32 s60, s60, 8192
  buffer_load_dword v78, v21, s[32:35], s60 offen sc1
  s_add_u32 s60, s60, 8192
  buffer_load_dword v79, v21, s[32:35], s60 offen sc1
  s_add_u32 s60, s60, s63
L_RED_LP0:
  s_min_u32 s60, s84, s85
  s_cmp_ge_u32 s60, 64
  s_cbranch_scc1 L_RED_FIN0
  s_min_u32 s60, s84, 63
  s_min_u32 s61, s85, 63
  v_mov_b32 v12, s60
  v_mov_b32 v13, s61
  v_cndmask_b32 v12, v12, v13, s[66:67]
  v_mad_u32_u24 v13, v12, v9, v8
  v_mad_u32_u24 v14, v12, v11, v10
  buffer_load_dwordx2 v[16:17], v13, s[32:35], 0 offen sc1
PK_10:
  s_waitcnt vmcnt(0)
  v_min_u32 v12, v16, v17
  v_cmp_ge_u32 vcc, v12, v14
  s_add_u32 s61, s85, 64
  s_cmp_lt_u32 s85, 64
  s_cselect_b32 s61, s61, 255
  s_cmp_eq_u32 vcc_lo, -1
  s_cselect_b32 s61, s61, 255
  s_cmp_lt_u32 s84, 64
  s_cselect_b32 s60, s84, 255
  s_cmp_eq_u32 vcc_hi, -1
  s_cselect_b32 s60, s60, 255
  s_min_u32 s60, s60, s61
  s_mov_b32 s63, s60
  s_cmp_eq_u32 s89, 0
  s_cbranch_scc1 RSG_12
  v_mov_b32 v40, 1
  v_mov_b32 v41, 0
  buffer_store_dword v40, v41, s[32:35], s89 offen sc1
  s_mov_b32 s89, 0
RSG_12:
  s_cmp_lg_u32 s63, 255
  s_cbranch_scc1 PKG_11
  s_add_u32 s64, s64, 1
  s_cmp_lt_u32 s64, 131072
  s_cbranch_scc1 SPOK_13
  s_mov_b32 s63, 2
  s_branch L_ABORT
SPOK_13:
  s_sleep 8
  buffer_load_dwordx2 v[16:17], v13, s[32:35], 0 offen sc1
  s_branch PK_10
PKG_11:
  s_mov_b32 s64, 0
  s_lshr_b32 s86, s63, 6
  s_and_b32 s87, s63, 63
  s_cmp_eq_u32 s86, 0
  s_cselect_b32 s60, 3, 0
  s_cselect_b32 s61, 0, 3
  s_add_u32 s84, s84, s60
  s_add_u32 s85, s85, s61
  s_cmp_ge_u32 s85, 48
  s_cselect_b32 s60, s78, 0
  s_lshl_b32 s60, s60, 7
  s_or_b32 s85, s85, s60
L_RED_LP0_AGAIN:
  s_mov_b32 s91, s86
  s_mov_b32 s92, s87
  s_lshl_b32 s72, s92, 5
  s_lshl_b32 s60, s70, 1
  s_add_u32 s72, s72, s60
  s_mul_i32 s74, s92, 43
  s_bfe_u32 s74, s74, 0x20007
  s_lshl_b32 s60, s76, 2
  s_add_u32 s74, s74, s60
  s_add_u32 s60, s92, 16
  s_cmp_ge_u32 s92, 52
  s_cselect_b32 s60, s74, s60
  s_cmp_eq_u32 s91, 0
  s_cselect_b32 s74, s74, s60
  s_lshl_b32 s74, s74, 19
  s_add_u32 s74, s74, 138412032
  s_lshl_b32 s60, s70, 15
  s_add_u32 s74, s74, s60
  s_lshl_b32 s73, s91, 1
  s_add_u32 s73, s73, 1
  s_lshl_b32 s60, s72, 10
  buffer_load_dwordx4 v[64:67], v2, s[32:35], s74 offen offset:0 sc1
  buffer_load_dwordx4 v[68:71], v2, s[32:35], s74 offen offset:1024 sc1
  buffer_load_dwordx4 v[72:75], v2, s[32:35], s74 offen offset:2048 sc1
  buffer_load_dwordx4 v[76:79], v2, s[32:35], s74 offen offset:3072 sc1
  s_add_u32 s74, s74, 4096
  buffer_load_dwordx4 v[80:83], v2, s[32:35], s74 offen offset:0 sc1
  buffer_load_dwordx4 v[84:87], v2, s[32:35], s74 offen offset:1024 sc1
  buffer_load_dwordx4 v[88:91], v2, s[32:35], s74 offen offset:2048 sc1
  buffer_load_dwordx4 v[92:95], v2, s[32:35], s74 offen offset:3072 sc1
  s_add_u32 s74, s74, 4096
  buffer_load_dwordx4 v[96:99], v2, s[32:35], s74 offen offset:0 sc1
  buffer_load_dwordx4 v[100:103], v2, s[32:35], s74 offen offset:1024 sc1
  buffer_load_dwordx4 v[104:107], v2, s[32:35], s74 offen offset:2048 sc1
  buffer_load_dwordx4 v[108:111], v2, s[32:35], s74 offen offset:3072 sc1
  s_add_u32 s74, s74, 4096
  buffer_load_dwordx4 v[112:115], v2, s[32:35], s74 offen offset:0 sc1
  s_waitcnt vmcnt(12)
  s_cmp_eq_u32 s89, 0
  s_cbranch_scc1 RSG_14
  v_mov_b32 v40, 1
  v_mov_b32 v41, 0
  buffer_store_dword v40, v41, s[32:35], s89 offen sc1
  s_mov_b32 s89, 0
RSG_14:
  s_lshl_b32 s60, s72, 10
  v_mfma_f32_16x16x32_bf16 v[24:27], v[48:51], v[64:67], 0
  v_mfma_f32_16x16x32_bf16 v[28:31], v[52:55], v[64:67], 0
  buffer_load_dwordx4 v[116:119], v2, s[32:35], s74 offen offset:1024 sc1
  s_waitcnt vmcnt(12)
  v_mfma_f32_16x16x32_bf16 v[32:35], v[48:51], v[68:71], 0
  v_mfma_f32_16x16x32_bf16 v[36:39], v[52:55], v[68:71], 0
  buffer_load_dwordx4 v[120:123], v2, s[32:35], s74 offen offset:2048 sc1
  s_waitcnt vmcnt(12)
  v_mfma_f32_16x16x32_bf16 v[24:27], v[48:51], v[72:75], v[24:27]
  v_mfma_f32_16x16x32_bf16 v[28:31], v[52:55], v[72:75], v[28:31]
  buffer_load_dwordx4 v[124:127], v2, s[32:35], s74 offen offset:3072 sc1
  s_add_u32 s74, s74, 4096
  s_waitcnt vmcnt(12)
  v_mfma_f32_16x16x32_bf16 v[32:35], v[48:51], v[76:79], v[32:35]
  v_mfma_f32_16x16x32_bf16 v[36:39], v[52:55], v[76:79], v[36:39]
  buffer_load_dwordx4 v[128:131], v2, s[32:35], s74 offen offset:0 sc1
  s_waitcnt vmcnt(12)
  v_mfma_f32_16x16x32_bf16 v[24:27], v[48:51], v[80:83], v[24:27]
  v_mfma_f32_16x16x32_bf16 v[28:31], v[52:55], v[80:83], v[28:31]
  buffer_load_dwordx4 v[132:135], v2, s[32:35], s74 offen offset:1024 sc1
  s_waitcnt vmcnt(12)
  v_mfma_f32_16x16x32_bf16 v[32:35], v[48:51], v[84:87], v[32:35]
  v_mfma_f32_16x16x32_bf16 v[36:39], v[52:55], v[84:87], v[36:39]
  buffer_load_dwordx4 v[136:139], v2, s[32:35], s74 offen offset:2048 sc1
  s_waitcnt vmcnt(12)
  v_mfma_f32_16x16x32_bf16 v[24:27], v[48:51], v[88:91], v[24:27]
  v_mfma_f32_16x16x32_bf16 v[28:31], v[52:55], v[88:91], v[28:31]
  buffer_load_dwordx4 v[140:143], v2, s[32:35], s74 offen offset:3072 sc1
  s_add_u32 s74, s74, 4096
  s_waitcnt vmcnt(12)
  v_mfma_f32_16x16x32_bf16 v[32:35], v[48:51], v[92:95], v[32:35]
  v_mfma_f32_16x16x32_bf16 v[36:39], v[52:55], v[92:95], v[36:39]
  buffer_load_dwordx4 v[144:147], v2, s[32:35], s74 offen offset:0 sc1
  s_waitcnt vmcnt(12)
  v_mfma_f32_16x16x32_bf16 v[24:27], v[48:51], v[96:99], v[24:27]
  v_mfma_f32_16x16x32_bf16 v[28:31], v[52:55], v[96:99], v[28:31]
  buffer_load_dwordx4 v[148:151], v2, s[32:35], s74 offen offset:1024 sc1
  s_waitcnt vmcnt(12)
  v_mfma_f32_16x16x32_bf16 v[32:35], v[48:51], v[100:103], v[32:35]
  v_mfma_f32_16x16x32_bf16 v[36:39], v[52:55], v[100:103], v[36:39]
  buffer_load_dwordx4 v[152:155], v2, s[32:35], s74 offen offset:2048 sc1
  s_waitcnt vmcnt(12)
  v_mfma_f32_16x16x32_bf16 v[24:27], v[48:51], v[104:107], v[24:27]
  v_mfma_f32_16x16x32_bf16 v[28:31], v[52:55], v[104:107], v[28:31]
  buffer_load_dwordx4 v[156:159], v2, s[32:35], s74 offen offset:3072 sc1
  s_add_u32 s74, s74, 4096
  s_waitcnt vmcnt(12)
  v_mfma_f32_16x16x32_bf16 v[32:35], v[48:51], v[108:111], v[32:35]
  v_mfma_f32_16x16x32_bf16 v[36:39], v[52:55], v[108:111], v[36:39]
  buffer_load_dwordx4 v[160:163], v2, s[32:35], s74 offen offset:0 sc1
  s_waitcnt vmcnt(12)
  v_mfma_f32_16x16x32_bf16 v[24:27], v[48:51], v[112:115], v[24:27]
  v_mfma_f32_16x16x32_bf16 v[28:31], v[52:55], v[112:115], v[28:31]
  buffer_load_dwordx4 v[164:167], v2, s[32:35], s74 offen offset:1024 sc1
  s_waitcnt vmcnt(12)
  v_mfma_f32_16x16x32_bf16 v[32:35], v[48:51], v[116:119], v[32:35]
  v_mfma_f32_16x16x32_bf16 v[36:39], v[52:55], v[116:119], v[36:39]
  buffer_load_dwordx4 v[168:171], v2, s[32:35], s74 offen offset:2048 sc1
  s_waitcnt vmcnt(12)
  v_mfma_f32_16x16x32_bf16 v[24:27], v[48:51], v[120:123], v[24:27]
  v_mfma_f32_16x16x32_bf16 v[28:31], v[52:55], v[120:123], v[28:31]
  buffer_load_dwordx4 v[172:175], v2, s[32:35], s74 offen offset:3072 sc1
  s_add_u32 s74, s74, 4096
  s_waitcnt vmcnt(12)
  v_mfma_f32_16x16x32_bf16 v[32:35], v[48:51], v[124:127], v[32:35]
  v_mfma_f32_16x16x32_bf16 v[36:39], v[52:55], v[124:127], v[36:39]
  buffer_load_dwordx4 v[176:179], v2, s[32:35], s74 offen offset:0 sc1
  s_waitcnt vmcnt(12)
  v_mfma_f32_16x16x32_bf16 v[24:27], v[48:51], v[128:131], v[24:27]
  v_mfma_f32_16x16x32_bf16 v[28:31], v[52:55], v[128:131], v[28:31]
  buffer_load_dwordx4 v[180:183], v2, s[32:35], s74 offen offset:1024 sc1
  s_waitcnt vmcnt(12)
  v_mfma_f32_16x16x32_bf16 v[32:35], v[48:51], v[132:135], v[32:35]
  v_mfma_f32_16x16x32_bf16 v[36:39], v[52:55], v[132:135], v[36:39]
  buffer_load_dwordx4 v[184:187], v2, s[32:35], s74 offen offset:2048 sc1
  s_waitcnt vmcnt(12)
  v_mfma_f32_16x16x32_bf16 v[24:27], v[48:51], v[136:139], v[24:27]
  v_mfma_f32_16x16x32_bf16 v[28:31], v[52:55], v[136:139], v[28:31]
  buffer_load_dwordx4 v[188:191], v2, s[32:35], s74 offen offset:3072 sc1
  s_waitcnt vmcnt(12)
  v_mfma_f32_16x16x32_bf16 v[32:35], v[48:51], v[140:143], v[32:35]
  v_mfma_f32_16x16x32_bf16 v[36:39], v[52:55], v[140:143], v[36:39]
  s_cmp_lg_u32 s91, 0
  s_cbranch_scc1 RXR_15
  buffer_load_dwordx2 v[56:57], v18, s[40:43], s60 offen offset:0
  buffer_load_dwordx2 v[58:59], v18, s[40:43], s60 offen offset:256
  buffer_load_dwordx2 v[60:61], v18, s[40:43], s60 offen offset:512
  buffer_load_dwordx2 v[62:63], v18, s[40:43], s60 offen offset:768
  s_branch RXD_16
RXR_15:
  s_lshl_b32 s61, s73, 21
  s_add_u32 s61, s61, s60
  s_add_u32 s61, s61, 8388608
  buffer_load_dwordx2 v[56:57], v23, s[32:35], s61 offen offset:0 sc1
  buffer_load_dwordx2 v[58:59], v23, s[32:35], s61 offen offset:512 sc1
  buffer_load_dwordx2 v[60:61], v23, s[32:35], s61 offen offset:1024 sc1
  buffer_load_dwordx2 v[62:63], v23, s[32:35], s61 offen offset:1536 sc1
RXD_16:
  s_waitcnt vmcnt(15)
  v_mfma_f32_16x16x32_bf16 v[24:27], v[48:51], v[144:147], v[24:27]
  v_mfma_f32_16x16x32_bf16 v[28:31], v[52:55], v[144:147], v[28:31]
  s_waitcnt vmcnt(14)
  v_mfma_f32_16x16x32_bf16 v[32:35], v[48:51], v[148:151], v[32:35]
  v_mfma_f32_16x16x32_bf16 v[36:39], v[52:55], v[148:151], v[36:39]
  s_waitcnt vmcnt(13)
  v_mfma_f32_16x16x32_bf16 v[24:27], v[48:51], v[152:155], v[24:27]
  v_mfma_f32_16x16x32_bf16 v[28:31], v[52:55], v[152:155], v[28:31]
  s_waitcnt vmcnt(12)
  v_mfma_f32_16x16x32_bf16 v[32:35], v[48:51], v[156:159], v[32:35]
  v_mfma_f32_16x16x32_bf16 v[36:39], v[52:55], v[156:159], v[36:39]
  s_waitcnt vmcnt(11)
  v_mfma_f32_16x16x32_bf16 v[24:27], v[48:51], v[160:163], v[24:27]
  v_mfma_f32_16x16x32_bf16 v[28:31], v[52:55], v[160:163], v[28:31]
  s_waitcnt vmcnt(10)
  v_mfma_f32_16x16x32_bf16 v[32:35], v[48:51], v[164:167], v[32:35]
  v_mfma_f32_16x16x32_bf16 v[36:39], v[52:55], v[164:167], v[36:39]
  s_waitcnt vmcnt(9)
  v_mfma_f32_16x16x32_bf16 v[24:27], v[48:51], v[168:171], v[24:27]
  v_mfma_f32_16x16x32_bf16 v[28:31], v[52:55], v[168:171], v[28:31]
  s_waitcnt vmcnt(8)
  v_mfma_f32_16x16x32_bf16 v[32:35], v[48:51], v[172:175], v[32:35]
  v_mfma_f32_16x16x32_bf16 v[36:39], v[52:55], v[172:175], v[36:39]
  s_waitcnt vmcnt(7)
  v_mfma_f32_16x16x32_bf16 v[24:27], v[48:51], v[176:179], v[24:27]
  v_mfma_f32_16x16x32_bf16 v[28:31], v[52:55], v[176:179], v[28:31]
  s_waitcnt vmcnt(6)
  v_mfma_f32_16x16x32_bf16 v[32:35], v[48:51], v[180:183], v[32:35]
  v_mfma_f32_16x16x32_bf16 v[36:39], v[52:55], v[180:183], v[36:39]
  s_waitcnt vmcnt(5)
  v_mfma_f32_16x16x32_bf16 v[24:27], v[48:51], v[184:187], v[24:27]
  v_mfma_f32_16x16x32_bf16 v[28:31], v[52:55], v[184:187], v[28:31]
  s_waitcnt vmcnt(4)
  v_mfma_f32_16x16x32_bf16 v[32:35], v[48:51], v[188:191], v[32:35]
  v_mfma_f32_16x16x32_bf16 v[36:39], v[52:55], v[188:191], v[36:39]
  s_waitcnt vmcnt(0)
  v_lshlrev_b32 v192, 16, v56
  v_and_b32 v193, 0xffff0000, v56
  v_lshlrev_b32 v194, 16, v57
  v_and_b32 v195, 0xffff0000, v57
  v_lshlrev_b32 v196, 16, v58
  v_and_b32 v197, 0xffff0000, v58
  v_lshlrev_b32 v198, 16, v59
  v_and_b32 v199, 0xffff0000, v59
  v_lshlrev_b32 v200, 16, v60
  v_and_b32 v201, 0xffff0000, v60
  v_lshlrev_b32 v202, 16, v61
  v_and_b32 v203, 0xffff0000, v61
  v_lshlrev_b32 v204, 16, v62
  v_and_b32 v205, 0xffff0000, v62
  v_lshlrev_b32 v206, 16, v63
  v_and_b32 v207, 0xffff0000, v63
  v_cvt_pk_bf16_f32 v208, v24, v25
  v_cvt_pk_bf16_f32 v209, v26, v27
  v_cvt_pk_bf16_f32 v210, v28, v29
  v_cvt_pk_bf16_f32 v211, v30, v31
  v_cvt_pk_bf16_f32 v212, v32, v33
  v_cvt_pk_bf16_f32 v213, v34, v35
  v_cvt_pk_bf16_f32 v214, v36, v37
  v_cvt_pk_bf16_f32 v215, v38, v39
  v_lshlrev_b32 v24, 16, v208
  v_and_b32 v25, 0xffff0000, v208
  v_lshlrev_b32 v26, 16, v209
  v_and_b32 v27, 0xffff0000, v209
  v_lshlrev_b32 v28, 16, v210
  v_and_b32 v29, 0xffff0000, v210
  v_lshlrev_b32 v30, 16, v211
  v_and_b32 v31, 0xffff0000, v211
  v_lshlrev_b32 v32, 16, v212
  v_and_b32 v33, 0xffff0000, v212
  v_lshlrev_b32 v34, 16, v213
  v_and_b32 v35, 0xffff0000, v213
  v_lshlrev_b32 v36, 16, v214
  v_and_b32 v37, 0xffff0000, v214
  v_lshlrev_b32 v38, 16, v215
  v_and_b32 v39, 0xffff0000, v215
  v_pk_add_f32 v[24:25], v[24:25], v[192:193]
  v_pk_add_f32 v[26:27], v[26:27], v[194:195]
  v_pk_add_f32 v[28:29], v[28:29], v[196:197]
  v_pk_add_f32 v[30:31], v[30:31], v[198:199]
  v_pk_add_f32 v[32:33], v[32:33], v[200:201]
  v_pk_add_f32 v[34:35], v[34:35], v[202:203]
  v_pk_add_f32 v[36:37], v[36:37], v[204:205]
  v_pk_add_f32 v[38:39], v[38:39], v[206:207]
  v_cvt_pk_bf16_f32 v208, v24, v25
  v_cvt_pk_bf16_f32 v209, v26, v27
  v_cvt_pk_bf16_f32 v210, v28, v29
  v_cvt_pk_bf16_f32 v211, v30, v31
  v_cvt_pk_bf16_f32 v212, v32, v33
  v_cvt_pk_bf16_f32 v213, v34, v35
  v_cvt_pk_bf16_f32 v214, v36, v37
  v_cvt_pk_bf16_f32 v215, v38, v39
  s_lshl_b32 s60, s72, 10
  s_lshl_b32 s61, s73, 21
  s_add_u32 s61, s61, s60
  s_add_u32 s61, s61, 10485760
  buffer_store_dwordx2 v[208:209], v23, s[32:35], s61 offen offset:0 sc1
  buffer_store_dwordx2 v[210:211], v23, s[32:35], s61 offen offset:512 sc1
  buffer_store_dwordx2 v[212:213], v23, s[32:35], s61 offen offset:1024 sc1
  buffer_store_dwordx2 v[214:215], v23, s[32:35], s61 offen offset:1536 sc1
  v_lshlrev_b32 v24, 16, v208
  v_and_b32 v25, 0xffff0000, v208
  v_lshlrev_b32 v26, 16, v209
  v_and_b32 v27, 0xffff0000, v209
  v_lshlrev_b32 v28, 16, v210
  v_and_b32 v29, 0xffff0000, v210
  v_lshlrev_b32 v30, 16, v211
  v_and_b32 v31, 0xffff0000, v211
  v_lshlrev_b32 v32, 16, v212
  v_and_b32 v33, 0xffff0000, v212
  v_lshlrev_b32 v34, 16, v213
  v_and_b32 v35, 0xffff0000, v213
  v_lshlrev_b32 v36, 16, v214
  v_and_b32 v37, 0xffff0000, v214
  v_lshlrev_b32 v38, 16, v215
  v_and_b32 v39, 0xffff0000, v215
  v_pk_add_f32 v[192:193], v[24:25], v[26:27]
  v_pk_add_f32 v[194:195], v[28:29], v[30:31]
  v_pk_add_f32 v[196:197], v[32:33], v[34:35]
  v_pk_add_f32 v[198:199], v[36:37], v[38:39]
  v_pk_add_f32 v[192:193], v[192:193], v[194:195]
  v_pk_add_f32 v[196:197], v[196:197], v[198:199]
  v_pk_add_f32 v[192:193], v[192:193], v[196:197]
  v_add_f32 v40, v192, v193
  s_and_b32 s61, s72, 14
  v_xor_b32 v43, s61, v19
  v_lshl_add_u32 v43, v43, 4, v22
  v_add_f32_dpp v40, v40, v40 quad_perm:[1,0,3,2] row_mask:0xf bank_mask:0xf
  s_nop 1
  v_add_f32_dpp v40, v40, v40 quad_perm:[2,3,0,1] row_mask:0xf bank_mask:0xf
  s_nop 1
  v_add_f32_dpp v40, v40, v40 row_ror:8 row_mask:0xf bank_mask:0xf
  v_mov_b32 v41, v40
  s_nop 1
  v_permlane16_swap_b32 v40, v41
  v_add_f32 v40, v40, v41
  v_mov_b32 v41, v40
  s_nop 1
  v_permlane32_swap_b32 v40, v41
  v_add_f32 v40, v40, v41
  v_mul_f32 v42, 0x3b000000, v40
  v_pk_add_f32 v[192:193], v[24:25], v[42:43] op_sel_hi:[1,0] neg_lo:[0,1] neg_hi:[0,1]
  v_pk_add_f32 v[194:195], v[26:27], v[42:43] op_sel_hi:[1,0] neg_lo:[0,1] neg_hi:[0,1]
  v_pk_add_f32 v[196:197], v[28:29], v[42:43] op_sel_hi:[1,0] neg_lo:[0,1] neg_hi:[0,1]
  v_pk_add_f32 v[198:199], v[30:31], v[42:43] op_sel_hi:[1,0] neg_lo:[0,1] neg_hi:[0,1]
  v_pk_add_f32 v[200:201], v[32:33], v[42:43] op_sel_hi:[1,0] neg_lo:[0,1] neg_hi:[0,1]
  v_pk_add_f32 v[202:203], v[34:35], v[42:43] op_sel_hi:[1,0] neg_lo:[0,1] neg_hi:[0,1]
  v_pk_add_f32 v[204:205], v[36:37], v[42:43] op_sel_hi:[1,0] neg_lo:[0,1] neg_hi:[0,1]
  v_pk_add_f32 v[206:207], v[38:39], v[42:43] op_sel_hi:[1,0] neg_lo:[0,1] neg_hi:[0,1]
  v_cvt_pk_bf16_f32 v42, v42, v42
  v_and_b32 v42, 0xffff0000, v42
  v_pk_mul_f32 v[192:193], v[192:193], v[192:193]
  v_pk_mul_f32 v[194:195], v[194:195], v[194:195]
  v_pk_fma_f32 v[192:193], v[196:197], v[196:197], v[192:193]
  v_pk_fma_f32 v[194:195], v[198:199], v[198:199], v[194:195]
  v_pk_fma_f32 v[192:193], v[200:201], v[200:201], v[192:193]
  v_pk_fma_f32 v[194:195], v[202:203], v[202:203], v[194:195]
  v_pk_fma_f32 v[192:193], v[204:205], v[204:205], v[192:193]
  v_pk_fma_f32 v[194:195], v[206:207], v[206:207], v[194:195]
  v_pk_add_f32 v[192:193], v[192:193], v[194:195]
  v_add_f32 v40, v192, v193
  v_pk_add_f32 v[24:25], v[24:25], v[42:43] op_sel_hi:[1,0] neg_lo:[0,1] neg_hi:[0,1]
  v_pk_add_f32 v[26:27], v[26:27], v[42:43] op_sel_hi:[1,0] neg_lo:[0,1] neg_hi:[0,1]
  v_pk_add_f32 v[28:29], v[28:29], v[42:43] op_sel_hi:[1,0] neg_lo:[0,1] neg_hi:[0,1]
  v_pk_add_f32 v[30:31], v[30:31], v[42:43] op_sel_hi:[1,0] neg_lo:[0,1] neg_hi:[0,1]
  v_pk_add_f32 v[32:33], v[32:33], v[42:43] op_sel_hi:[1,0] neg_lo:[0,1] neg_hi:[0,1]
  v_pk_add_f32 v[34:35], v[34:35], v[42:43] op_sel_hi:[1,0] neg_lo:[0,1] neg_hi:[0,1]
  v_pk_add_f32 v[36:37], v[36:37], v[42:43] op_sel_hi:[1,0] neg_lo:[0,1] neg_hi:[0,1]
  v_pk_add_f32 v[38:39], v[38:39], v[42:43] op_sel_hi:[1,0] neg_lo:[0,1] neg_hi:[0,1]
  v_add_f32_dpp v40, v40, v40 quad_perm:[1,0,3,2] row_mask:0xf bank_mask:0xf
  s_nop 1
  v_add_f32_dpp v40, v40, v40 quad_perm:[2,3,0,1] row_mask:0xf bank_mask:0xf
  s_nop 1
  v_add_f32_dpp v40, v40, v40 row_ror:8 row_mask:0xf bank_mask:0xf
  v_mov_b32 v41, v40
  s_nop 1
  v_permlane16_swap_b32 v40, v41
  v_add_f32 v40, v40, v41
  v_mov_b32 v41, v40
  s_nop 1
  v_permlane32_swap_b32 v40, v41
  v_add_f32 v40, v40, v41
  v_mul_f32 v40, 0x3b000000, v40
  v_cvt_pk_bf16_f32 v40, v40, v40
  v_and_b32 v40, 0xffff0000, v40
  v_add_f32 v40, 0x3727c5ac, v40
  v_cvt_pk_bf16_f32 v40, v40, v40
  v_and_b32 v40, 0xffff0000, v40
  v_sqrt_f32 v40, v40
  v_cvt_pk_bf16_f32 v192, v24, v25
  v_cvt_pk_bf16_f32 v193, v26, v27
  v_cvt_pk_bf16_f32 v194, v28, v29
  v_cvt_pk_bf16_f32 v195, v30, v31
  v_cvt_pk_bf16_f32 v196, v32, v33
  v_cvt_pk_bf16_f32 v197, v34, v35
  v_cvt_pk_bf16_f32 v198, v36, v37
  v_cvt_pk_bf16_f32 v199, v38, v39
  v_cvt_pk_bf16_f32 v40, v40, v40
  v_and_b32 v40, 0xffff0000, v40
  v_rcp_f32 v42, v40
  v_lshlrev_b32 v24, 16, v192
  v_and_b32 v25, 0xffff0000, v192
  v_lshlrev_b32 v26, 16, v193
  v_and_b32 v27, 0xffff0000, v193
  v_lshlrev_b32 v28, 16, v194
  v_and_b32 v29, 0xffff0000, v194
  v_lshlrev_b32 v30, 16, v195
  v_and_b32 v31, 0xffff0000, v195
  v_lshlrev_b32 v32, 16, v196
  v_and_b32 v33, 0xffff0000, v196
  v_lshlrev_b32 v34, 16, v197
  v_and_b32 v35, 0xffff0000, v197
  v_lshlrev_b32 v36, 16, v198
  v_and_b32 v37, 0xffff0000, v198
  v_lshlrev_b32 v38, 16, v199
  v_and_b32 v39, 0xffff0000, v199
  s_lshl_b32 s60, s72, 10
  s_and_b32 s61, s73, 1
  s_lshl_b32 s61, s61, 21
  s_add_u32 s60, s60, s61
  s_add_u32 s60, s60, 4194304
  v_pk_mul_f32 v[24:25], v[24:25], v[42:43] op_sel_hi:[1,0]
  v_pk_mul_f32 v[26:27], v[26:27], v[42:43] op_sel_hi:[1,0]
  v_cvt_pk_bf16_f32 v192, v24, v25
  v_cvt_pk_bf16_f32 v193, v26, v27
  buffer_store_dwordx2 v[192:193], v43, s[32:35], s60 offen offset:0 sc1
  v_pk_mul_f32 v[28:29], v[28:29], v[42:43] op_sel_hi:[1,0]
  v_pk_mul_f32 v[30:31], v[30:31], v[42:43] op_sel_hi:[1,0]
  v_cvt_pk_bf16_f32 v194, v28, v29
  v_cvt_pk_bf16_f32 v195, v30, v31
  buffer_store_dwordx2 v[194:195], v43, s[32:35], s60 offen offset:256 sc1
  v_pk_mul_f32 v[32:33], v[32:33], v[42:43] op_sel_hi:[1,0]
  v_pk_mul_f32 v[34:35], v[34:35], v[42:43] op_sel_hi:[1,0]
  v_cvt_pk_bf16_f32 v196, v32, v33
  v_cvt_pk_bf16_f32 v197, v34, v35
  buffer_store_dwordx2 v[196:197], v43, s[32:35], s60 offen offset:512 sc1
  v_pk_mul_f32 v[36:37], v[36:37], v[42:43] op_sel_hi:[1,0]
  v_pk_mul_f32 v[38:39], v[38:39], v[42:43] op_sel_hi:[1,0]
  v_cvt_pk_bf16_f32 v198, v36, v37
  v_cvt_pk_bf16_f32 v199, v38, v39
  buffer_store_dwordx2 v[198:199], v43, s[32:35], s60 offen offset:768 sc1
  s_lshl_b32 s89, s73, 13
  s_lshl_b32 s61, s72, 1
  s_add_u32 s89, s89, s61
  s_add_u32 s89, s89, 221952
  s_xor_b32 s70, s70, s78
  s_and_b32 s60, s70, s78
  s_cbranch_scc1 L_RED_LP0_AGAIN
  s_branch L_RED_LP0
L_RED_FIN0:
  s_waitcnt vmcnt(0)
  s_cmp_eq_u32 s89, 0
  s_cbranch_scc1 RSG_17
  v_mov_b32 v40, 1
  v_mov_b32 v41, 0
  buffer_store_dword v40, v41, s[32:35], s89 offen sc1
  s_mov_b32 s89, 0
RSG_17:
  s_branch L_END
L_RED_P1:
  v_and_b32 v3, 31, v1
  v_cmp_gt_u32 vcc, 28, v3
  v_lshlrev_b32 v3, 3, v3
  s_nop 0
  v_cndmask_b32 v3, 0, v3, vcc
  v_mov_b32 v4, 188416
  v_mov_b32 v5, 204800
  v_cndmask_b32 v4, v4, v5, s[66:67]
  v_add_u32 v8, v3, v4
  v_mov_b32 v9, 256
  v_mov_b32 v10, 1
  v_mov_b32 v11, 0
  v_lshlrev_b32 v21, 7, v1
  s_lshl_b32 s60, s76, 21
  s_lshl_b32 s61, s76, 20
  s_add_u32 s61, s61, 6291456
  s_cmp_eq_u32 s78, 1
  s_cselect_b32 s60, s61, s60
  s_mov_b32 s62, 499712
  s_cselect_b32 s62, 8192, s62
  s_mov_b32 s63, 499712
  s_cselect_b32 s63, 466944, s63
  s_lshl_b32 s61, s70, 15
  s_add_u32 s60, s60, s61
  s_add_u32 s60, s60, 184549376
  buffer_load_dword v64, v21, s[32:35], s60 offen sc1
  s_add_u32 s60, s60, 8192
  buffer_load_dword v65, v21, s[32:35], s60 offen sc1
  s_add_u32 s60, s60, 8192
  buffer_load_dword v66, v21, s[32:35], s60 offen sc1
  s_add_u32 s60, s60, 8192
  buffer_load_dword v67, v21, s[32:35], s60 offen sc1
  s_add_u32 s60, s60, s62
  buffer_load_dword v68, v21, s[32:35], s60 offen sc1
  s_add_u32 s60, s60, 8192
  buffer_load_dword v69, v21, s[32:35], s60 offen sc1
  s_add_u32 s60, s60, 8192
  buffer_load_dword v70, v21, s[32:35], s60 offen sc1
  s_add_u32 s60, s60, 8192
  buffer_load_dword v71, v21, s[32:35], s60 offen sc1
  s_add_u32 s60, s60, s63
  buffer_load_dword v72, v21, s[32:35], s60 offen sc1
  s_add_u32 s60, s60, 8192
  buffer_load_dword v73, v21, s[32:35], s60 offen sc1
  s_add_u32 s60, s60, 8192
  buffer_load_dword v74, v21, s[32:35], s60 offen sc1
  s_add_u32 s60, s60, 8192
  buffer_load_dword v75, v21, s[32:35], s60 offen sc1
  s_add_u32 s60, s60, s62
  buffer_load_dword v76, v21, s[32:35], s60 offen sc1
  s_add_u32 s60, s60, 8192
  buffer_load_dword v77, v21, s[32:35], s60 offen sc1
  s_add_u32 s60, s60, 8192
  buffer_load_dword v78, v21, s[32:35], s60 offen sc1
  s_add_u32 s60, s60, 8192
  buffer_load_dword v79, v21, s[32:35], s60 offen sc1
  s_add_u32 s60, s60, s63
L_RED_LP1:
  s_min_u32 s60, s84, s85
  s_cmp_ge_u32 s60, 64
  s_cbranch_scc1 L_RED_FIN1
  s_min_u32 s60, s84, 63
  s_min_u32 s61, s85, 63
  v_mov_b32 v12, s60
  v_mov_b32 v13, s61
  v_cndmask_b32 v12, v12, v13, s[66:67]
  v_mad_u32_u24 v13, v12, v9, v8
  v_mad_u32_u24 v14, v12, v11, v10
  buffer_load_dwordx2 v[16:17], v13, s[32:35], 0 offen sc1
PK_18:
  s_waitcnt vmcnt(0)
  v_min_u32 v12, v16, v17
  v_cmp_ge_u32 vcc, v12, v14
  s_add_u32 s61, s85, 64
  s_cmp_lt_u32 s85, 64
  s_cselect_b32 s61, s61, 255
  s_cmp_eq_u32 vcc_lo, -1
  s_cselect_b32 s61, s61, 255
  s_cmp_lt_u32 s84, 64
  s_cselect_b32 s60, s84, 255
  s_cmp_eq_u32 vcc_hi, -1
  s_cselect_b32 s60, s60, 255
  s_min_u32 s60, s60, s61
  s_mov_b32 s63, s60
  s_cmp_eq_u32 s89, 0
  s_cbranch_scc1 RSG_20
  v_mov_b32 v40, 1
  v_mov_b32 v41, 0
  buffer_store_dword v40, v41, s[32:35], s89 offen sc1
  s_mov_b32 s89, 0
RSG_20:
  s_cmp_lg_u32 s63, 255
  s_cbranch_scc1 PKG_19
  s_add_u32 s64, s64, 1
  s_cmp_lt_u32 s64, 131072
  s_cbranch_scc1 SPOK_21
  s_mov_b32 s63, 2
  s_branch L_ABORT
SPOK_21:
  s_sleep 8
  buffer_load_dwordx2 v[16:17], v13, s[32:35], 0 offen sc1
  s_branch PK_18
PKG_19:
  s_mov_b32 s64, 0
  s_lshr_b32 s86, s63, 6
  s_and_b32 s87, s63, 63
  s_cmp_eq_u32 s86, 0
  s_cselect_b32 s60, 3, 0
  s_cselect_b32 s61, 0, 3
  s_add_u32 s84, s84, s60
  s_add_u32 s85, s85, s61
  s_cmp_ge_u32 s85, 48
  s_cselect_b32 s60, s78, 0
  s_lshl_b32 s60, s60, 7
  s_or_b32 s85, s85, s60
L_RED_LP1_AGAIN:
  s_mov_b32 s91, s86
  s_mov_b32 s92, s87
  s_lshl_b32 s72, s92, 5
  s_lshl_b32 s60, s70, 1
  s_add_u32 s72, s72, s60
  s_mul_i32 s74, s92, 43
  s_bfe_u32 s74, s74, 0x20007
  s_lshl_b32 s60, s76, 2
  s_add_u32 s74, s74, s60
  s_lshl_b32 s60, s76, 1
  s_add_u32 s60, s60, 12
  s_bitcmp1_b32 s74, 0
  s_addc_u32 s60, s60, 0
  s_cmp_ge_u32 s92, 52
  s_cselect_b32 s60, s74, s60
  s_cmp_eq_u32 s91, 0
  s_cselect_b32 s74, s74, s60
  s_lshl_b32 s74, s74, 19
  s_add_u32 s74, s74, 184549376
  s_lshl_b32 s60, s70, 15
  s_add_u32 s74, s74, s60
  s_lshl_b32 s73, s91, 1
  s_add_u32 s73, s73, 2
  s_lshl_b32 s60, s72, 10
  buffer_load_dwordx4 v[64:67], v2, s[32:35], s74 offen offset:0 sc1
  buffer_load_dwordx4 v[68:71], v2, s[32:35], s74 offen offset:1024 sc1
  buffer_load_dwordx4 v[72:75], v2, s[32:35], s74 offen offset:2048 sc1
  buffer_load_dwordx4 v[76:79], v2, s[32:35], s74 offen offset:3072 sc1
  s_add_u32 s74, s74, 4096
  buffer_load_dwordx4 v[80:83], v2, s[32:35], s74 offen offset:0 sc1
  buffer_load_dwordx4 v[84:87], v2, s[32:35], s74 offen offset:1024 sc1
  buffer_load_dwordx4 v[88:91], v2, s[32:35], s74 offen offset:2048 sc1
  buffer_load_dwordx4 v[92:95], v2, s[32:35], s74 offen offset:3072 sc1
  s_add_u32 s74, s74, 4096
  buffer_load_dwordx4 v[96:99], v2, s[32:35], s74 offen offset:0 sc1
  buffer_load_dwordx4 v[100:103], v2, s[32:35], s74 offen offset:1024 sc1
  buffer_load_dwordx4 v[104:107], v2, s[32:35], s74 offen offset:2048 sc1
  buffer_load_dwordx4 v[108:111], v2, s[32:35], s74 offen offset:3072 sc1
  s_add_u32 s74, s74, 4096
  buffer_load_dwordx4 v[112:115], v2, s[32:35], s74 offen offset:0 sc1
  s_waitcnt vmcnt(12)
  s_cmp_eq_u32 s89, 0
  s_cbranch_scc1 RSG_22
  v_mov_b32 v40, 1
  v_mov_b32 v41, 0
  buffer_store_dword v40, v41, s[32:35], s89 offen sc1
  s_mov_b32 s89, 0
RSG_22:
  s_lshl_b32 s60, s72, 10
  v_mfma_f32_16x16x32_bf16 v[24:27], v[48:51], v[64:67], 0
  v_mfma_f32_16x16x32_bf16 v[28:31], v[52:55], v[64:67], 0
  buffer_load_dwordx4 v[116:119], v2, s[32:35], s74 offen offset:1024 sc1
  s_waitcnt vmcnt(12)
  v_mfma_f32_16x16x32_bf16 v[32:35], v[48:51], v[68:71], 0
  v_mfma_f32_16x16x32_bf16 v[36:39], v[52:55], v[68:71], 0
  buffer_load_dwordx4 v[120:123], v2, s[32:35], s74 offen offset:2048 sc1
  s_waitcnt vmcnt(12)
  v_mfma_f32_16x16x32_bf16 v[24:27], v[48:51], v[72:75], v[24:27]
  v_mfma_f32_16x16x32_bf16 v[28:31], v[52:55], v[72:75], v[28:31]
  buffer_load_dwordx4 v[124:127], v2, s[32:35], s74 offen offset:3072 sc1
  s_add_u32 s74, s74, 4096
  s_waitcnt vmcnt(12)
  v_mfma_f32_16x16x32_bf16 v[32:35], v[48:51], v[76:79], v[32:35]
  v_mfma_f32_16x16x32_bf16 v[36:39], v[52:55], v[76:79], v[36:39]
  buffer_load_dwordx4 v[128:131], v2, s[32:35], s74 offen offset:0 sc1
  s_waitcnt vmcnt(12)
  v_mfma_f32_16x16x32_bf16 v[24:27], v[48:51], v[80:83], v[24:27]
  v_mfma_f32_16x16x32_bf16 v[28:31], v[52:55], v[80:83], v[28:31]
  buffer_load_dwordx4 v[132:135], v2, s[32:35], s74 offen offset:1024 sc1
  s_waitcnt vmcnt(12)
  v_mfma_f32_16x16x32_bf16 v[32:35], v[48:51], v[84:87], v[32:35]
  v_mfma_f32_16x16x32_bf16 v[36:39], v[52:55], v[84:87], v[36:39]
  buffer_load_dwordx4 v[136:139], v2, s[32:35], s74 offen offset:2048 sc1
  s_waitcnt vmcnt(12)
  v_mfma_f32_16x16x32_bf16 v[24:27], v[48:51], v[88:91], v[24:27]
  v_mfma_f32_16x16x32_bf16 v[28:31], v[52:55], v[88:91], v[28:31]
  buffer_load_dwordx4 v[140:143], v2, s[32:35], s74 offen offset:3072 sc1
  s_add_u32 s74, s74, 4096
  s_waitcnt vmcnt(12)
  v_mfma_f32_16x16x32_bf16 v[32:35], v[48:51], v[92:95], v[32:35]
  v_mfma_f32_16x16x32_bf16 v[36:39], v[52:55], v[92:95], v[36:39]
  buffer_load_dwordx4 v[144:147], v2, s[32:35], s74 offen offset:0 sc1
  s_waitcnt vmcnt(12)
  v_mfma_f32_16x16x32_bf16 v[24:27], v[48:51], v[96:99], v[24:27]
  v_mfma_f32_16x16x32_bf16 v[28:31], v[52:55], v[96:99], v[28:31]
  buffer_load_dwordx4 v[148:151], v2, s[32:35], s74 offen offset:1024 sc1
  s_waitcnt vmcnt(12)
  v_mfma_f32_16x16x32_bf16 v[32:35], v[48:51], v[100:103], v[32:35]
  v_mfma_f32_16x16x32_bf16 v[36:39], v[52:55], v[100:103], v[36:39]
  buffer_load_dwordx4 v[152:155], v2, s[32:35], s74 offen offset:2048 sc1
  s_waitcnt vmcnt(12)
  v_mfma_f32_16x16x32_bf16 v[24:27], v[48:51], v[104:107], v[24:27]
  v_mfma_f32_16x16x32_bf16 v[28:31], v[52:55], v[104:107], v[28:31]
  buffer_load_dwordx4 v[156:159], v2, s[32:35], s74 offen offset:3072 sc1
  s_add_u32 s74, s74, 4096
  s_waitcnt vmcnt(12)
  v_mfma_f32_16x16x32_bf16 v[32:35], v[48:51], v[108:111], v[32:35]
  v_mfma_f32_16x16x32_bf16 v[36:39], v[52:55], v[108:111], v[36:39]
  buffer_load_dwordx4 v[160:163], v2, s[32:35], s74 offen offset:0 sc1
  s_waitcnt vmcnt(12)
  v_mfma_f32_16x16x32_bf16 v[24:27], v[48:51], v[112:115], v[24:27]
  v_mfma_f32_16x16x32_bf16 v[28:31], v[52:55], v[112:115], v[28:31]
  buffer_load_dwordx4 v[164:167], v2, s[32:35], s74 offen offset:1024 sc1
  s_waitcnt vmcnt(12)
  v_mfma_f32_16x16x32_bf16 v[32:35], v[48:51], v[116:119], v[32:35]
  v_mfma_f32_16x16x32_bf16 v[36:39], v[52:55], v[116:119], v[36:39]
  buffer_load_dwordx4 v[168:171], v2, s[32:35], s74 offen offset:2048 sc1
  s_waitcnt vmcnt(12)
  v_mfma_f32_16x16x32_bf16 v[24:27], v[48:51], v[120:123], v[24:27]
  v_mfma_f32_16x16x32_bf16 v[28:31], v[52:55], v[120:123], v[28:31]
  buffer_load_dwordx4 v[172:175], v2, s[32:35], s74 offen offset:3072 sc1
  s_waitcnt vmcnt(12)
  v_mfma_f32_16x16x32_bf16 v[32:35], v[48:51], v[124:127], v[32:35]
  v_mfma_f32_16x16x32_bf16 v[36:39], v[52:55], v[124:127], v[36:39]
RXR_23:
  s_lshl_b32 s61, s73, 21
  s_add_u32 s61, s61, s60
  s_add_u32 s61, s61, 8388608
  buffer_load_dwordx2 v[56:57], v23, s[32:35], s61 offen offset:0 sc1
  buffer_load_dwordx2 v[58:59], v23, s[32:35], s61 offen offset:512 sc1
  buffer_load_dwordx2 v[60:61], v23, s[32:35], s61 offen offset:1024 sc1
  buffer_load_dwordx2 v[62:63], v23, s[32:35], s61 offen offset:1536 sc1
RXD_24:
  s_waitcnt vmcnt(15)
  v_mfma_f32_16x16x32_bf16 v[24:27], v[48:51], v[128:131], v[24:27]
  v_mfma_f32_16x16x32_bf16 v[28:31], v[52:55], v[128:131], v[28:31]
  s_waitcnt vmcnt(14)
  v_mfma_f32_16x16x32_bf16 v[32:35], v[48:51], v[132:135], v[32:35]
  v_mfma_f32_16x16x32_bf16 v[36:39], v[52:55], v[132:135], v[36:39]
  s_waitcnt vmcnt(13)
  v_mfma_f32_16x16x32_bf16 v[24:27], v[48:51], v[136:139], v[24:27]
  v_mfma_f32_16x16x32_bf16 v[28:31], v[52:55], v[136:139], v[28:31]
  s_waitcnt vmcnt(12)
  v_mfma_f32_16x16x32_bf16 v[32:35], v[48:51], v[140:143], v[32:35]
  v_mfma_f32_16x16x32_bf16 v[36:39], v[52:55], v[140:143], v[36:39]
  s_waitcnt vmcnt(11)
  v_mfma_f32_16x16x32_bf16 v[24:27], v[48:51], v[144:147], v[24:27]
  v_mfma_f32_16x16x32_bf16 v[28:31], v[52:55], v[144:147], v[28:31]
  s_waitcnt vmcnt(10)
  v_mfma_f32_16x16x32_bf16 v[32:35], v[48:51], v[148:151], v[32:35]
  v_mfma_f32_16x16x32_bf16 v[36:39], v[52:55], v[148:151], v[36:39]
  s_waitcnt vmcnt(9)
  v_mfma_f32_16x16x32_bf16 v[24:27], v[48:51], v[152:155], v[24:27]
  v_mfma_f32_16x16x32_bf16 v[28:31], v[52:55], v[152:155], v[28:31]
  s_waitcnt vmcnt(8)
  v_mfma_f32_16x16x32_bf16 v[32:35], v[48:51], v[156:159], v[32:35]
  v_mfma_f32_16x16x32_bf16 v[36:39], v[52:55], v[156:159], v[36:39]
  s_waitcnt vmcnt(7)
  v_mfma_f32_16x16x32_bf16 v[24:27], v[48:51], v[160:163], v[24:27]
  v_mfma_f32_16x16x32_bf16 v[28:31], v[52:55], v[160:163], v[28:31]
  s_waitcnt vmcnt(6)
  v_mfma_f32_16x16x32_bf16 v[32:35], v[48:51], v[164:167], v[32:35]
  v_mfma_f32_16x16x32_bf16 v[36:39], v[52:55], v[164:167], v[36:39]
  s_waitcnt vmcnt(5)
  v_mfma_f32_16x16x32_bf16 v[24:27], v[48:51], v[168:171], v[24:27]
  v_mfma_f32_16x16x32_bf16 v[28:31], v[52:55], v[168:171], v[28:31]
  s_waitcnt vmcnt(4)
  v_mfma_f32_16x16x32_bf16 v[32:35], v[48:51], v[172:175], v[32:35]
  v_mfma_f32_16x16x32_bf16 v[36:39], v[52:55], v[172:175], v[36:39]
  s_waitcnt vmcnt(0)
  v_lshlrev_b32 v192, 16, v56
  v_and_b32 v193, 0xffff0000, v56
  v_lshlrev_b32 v194, 16, v57
  v_and_b32 v195, 0xffff0000, v57
  v_lshlrev_b32 v196, 16, v58
  v_and_b32 v197, 0xffff0000, v58
  v_lshlrev_b32 v198, 16, v59
  v_and_b32 v199, 0xffff0000, v59
  v_lshlrev_b32 v200, 16, v60
  v_and_b32 v201, 0xffff0000, v60
  v_lshlrev_b32 v202, 16, v61
  v_and_b32 v203, 0xffff0000, v61
  v_lshlrev_b32 v204, 16, v62
  v_and_b32 v205, 0xffff0000, v62
  v_lshlrev_b32 v206, 16, v63
  v_and_b32 v207, 0xffff0000, v63
  v_cvt_pk_bf16_f32 v208, v24, v25
  v_cvt_pk_bf16_f32 v209, v26, v27
  v_cvt_pk_bf16_f32 v210, v28, v29
  v_cvt_pk_bf16_f32 v211, v30, v31
  v_cvt_pk_bf16_f32 v212, v32, v33
  v_cvt_pk_bf16_f32 v213, v34, v35
  v_cvt_pk_bf16_f32 v214, v36, v37
  v_cvt_pk_bf16_f32 v215, v38, v39
  v_lshlrev_b32 v24, 16, v208
  v_and_b32 v25, 0xffff0000, v208
  v_lshlrev_b32 v26, 16, v209
  v_and_b32 v27, 0xffff0000, v209
  v_lshlrev_b32 v28, 16, v210
  v_and_b32 v29, 0xffff0000, v210
  v_lshlrev_b32 v30, 16, v211
  v_and_b32 v31, 0xffff0000, v211
  v_lshlrev_b32 v32, 16, v212
  v_and_b32 v33, 0xffff0000, v212
  v_lshlrev_b32 v34, 16, v213
  v_and_b32 v35, 0xffff0000, v213
  v_lshlrev_b32 v36, 16, v214
  v_and_b32 v37, 0xffff0000, v214
  v_lshlrev_b32 v38, 16, v215
  v_and_b32 v39, 0xffff0000, v215
  v_pk_add_f32 v[24:25], v[24:25], v[192:193]
  v_pk_add_f32 v[26:27], v[26:27], v[194:195]
  v_pk_add_f32 v[28:29], v[28:29], v[196:197]
  v_pk_add_f32 v[30:31], v[30:31], v[198:199]
  v_pk_add_f32 v[32:33], v[32:33], v[200:201]
  v_pk_add_f32 v[34:35], v[34:35], v[202:203]
  v_pk_add_f32 v[36:37], v[36:37], v[204:205]
  v_pk_add_f32 v[38:39], v[38:39], v[206:207]
  v_cvt_pk_bf16_f32 v208, v24, v25
  v_cvt_pk_bf16_f32 v209, v26, v27
  v_cvt_pk_bf16_f32 v210, v28, v29
  v_cvt_pk_bf16_f32 v211, v30, v31
  v_cvt_pk_bf16_f32 v212, v32, v33
  v_cvt_pk_bf16_f32 v213, v34, v35
  v_cvt_pk_bf16_f32 v214, v36, v37
  v_cvt_pk_bf16_f32 v215, v38, v39
  s_lshl_b32 s60, s72, 10
  s_cmp_lg_u32 s91, 1
  s_cbranch_scc1 RNL_25
  buffer_store_dwordx2 v[208:209], v18, s[44:47], s60 offen offset:0
  buffer_store_dwordx2 v[210:211], v18, s[44:47], s60 offen offset:256
  buffer_store_dwordx2 v[212:213], v18, s[44:47], s60 offen offset:512
  buffer_store_dwordx2 v[214:215], v18, s[44:47], s60 offen offset:768
  s_lshl_b32 s89, s73, 13
  s_lshl_b32 s61, s72, 1
  s_add_u32 s89, s89, s61
  s_add_u32 s89, s89, 221952
  s_xor_b32 s70, s70, s78
  s_and_b32 s60, s70, s78
  s_cbranch_scc1 L_RED_LP1_AGAIN
  s_branch L_RED_LP1
RNL_25:
  s_lshl_b32 s61, s73, 21
  s_add_u32 s61, s61, s60
  s_add_u32 s61, s61, 10485760
  buffer_store_dwordx2 v[208:209], v23, s[32:35], s61 offen offset:0 sc1
  buffer_store_dwordx2 v[210:211], v23, s[32:35], s61 offen offset:512 sc1
  buffer_store_dwordx2 v[212:213], v23, s[32:35], s61 offen offset:1024 sc1
  buffer_store_dwordx2 v[214:215], v23, s[32:35], s61 offen offset:1536 sc1
  v_lshlrev_b32 v24, 16, v208
  v_and_b32 v25, 0xffff0000, v208
  v_lshlrev_b32 v26, 16, v209
  v_and_b32 v27, 0xffff0000, v209
  v_lshlrev_b32 v28, 16, v210
  v_and_b32 v29, 0xffff0000, v210
  v_lshlrev_b32 v30, 16, v211
  v_and_b32 v31, 0xffff0000, v211
  v_lshlrev_b32 v32, 16, v212
  v_and_b32 v33, 0xffff0000, v212
  v_lshlrev_b32 v34, 16, v213
  v_and_b32 v35, 0xffff0000, v213
  v_lshlrev_b32 v36, 16, v214
  v_and_b32 v37, 0xffff0000, v214
  v_lshlrev_b32 v38, 16, v215
  v_and_b32 v39, 0xffff0000, v215
  v_pk_add_f32 v[192:193], v[24:25], v[26:27]
  v_pk_add_f32 v[194:195], v[28:29], v[30:31]
  v_pk_add_f32 v[196:197], v[32:33], v[34:35]
  v_pk_add_f32 v[198:199], v[36:37], v[38:39]
  v_pk_add_f32 v[192:193], v[192:193], v[194:195]
  v_pk_add_f32 v[196:197], v[196:197], v[198:199]
  v_pk_add_f32 v[192:193], v[192:193], v[196:197]
  v_add_f32 v40, v192, v193
  s_and_b32 s61, s72, 14
  v_xor_b32 v43, s61, v19
  v_lshl_add_u32 v43, v43, 4, v22
  v_add_f32_dpp v40, v40, v40 quad_perm:[1,0,3,2] row_mask:0xf bank_mask:0xf
  s_nop 1
  v_add_f32_dpp v40, v40, v40 quad_perm:[2,3,0,1] row_mask:0xf bank_mask:0xf
  s_nop 1
  v_add_f32_dpp v40, v40, v40 row_ror:8 row_mask:0xf bank_mask:0xf
  v_mov_b32 v41, v40
  s_nop 1
  v_permlane16_swap_b32 v40, v41
  v_add_f32 v40, v40, v41
  v_mov_b32 v41, v40
  s_nop 1
  v_permlane32_swap_b32 v40, v41
  v_add_f32 v40, v40, v41
  v_mul_f32 v42, 0x3b000000, v40
  v_pk_add_f32 v[192:193], v[24:25], v[42:43] op_sel_hi:[1,0] neg_lo:[0,1] neg_hi:[0,1]
  v_pk_add_f32 v[194:195], v[26:27], v[42:43] op_sel_hi:[1,0] neg_lo:[0,1] neg_hi:[0,1]
  v_pk_add_f32 v[196:197], v[28:29], v[42:43] op_sel_hi:[1,0] neg_lo:[0,1] neg_hi:[0,1]
  v_pk_add_f32 v[198:199], v[30:31], v[42:43] op_sel_hi:[1,0] neg_lo:[0,1] neg_hi:[0,1]
  v_pk_add_f32 v[200:201], v[32:33], v[42:43] op_sel_hi:[1,0] neg_lo:[0,1] neg_hi:[0,1]
  v_pk_add_f32 v[202:203], v[34:35], v[42:43] op_sel_hi:[1,0] neg_lo:[0,1] neg_hi:[0,1]
  v_pk_add_f32 v[204:205], v[36:37], v[42:43] op_sel_hi:[1,0] neg_lo:[0,1] neg_hi:[0,1]
  v_pk_add_f32 v[206:207], v[38:39], v[42:43] op_sel_hi:[1,0] neg_lo:[0,1] neg_hi:[0,1]
  v_cvt_pk_bf16_f32 v42, v42, v42
  v_and_b32 v42, 0xffff0000, v42
  v_pk_mul_f32 v[192:193], v[192:193], v[192:193]
  v_pk_mul_f32 v[194:195], v[194:195], v[194:195]
  v_pk_fma_f32 v[192:193], v[196:197], v[196:197], v[192:193]
  v_pk_fma_f32 v[194:195], v[198:199], v[198:199], v[194:195]
  v_pk_fma_f32 v[192:193], v[200:201], v[200:201], v[192:193]
  v_pk_fma_f32 v[194:195], v[202:203], v[202:203], v[194:195]
  v_pk_fma_f32 v[192:193], v[204:205], v[204:205], v[192:193]
  v_pk_fma_f32 v[194:195], v[206:207], v[206:207], v[194:195]
  v_pk_add_f32 v[192:193], v[192:193], v[194:195]
  v_add_f32 v40, v192, v193
  v_pk_add_f32 v[24:25], v[24:25], v[42:43] op_sel_hi:[1,0] neg_lo:[0,1] neg_hi:[0,1]
  v_pk_add_f32 v[26:27], v[26:27], v[42:43] op_sel_hi:[1,0] neg_lo:[0,1] neg_hi:[0,1]
  v_pk_add_f32 v[28:29], v[28:29], v[42:43] op_sel_hi:[1,0] neg_lo:[0,1] neg_hi:[0,1]
  v_pk_add_f32 v[30:31], v[30:31], v[42:43] op_sel_hi:[1,0] neg_lo:[0,1] neg_hi:[0,1]
  v_pk_add_f32 v[32:33], v[32:33], v[42:43] op_sel_hi:[1,0] neg_lo:[0,1] neg_hi:[0,1]
  v_pk_add_f32 v[34:35], v[34:35], v[42:43] op_sel_hi:[1,0] neg_lo:[0,1] neg_hi:[0,1]
  v_pk_add_f32 v[36:37], v[36:37], v[42:43] op_sel_hi:[1,0] neg_lo:[0,1] neg_hi:[0,1]
  v_pk_add_f32 v[38:39], v[38:39], v[42:43] op_sel_hi:[1,0] neg_lo:[0,1] neg_hi:[0,1]
  v_add_f32_dpp v40, v40, v40 quad_perm:[1,0,3,2] row_mask:0xf bank_mask:0xf
  s_nop 1
  v_add_f32_dpp v40, v40, v40 quad_perm:[2,3,0,1] row_mask:0xf bank_mask:0xf
  s_nop 1
  v_add_f32_dpp v40, v40, v40 row_ror:8 row_mask:0xf bank_mask:0xf
  v_mov_b32 v41, v40
  s_nop 1
  v_permlane16_swap_b32 v40, v41
  v_add_f32 v40, v40, v41
  v_mov_b32 v41, v40
  s_nop 1
  v_permlane32_swap_b32 v40, v41
  v_add_f32 v40, v40, v41
  v_mul_f32 v40, 0x3b000000, v40
  v_cvt_pk_bf16_f32 v40, v40, v40
  v_and_b32 v40, 0xffff0000, v40
  v_add_f32 v40, 0x3727c5ac, v40
  v_cvt_pk_bf16_f32 v40, v40, v40
  v_and_b32 v40, 0xffff0000, v40
  v_sqrt_f32 v40, v40
  v_cvt_pk_bf16_f32 v192, v24, v25
  v_cvt_pk_bf16_f32 v193, v26, v27
  v_cvt_pk_bf16_f32 v194, v28, v29
  v_cvt_pk_bf16_f32 v195, v30, v31
  v_cvt_pk_bf16_f32 v196, v32, v33
  v_cvt_pk_bf16_f32 v197, v34, v35
  v_cvt_pk_bf16_f32 v198, v36, v37
  v_cvt_pk_bf16_f32 v199, v38, v39
  v_cvt_pk_bf16_f32 v40, v40, v40
  v_and_b32 v40, 0xffff0000, v40
  v_rcp_f32 v42, v40
  v_lshlrev_b32 v24, 16, v192
  v_and_b32 v25, 0xffff0000, v192
  v_lshlrev_b32 v26, 16, v193
  v_and_b32 v27, 0xffff0000, v193
  v_lshlrev_b32 v28, 16, v194
  v_and_b32 v29, 0xffff0000, v194
  v_lshlrev_b32 v30, 16, v195
  v_and_b32 v31, 0xffff0000, v195
  v_lshlrev_b32 v32, 16, v196
  v_and_b32 v33, 0xffff0000, v196
  v_lshlrev_b32 v34, 16, v197
  v_and_b32 v35, 0xffff0000, v197
  v_lshlrev_b32 v36, 16, v198
  v_and_b32 v37, 0xffff0000, v198
  v_lshlrev_b32 v38, 16, v199
  v_and_b32 v39, 0xffff0000, v199
  s_lshl_b32 s60, s72, 10
  s_and_b32 s61, s73, 1
  s_lshl_b32 s61, s61, 21
  s_add_u32 s60, s60, s61
  s_add_u32 s60, s60, 4194304
  v_pk_mul_f32 v[24:25], v[24:25], v[42:43] op_sel_hi:[1,0]
  v_pk_mul_f32 v[26:27], v[26:27], v[42:43] op_sel_hi:[1,0]
  v_cvt_pk_bf16_f32 v192, v24, v25
  v_cvt_pk_bf16_f32 v193, v26, v27
  buffer_store_dwordx2 v[192:193], v43, s[32:35], s60 offen offset:0 sc1
  v_pk_mul_f32 v[28:29], v[28:29], v[42:43] op_sel_hi:[1,0]
  v_pk_mul_f32 v[30:31], v[30:31], v[42:43] op_sel_hi:[1,0]
  v_cvt_pk_bf16_f32 v194, v28, v29
  v_cvt_pk_bf16_f32 v195, v30, v31
  buffer_store_dwordx2 v[194:195], v43, s[32:35], s60 offen offset:256 sc1
  v_pk_mul_f32 v[32:33], v[32:33], v[42:43] op_sel_hi:[1,0]
  v_pk_mul_f32 v[34:35], v[34:35], v[42:43] op_sel_hi:[1,0]
  v_cvt_pk_bf16_f32 v196, v32, v33
  v_cvt_pk_bf16_f32 v197, v34, v35
  buffer_store_dwordx2 v[196:197], v43, s[32:35], s60 offen offset:512 sc1
  v_pk_mul_f32 v[36:37], v[36:37], v[42:43] op_sel_hi:[1,0]
  v_pk_mul_f32 v[38:39], v[38:39], v[42:43] op_sel_hi:[1,0]
  v_cvt_pk_bf16_f32 v198, v36, v37
  v_cvt_pk_bf16_f32 v199, v38, v39
  buffer_store_dwordx2 v[198:199], v43, s[32:35], s60 offen offset:768 sc1
  s_lshl_b32 s89, s73, 13
  s_lshl_b32 s61, s72, 1
  s_add_u32 s89, s89, s61
  s_add_u32 s89, s89, 221952
  s_xor_b32 s70, s70, s78
  s_and_b32 s60, s70, s78
  s_cbranch_scc1 L_RED_LP1_AGAIN
  s_branch L_RED_LP1
L_RED_FIN1:
  s_waitcnt vmcnt(0)
  s_cmp_eq_u32 s89, 0
  s_cbranch_scc1 RSG_26
  v_mov_b32 v40, 1
  v_mov_b32 v41, 0
  buffer_store_dword v40, v41, s[32:35], s89 offen sc1
  s_mov_b32 s89, 0
RSG_26:
  s_branch L_END
L_QKV:
  s_sub_u32 s70, s57, 64
  s_lshr_b32 s71, s70, 5
  s_and_b32 s70, s70, 31
  s_cmp_lg_u32 s56, 0
  s_cbranch_scc1 IA_27
  s_waitcnt vmcnt(0)
  s_mov_b64 exec, 1
  v_mov_b32 v30, 1
  v_mov_b32 v31, 12
  buffer_atomic_add v30, v31, s[36:39], 0 offen
  s_mov_b64 exec, -1
IA_27:
  s_mov_b32 s40, s10
  s_and_b32 s41, s11, 0xffff
  s_mov_b32 s42, 4194304
  s_mov_b32 s43, 0x20000
  s_mov_b32 s44, s12
  s_and_b32 s45, s13, 0xffff
  s_mov_b32 s46, 4194304
  s_mov_b32 s47, 0x20000
  s_mov_b32 s48, s8
  s_and_b32 s49, s9, 0xffff
  s_mov_b32 s50, 4194304
  s_mov_b32 s51, 0x20000
  s_lshl_b32 s74, s70, 8
  s_lshl_b32 s60, s56, 18
  s_add_u32 s74, s74, s60
  v_lshrrev_b32 v3, 4, v1
  v_bfe_u32 v4, v1, 2, 2
  v_lshl_add_u32 v3, v3, 3, v4
  v_lshlrev_b32 v3, 8, v3
  v_and_b32 v5, 3, v1
  v_lshl_add_u32 v3, v5, 4, v3
  v_xor_b32 v4, s56, v4
  v_lshl_add_u32 v8, v4, 6, v3
  v_add_u32 v9, 0x10000, v8
  s_mov_b32 s73, 8192
  v_lshrrev_b32 v3, 4, v1
  v_mul_lo_u32 v16, v3, s73
  v_lshlrev_b32 v3, 2, v3
  v_and_b32 v4, 15, v1
  v_xor_b32 v3, v3, v4
  v_lshl_add_u32 v16, v3, 4, v16
  s_lshl_b32 s73, s56, 13
  s_add_u32 m0, s73, 65536
  s_add_u32 s73, s74, 0
  buffer_load_dwordx4 v16, s[40:43], s73 offen lds
  s_add_u32 m0, m0, 1024
  s_add_u32 s73, s73, 32768
  buffer_load_dwordx4 v16, s[40:43], s73 offen lds
  s_add_u32 m0, m0, 1024
  s_add_u32 s73, s73, 32768
  buffer_load_dwordx4 v16, s[40:43], s73 offen lds
  s_add_u32 m0, m0, 1024
  s_add_u32 s73, s73, 32768
  buffer_load_dwordx4 v16, s[40:43], s73 offen lds
  s_add_u32 m0, m0, 1024
  s_add_u32 s73, s73, 32768
  buffer_load_dwordx4 v16, s[40:43], s73 offen lds
  s_add_u32 m0, m0, 1024
  s_add_u32 s73, s73, 32768
  buffer_load_dwordx4 v16, s[40:43], s73 offen lds
  s_add_u32 m0, m0, 1024
  s_add_u32 s73, s73, 32768
  buffer_load_dwordx4 v16, s[40:43], s73 offen lds
  s_add_u32 m0, m0, 1024
  s_add_u32 s73, s73, 32768
  buffer_load_dwordx4 v16, s[40:43], s73 offen lds
  s_lshl_b32 s73, s56, 13
  s_add_u32 m0, s73, 98304
  s_add_u32 s73, s74, 1048576
  buffer_load_dwordx4 v16, s[40:43], s73 offen lds
  s_add_u32 m0, m0, 1024
  s_add_u32 s73, s73, 32768
  buffer_load_dwordx4 v16, s[40:43], s73 offen lds
  s_add_u32 m0, m0, 1024
  s_add_u32 s73, s73, 32768
  buffer_load_dwordx4 v16, s[40:43], s73 offen lds
  s_add_u32 m0, m0, 1024
  s_add_u32 s73, s73, 32768
  buffer_load_dwordx4 v16, s[40:43], s73 offen lds
  s_add_u32 m0, m0, 1024
  s_add_u32 s73, s73, 32768
  buffer_load_dwordx4 v16, s[40:43], s73 offen lds
  s_add_u32 m0, m0, 1024
  s_add_u32 s73, s73, 32768
  buffer_load_dwordx4 v16, s[40:43], s73 offen lds
  s_add_u32 m0, m0, 1024
  s_add_u32 s73, s73, 32768
  buffer_load_dwordx4 v16, s[40:43], s73 offen lds
  s_add_u32 m0, m0, 1024
  s_add_u32 s73, s73, 32768
  buffer_load_dwordx4 v16, s[40:43], s73 offen lds
  s_lshl_b32 s73, s56, 13
  s_add_u32 m0, s73, 131072
  s_add_u32 s73, s74, 2097152
  buffer_load_dwordx4 v16, s[40:43], s73 offen lds
  s_add_u32 m0, m0, 1024
  s_add_u32 s73, s73, 32768
  buffer_load_dwordx4 v16, s[40:43], s73 offen lds
  s_add_u32 m0, m0, 1024
  s_add_u32 s73, s73, 32768
  buffer_load_dwordx4 v16, s[40:43], s73 offen lds
  s_add_u32 m0, m0, 1024
  s_add_u32 s73, s73, 32768
  buffer_load_dwordx4 v16, s[40:43], s73 offen lds
  s_add_u32 m0, m0, 1024
  s_add_u32 s73, s73, 32768
  buffer_load_dwordx4 v16, s[40:43], s73 offen lds
  s_add_u32 m0, m0, 1024
  s_add_u32 s73, s73, 32768
  buffer_load_dwordx4 v16, s[40:43], s73 offen lds
  s_add_u32 m0, m0, 1024
  s_add_u32 s73, s73, 32768
  buffer_load_dwordx4 v16, s[40:43], s73 offen lds
  s_add_u32 m0, m0, 1024
  s_add_u32 s73, s73, 32768
  buffer_load_dwordx4 v16, s[40:43], s73 offen lds
  s_lshl_b32 s73, s56, 13
  s_add_u32 m0, s73, 0
  s_add_u32 s73, s74, 3145728
  buffer_load_dwordx4 v16, s[40:43], s73 offen lds
  s_add_u32 m0, m0, 1024
  s_add_u32 s73, s73, 32768
  buffer_load_dwordx4 v16, s[40:43], s73 offen lds
  s_add_u32 m0, m0, 1024
  s_add_u32 s73, s73, 32768
  buffer_load_dwordx4 v16, s[40:43], s73 offen lds
  s_add_u32 m0, m0, 1024
  s_add_u32 s73, s73, 32768
  buffer_load_dwordx4 v16, s[40:43], s73 offen lds
  s_add_u32 m0, m0, 1024
  s_add_u32 s73, s73, 32768
  buffer_load_dwordx4 v16, s[40:43], s73 offen lds
  s_add_u32 m0, m0, 1024
  s_add_u32 s73, s73, 32768
  buffer_load_dwordx4 v16, s[40:43], s73 offen lds
  s_add_u32 m0, m0, 1024
  s_add_u32 s73, s73, 32768
  buffer_load_dwordx4 v16, s[40:43], s73 offen lds
  s_add_u32 m0, m0, 1024
  s_add_u32 s73, s73, 32768
  buffer_load_dwordx4 v16, s[40:43], s73 offen lds
  s_lshl_b32 s73, s56, 13
  s_add_u32 m0, s73, 32768
  s_add_u32 s73, s74, 0
  buffer_load_dwordx4 v16, s[44:47], s73 offen lds
  s_add_u32 m0, m0, 1024
  s_add_u32 s73, s73, 32768
  buffer_load_dwordx4 v16, s[44:47], s73 offen lds
  s_add_u32 m0, m0, 1024
  s_add_u32 s73, s73, 32768
  buffer_load_dwordx4 v16, s[44:47], s73 offen lds
  s_add_u32 m0, m0, 1024
  s_add_u32 s73, s73, 32768
  buffer_load_dwordx4 v16, s[44:47], s73 offen lds
  s_add_u32 m0, m0, 1024
  s_add_u32 s73, s73, 32768
  buffer_load_dwordx4 v16, s[44:47], s73 offen lds
  s_add_u32 m0, m0, 1024
  s_add_u32 s73, s73, 32768
  buffer_load_dwordx4 v16, s[44:47], s73 offen lds
  s_add_u32 m0, m0, 1024
  s_add_u32 s73, s73, 32768
  buffer_load_dwordx4 v16, s[44:47], s73 offen lds
  s_add_u32 m0, m0, 1024
  s_add_u32 s73, s73, 32768
  buffer_load_dwordx4 v16, s[44:47], s73 offen lds
  s_waitcnt vmcnt(32)
  s_barrier
  ds_read_b64_tr_b16 a[0:1], v9 offset:0
  ds_read_b64_tr_b16 a[2:3], v9 offset:1024
  ds_read_b64_tr_b16 a[64:65], v9 offset:8
  ds_read_b64_tr_b16 a[66:67], v9 offset:1032
  ds_read_b64_tr_b16 a[4:5], v9 offset:8192
  ds_read_b64_tr_b16 a[6:7], v9 offset:9216
  ds_read_b64_tr_b16 a[68:69], v9 offset:8200
  ds_read_b64_tr_b16 a[70:71], v9 offset:9224
  ds_read_b64_tr_b16 a[8:9], v9 offset:16384
  ds_read_b64_tr_b16 a[10:11], v9 offset:17408
  ds_read_b64_tr_b16 a[72:73], v9 offset:16392
  ds_read_b64_tr_b16 a[74:75], v9 offset:17416
  ds_read_b64_tr_b16 a[12:13], v9 offset:24576
  ds_read_b64_tr_b16 a[14:15], v9 offset:25600
  ds_read_b64_tr_b16 a[76:77], v9 offset:24584
  ds_read_b64_tr_b16 a[78:79], v9 offset:25608
  s_waitcnt lgkmcnt(0)
  s_waitcnt vmcnt(24)
  s_barrier
  s_lshl_b32 s73, s56, 13
  s_add_u32 m0, s73, 65536
  s_add_u32 s73, s74, 1048576
  buffer_load_dwordx4 v16, s[44:47], s73 offen lds
  s_add_u32 m0, m0, 1024
  s_add_u32 s73, s73, 32768
  buffer_load_dwordx4 v16, s[44:47], s73 offen lds
  s_add_u32 m0, m0, 1024
  s_add_u32 s73, s73, 32768
  buffer_load_dwordx4 v16, s[44:47], s73 offen lds
  s_add_u32 m0, m0, 1024
  s_add_u32 s73, s73, 32768
  buffer_load_dwordx4 v16, s[44:47], s73 offen lds
  s_add_u32 m0, m0, 1024
  s_add_u32 s73, s73, 32768
  buffer_load_dwordx4 v16, s[44:47], s73 offen lds
  s_add_u32 m0, m0, 1024
  s_add_u32 s73, s73, 32768
  buffer_load_dwordx4 v16, s[44:47], s73 offen lds
  s_add_u32 m0, m0, 1024
  s_add_u32 s73, s73, 32768
  buffer_load_dwordx4 v16, s[44:47], s73 offen lds
  s_add_u32 m0, m0, 1024
  s_add_u32 s73, s73, 32768
  buffer_load_dwordx4 v16, s[44:47], s73 offen lds
  ds_read_b64_tr_b16 a[16:17], v9 offset:32768
  ds_read_b64_tr_b16 a[18:19], v9 offset:33792
  ds_read_b64_tr_b16 a[80:81], v9 offset:32776
  ds_read_b64_tr_b16 a[82:83], v9 offset:33800
  ds_read_b64_tr_b16 a[20:21], v9 offset:40960
  ds_read_b64_tr_b16 a[22:23], v9 offset:41984
  ds_read_b64_tr_b16 a[84:85], v9 offset:40968
  ds_read_b64_tr_b16 a[86:87], v9 offset:41992
  ds_read_b64_tr_b16 a[24:25], v9 offset:49152
  ds_read_b64_tr_b16 a[26:27], v9 offset:50176
  ds_read_b64_tr_b16 a[88:89], v9 offset:49160
  ds_read_b64_tr_b16 a[90:91], v9 offset:50184
  ds_read_b64_tr_b16 a[28:29], v9 offset:57344
  ds_read_b64_tr_b16 a[30:31], v9 offset:58368
  ds_read_b64_tr_b16 a[92:93], v9 offset:57352
  ds_read_b64_tr_b16 a[94:95], v9 offset:58376
  s_waitcnt lgkmcnt(0)
  s_waitcnt vmcnt(24)
  s_barrier
  s_lshl_b32 s73, s56, 13
  s_add_u32 m0, s73, 98304
  s_add_u32 s73, s74, 2097152
  buffer_load_dwordx4 v16, s[44:47], s73 offen lds
  s_add_u32 m0, m0, 1024
  s_add_u32 s73, s73, 32768
  buffer_load_dwordx4 v16, s[44:47], s73 offen lds
  s_add_u32 m0, m0, 1024
  s_add_u32 s73, s73, 32768
  buffer_load_dwordx4 v16, s[44:47], s73 offen lds
  s_add_u32 m0, m0, 1024
  s_add_u32 s73, s73, 32768
  buffer_load_dwordx4 v16, s[44:47], s73 offen lds
  s_add_u32 m0, m0, 1024
  s_add_u32 s73, s73, 32768
  buffer_load_dwordx4 v16, s[44:47], s73 offen lds
  s_add_u32 m0, m0, 1024
  s_add_u32 s73, s73, 32768
  buffer_load_dwordx4 v16, s[44:47], s73 offen lds
  s_add_u32 m0, m0, 1024
  s_add_u32 s73, s73, 32768
  buffer_load_dwordx4 v16, s[44:47], s73 offen lds
  s_add_u32 m0, m0, 1024
  s_add_u32 s73, s73, 32768
  buffer_load_dwordx4 v16, s[44:47], s73 offen lds
  v_add_u32 v5, 0x10000, v9
  ds_read_b64_tr_b16 a[32:33], v5 offset:0
  ds_read_b64_tr_b16 a[34:35], v5 offset:1024
  ds_read_b64_tr_b16 a[96:97], v5 offset:8
  ds_read_b64_tr_b16 a[98:99], v5 offset:1032
  ds_read_b64_tr_b16 a[36:37], v5 offset:8192
  ds_read_b64_tr_b16 a[38:39], v5 offset:9216
  ds_read_b64_tr_b16 a[100:101], v5 offset:8200
  ds_read_b64_tr_b16 a[102:103], v5 offset:9224
  ds_read_b64_tr_b16 a[40:41], v5 offset:16384
  ds_read_b64_tr_b16 a[42:43], v5 offset:17408
  ds_read_b64_tr_b16 a[104:105], v5 offset:16392
  ds_read_b64_tr_b16 a[106:107], v5 offset:17416
  ds_read_b64_tr_b16 a[44:45], v5 offset:24576
  ds_read_b64_tr_b16 a[46:47], v5 offset:25600
  ds_read_b64_tr_b16 a[108:109], v5 offset:24584
  ds_read_b64_tr_b16 a[110:111], v5 offset:25608
  s_waitcnt lgkmcnt(0)
  s_waitcnt vmcnt(24)
  s_barrier
  s_lshl_b32 s73, s56, 13
  s_add_u32 m0, s73, 131072
  s_add_u32 s73, s74, 3145728
  buffer_load_dwordx4 v16, s[44:47], s73 offen lds
  s_add_u32 m0, m0, 1024
  s_add_u32 s73, s73, 32768
  buffer_load_dwordx4 v16, s[44:47], s73 offen lds
  s_add_u32 m0, m0, 1024
  s_add_u32 s73, s73, 32768
  buffer_load_dwordx4 v16, s[44:47], s73 offen lds
  s_add_u32 m0, m0, 1024
  s_add_u32 s73, s73, 32768
  buffer_load_dwordx4 v16, s[44:47], s73 offen lds
  s_add_u32 m0, m0, 1024
  s_add_u32 s73, s73, 32768
  buffer_load_dwordx4 v16, s[44:47], s73 offen lds
  s_add_u32 m0, m0, 1024
  s_add_u32 s73, s73, 32768
  buffer_load_dwordx4 v16, s[44:47], s73 offen lds
  s_add_u32 m0, m0, 1024
  s_add_u32 s73, s73, 32768
  buffer_load_dwordx4 v16, s[44:47], s73 offen lds
  s_add_u32 m0, m0, 1024
  s_add_u32 s73, s73, 32768
  buffer_load_dwordx4 v16, s[44:47], s73 offen lds
  ds_read_b64_tr_b16 a[48:49], v8 offset:0
  ds_read_b64_tr_b16 a[50:51], v8 offset:1024
  ds_read_b64_tr_b16 a[112:113], v8 offset:8
  ds_read_b64_tr_b16 a[114:115], v8 offset:1032
  ds_read_b64_tr_b16 a[52:53], v8 offset:8192
  ds_read_b64_tr_b16 a[54:55], v8 offset:9216
  ds_read_b64_tr_b16 a[116:117], v8 offset:8200
  ds_read_b64_tr_b16 a[118:119], v8 offset:9224
  ds_read_b64_tr_b16 a[56:57], v8 offset:16384
  ds_read_b64_tr_b16 a[58:59], v8 offset:17408
  ds_read_b64_tr_b16 a[120:121], v8 offset:16392
  ds_read_b64_tr_b16 a[122:123], v8 offset:17416
  ds_read_b64_tr_b16 a[60:61], v8 offset:24576
  ds_read_b64_tr_b16 a[62:63], v8 offset:25600
  ds_read_b64_tr_b16 a[124:125], v8 offset:24584
  ds_read_b64_tr_b16 a[126:127], v8 offset:25608
  s_waitcnt lgkmcnt(0)
  s_waitcnt vmcnt(24)
  s_barrier
  s_lshl_b32 s73, s56, 13
  s_add_u32 m0, s73, 0
  s_add_u32 s73, s74, 0
  buffer_load_dwordx4 v16, s[48:51], s73 offen lds
  s_add_u32 m0, m0, 1024
  s_add_u32 s73, s73, 32768
  buffer_load_dwordx4 v16, s[48:51], s73 offen lds
  s_add_u32 m0, m0, 1024
  s_add_u32 s73, s73, 32768
  buffer_load_dwordx4 v16, s[48:51], s73 offen lds
  s_add_u32 m0, m0, 1024
  s_add_u32 s73, s73, 32768
  buffer_load_dwordx4 v16, s[48:51], s73 offen lds
  s_add_u32 m0, m0, 1024
  s_add_u32 s73, s73, 32768
  buffer_load_dwordx4 v16, s[48:51], s73 offen lds
  s_add_u32 m0, m0, 1024
  s_add_u32 s73, s73, 32768
  buffer_load_dwordx4 v16, s[48:51], s73 offen lds
  s_add_u32 m0, m0, 1024
  s_add_u32 s73, s73, 32768
  buffer_load_dwordx4 v16, s[48:51], s73 offen lds
  s_add_u32 m0, m0, 1024
  s_add_u32 s73, s73, 32768
  buffer_load_dwordx4 v16, s[48:51], s73 offen lds
  ds_read_b64_tr_b16 a[128:129], v8 offset:32768
  ds_read_b64_tr_b16 a[130:131], v8 offset:33792
  ds_read_b64_tr_b16 a[192:193], v8 offset:32776
  ds_read_b64_tr_b16 a[194:195], v8 offset:33800
  ds_read_b64_tr_b16 a[132:133], v8 offset:40960
  ds_read_b64_tr_b16 a[134:135], v8 offset:41984
  ds_read_b64_tr_b16 a[196:197], v8 offset:40968
  ds_read_b64_tr_b16 a[198:199], v8 offset:41992
  ds_read_b64_tr_b16 a[136:137], v8 offset:49152
  ds_read_b64_tr_b16 a[138:139], v8 offset:50176
  ds_read_b64_tr_b16 a[200:201], v8 offset:49160
  ds_read_b64_tr_b16 a[202:203], v8 offset:50184
  ds_read_b64_tr_b16 a[140:141], v8 offset:57344
  ds_read_b64_tr_b16 a[142:143], v8 offset:58368
  ds_read_b64_tr_b16 a[204:205], v8 offset:57352
  ds_read_b64_tr_b16 a[206:207], v8 offset:58376
  s_waitcnt lgkmcnt(0)
  s_waitcnt vmcnt(24)
  s_barrier
  s_lshl_b32 s73, s56, 13
  s_add_u32 m0, s73, 32768
  s_add_u32 s73, s74, 1048576
  buffer_load_dwordx4 v16, s[48:51], s73 offen lds
  s_add_u32 m0, m0, 1024
  s_add_u32 s73, s73, 32768
  buffer_load_dwordx4 v16, s[48:51], s73 offen lds
  s_add_u32 m0, m0, 1024
  s_add_u32 s73, s73, 32768
  buffer_load_dwordx4 v16, s[48:51], s73 offen lds
  s_add_u32 m0, m0, 1024
  s_add_u32 s73, s73, 32768
  buffer_load_dwordx4 v16, s[48:51], s73 offen lds
  s_add_u32 m0, m0, 1024
  s_add_u32 s73, s73, 32768
  buffer_load_dwordx4 v16, s[48:51], s73 offen lds
  s_add_u32 m0, m0, 1024
  s_add_u32 s73, s73, 32768
  buffer_load_dwordx4 v16, s[48:51], s73 offen lds
  s_add_u32 m0, m0, 1024
  s_add_u32 s73, s73, 32768
  buffer_load_dwordx4 v16, s[48:51], s73 offen lds
  s_add_u32 m0, m0, 1024
  s_add_u32 s73, s73, 32768
  buffer_load_dwordx4 v16, s[48:51], s73 offen lds
  ds_read_b64_tr_b16 a[144:145], v9 offset:0
  ds_read_b64_tr_b16 a[146:147], v9 offset:1024
  ds_read_b64_tr_b16 a[208:209], v9 offset:8
  ds_read_b64_tr_b16 a[210:211], v9 offset:1032
  ds_read_b64_tr_b16 a[148:149], v9 offset:8192
  ds_read_b64_tr_b16 a[150:151], v9 offset:9216
  ds_read_b64_tr_b16 a[212:213], v9 offset:8200
  ds_read_b64_tr_b16 a[214:215], v9 offset:9224
  ds_read_b64_tr_b16 a[152:153], v9 offset:16384
  ds_read_b64_tr_b16 a[154:155], v9 offset:17408
  ds_read_b64_tr_b16 a[216:217], v9 offset:16392
  ds_read_b64_tr_b16 a[218:219], v9 offset:17416
  ds_read_b64_tr_b16 a[156:157], v9 offset:24576
  ds_read_b64_tr_b16 a[158:159], v9 offset:25600
  ds_read_b64_tr_b16 a[220:221], v9 offset:24584
  ds_read_b64_tr_b16 a[222:223], v9 offset:25608
  s_waitcnt lgkmcnt(0)
  s_waitcnt vmcnt(24)
  s_barrier
  s_lshl_b32 s73, s56, 13
  s_add_u32 m0, s73, 65536
  s_add_u32 s73, s74, 2097152
  buffer_load_dwordx4 v16, s[48:51], s73 offen lds
  s_add_u32 m0, m0, 1024
  s_add_u32 s73, s73, 32768
  buffer_load_dwordx4 v16, s[48:51], s73 offen lds
  s_add_u32 m0, m0, 1024
  s_add_u32 s73, s73, 32768
  buffer_load_dwordx4 v16, s[48:51], s73 offen lds
  s_add_u32 m0, m0, 1024
  s_add_u32 s73, s73, 32768
  buffer_load_dwordx4 v16, s[48:51], s73 offen lds
  s_add_u32 m0, m0, 1024
  s_add_u32 s73, s73, 32768
  buffer_load_dwordx4 v16, s[48:51], s73 offen lds
  s_add_u32 m0, m0, 1024
  s_add_u32 s73, s73, 32768
  buffer_load_dwordx4 v16, s[48:51], s73 offen lds
  s_add_u32 m0, m0, 1024
  s_add_u32 s73, s73, 32768
  buffer_load_dwordx4 v16, s[48:51], s73 offen lds
  s_add_u32 m0, m0, 1024
  s_add_u32 s73, s73, 32768
  buffer_load_dwordx4 v16, s[48:51], s73 offen lds
  ds_read_b64_tr_b16 a[160:161], v9 offset:32768
  ds_read_b64_tr_b16 a[162:163], v9 offset:33792
  ds_read_b64_tr_b16 a[224:225], v9 offset:32776
  ds_read_b64_tr_b16 a[226:227], v9 offset:33800
  ds_read_b64_tr_b16 a[164:165], v9 offset:40960
  ds_read_b64_tr_b16 a[166:167], v9 offset:41984
  ds_read_b64_tr_b16 a[228:229], v9 offset:40968
  ds_read_b64_tr_b16 a[230:231], v9 offset:41992
  ds_read_b64_tr_b16 a[168:169], v9 offset:49152
  ds_read_b64_tr_b16 a[170:171], v9 offset:50176
  ds_read_b64_tr_b16 a[232:233], v9 offset:49160
  ds_read_b64_tr_b16 a[234:235], v9 offset:50184
  ds_read_b64_tr_b16 a[172:173], v9 offset:57344
  ds_read_b64_tr_b16 a[174:175], v9 offset:58368
  ds_read_b64_tr_b16 a[236:237], v9 offset:57352
  ds_read_b64_tr_b16 a[238:239], v9 offset:58376
  s_waitcnt lgkmcnt(0)
  s_waitcnt vmcnt(24)
  s_barrier
  s_lshl_b32 s73, s56, 13
  s_add_u32 m0, s73, 98304
  s_add_u32 s73, s74, 3145728
  buffer_load_dwordx4 v16, s[48:51], s73 offen lds
  s_add_u32 m0, m0, 1024
  s_add_u32 s73, s73, 32768
  buffer_load_dwordx4 v16, s[48:51], s73 offen lds
  s_add_u32 m0, m0, 1024
  s_add_u32 s73, s73, 32768
  buffer_load_dwordx4 v16, s[48:51], s73 offen lds
  s_add_u32 m0, m0, 1024
  s_add_u32 s73, s73, 32768
  buffer_load_dwordx4 v16, s[48:51], s73 offen lds
  s_add_u32 m0, m0, 1024
  s_add_u32 s73, s73, 32768
  buffer_load_dwordx4 v16, s[48:51], s73 offen lds
  s_add_u32 m0, m0, 1024
  s_add_u32 s73, s73, 32768
  buffer_load_dwordx4 v16, s[48:51], s73 offen lds
  s_add_u32 m0, m0, 1024
  s_add_u32 s73, s73, 32768
  buffer_load_dwordx4 v16, s[48:51], s73 offen lds
  s_add_u32 m0, m0, 1024
  s_add_u32 s73, s73, 32768
  buffer_load_dwordx4 v16, s[48:51], s73 offen lds
  v_add_u32 v5, 0x10000, v9
  ds_read_b64_tr_b16 a[176:177], v5 offset:0
  ds_read_b64_tr_b16 a[178:179], v5 offset:1024
  ds_read_b64_tr_b16 a[240:241], v5 offset:8
  ds_read_b64_tr_b16 a[242:243], v5 offset:1032
  ds_read_b64_tr_b16 a[180:181], v5 offset:8192
  ds_read_b64_tr_b16 a[182:183], v5 offset:9216
  ds_read_b64_tr_b16 a[244:245], v5 offset:8200
  ds_read_b64_tr_b16 a[246:247], v5 offset:9224
  ds_read_b64_tr_b16 a[184:185], v5 offset:16384
  ds_read_b64_tr_b16 a[186:187], v5 offset:17408
  ds_read_b64_tr_b16 a[248:249], v5 offset:16392
  ds_read_b64_tr_b16 a[250:251], v5 offset:17416
  ds_read_b64_tr_b16 a[188:189], v5 offset:24576
  ds_read_b64_tr_b16 a[190:191], v5 offset:25600
  ds_read_b64_tr_b16 a[252:253], v5 offset:24584
  ds_read_b64_tr_b16 a[254:255], v5 offset:25608
  s_waitcnt lgkmcnt(0)
  s_waitcnt vmcnt(24)
  s_barrier
  ds_read_b64_tr_b16 v[128:129], v8 offset:0
  ds_read_b64_tr_b16 v[130:131], v8 offset:1024
  ds_read_b64_tr_b16 v[192:193], v8 offset:8
  ds_read_b64_tr_b16 v[194:195], v8 offset:1032
  ds_read_b64_tr_b16 v[132:133], v8 offset:8192
  ds_read_b64_tr_b16 v[134:135], v8 offset:9216
  ds_read_b64_tr_b16 v[196:197], v8 offset:8200
  ds_read_b64_tr_b16 v[198:199], v8 offset:9224
  ds_read_b64_tr_b16 v[136:137], v8 offset:16384
  ds_read_b64_tr_b16 v[138:139], v8 offset:17408
  ds_read_b64_tr_b16 v[200:201], v8 offset:16392
  ds_read_b64_tr_b16 v[202:203], v8 offset:17416
  ds_read_b64_tr_b16 v[140:141], v8 offset:24576
  ds_read_b64_tr_b16 v[142:143], v8 offset:25600
  ds_read_b64_tr_b16 v[204:205], v8 offset:24584
  ds_read_b64_tr_b16 v[206:207], v8 offset:25608
  s_waitcnt lgkmcnt(0)
  s_waitcnt vmcnt(16)
  s_barrier
  ds_read_b64_tr_b16 v[144:145], v8 offset:32768
  ds_read_b64_tr_b16 v[146:147], v8 offset:33792
  ds_read_b64_tr_b16 v[208:209], v8 offset:32776
  ds_read_b64_tr_b16 v[210:211], v8 offset:33800
  ds_read_b64_tr_b16 v[148:149], v8 offset:40960
  ds_read_b64_tr_b16 v[150:151], v8 offset:41984
  ds_read_b64_tr_b16 v[212:213], v8 offset:40968
  ds_read_b64_tr_b16 v[214:215], v8 offset:41992
  ds_read_b64_tr_b16 v[152:153], v8 offset:49152
  ds_read_b64_tr_b16 v[154:155], v8 offset:50176
  ds_read_b64_tr_b16 v[216:217], v8 offset:49160
  ds_read_b64_tr_b16 v[218:219], v8 offset:50184
  ds_read_b64_tr_b16 v[156:157], v8 offset:57344
  ds_read_b64_tr_b16 v[158:159], v8 offset:58368
  ds_read_b64_tr_b16 v[220:221], v8 offset:57352
  ds_read_b64_tr_b16 v[222:223], v8 offset:58376
  s_waitcnt lgkmcnt(0)
  s_waitcnt vmcnt(8)
  s_barrier
  ds_read_b64_tr_b16 v[160:161], v9 offset:0
  ds_read_b64_tr_b16 v[162:163], v9 offset:1024
  ds_read_b64_tr_b16 v[224:225], v9 offset:8
  ds_read_b64_tr_b16 v[226:227], v9 offset:1032
  ds_read_b64_tr_b16 v[164:165], v9 offset:8192
  ds_read_b64_tr_b16 v[166:167], v9 offset:9216
  ds_read_b64_tr_b16 v[228:229], v9 offset:8200
  ds_read_b64_tr_b16 v[230:231], v9 offset:9224
  ds_read_b64_tr_b16 v[168:169], v9 offset:16384
  ds_read_b64_tr_b16 v[170:171], v9 offset:17408
  ds_read_b64_tr_b16 v[232:233], v9 offset:16392
  ds_read_b64_tr_b16 v[234:235], v9 offset:17416
  ds_read_b64_tr_b16 v[172:173], v9 offset:24576
  ds_read_b64_tr_b16 v[174:175], v9 offset:25600
  ds_read_b64_tr_b16 v[236:237], v9 offset:24584
  ds_read_b64_tr_b16 v[238:239], v9 offset:25608
  s_waitcnt lgkmcnt(0)
  s_waitcnt vmcnt(0)
  s_barrier
  ds_read_b64_tr_b16 v[176:177], v9 offset:32768
  ds_read_b64_tr_b16 v[178:179], v9 offset:33792
  ds_read_b64_tr_b16 v[240:241], v9 offset:32776
  ds_read_b64_tr_b16 v[242:243], v9 offset:33800
  ds_read_b64_tr_b16 v[180:181], v9 offset:40960
  ds_read_b64_tr_b16 v[182:183], v9 offset:41984
  ds_read_b64_tr_b16 v[244:245], v9 offset:40968
  ds_read_b64_tr_b16 v[246:247], v9 offset:41992
  ds_read_b64_tr_b16 v[184:185], v9 offset:49152
  ds_read_b64_tr_b16 v[186:187], v9 offset:50176
  ds_read_b64_tr_b16 v[248:249], v9 offset:49160
  ds_read_b64_tr_b16 v[250:251], v9 offset:50184
  ds_read_b64_tr_b16 v[188:189], v9 offset:57344
  ds_read_b64_tr_b16 v[190:191], v9 offset:58368
  ds_read_b64_tr_b16 v[252:253], v9 offset:57352
  ds_read_b64_tr_b16 v[254:255], v9 offset:58376
  s_waitcnt lgkmcnt(0)
  s_barrier
  v_and_b32 v3, 15, v1
  v_lshlrev_b32 v3, 2, v3
  v_mov_b32 v4, 221952
  v_mov_b32 v5, 238336
  v_cndmask_b32 v4, v4, v5, s[66:67]
  v_add_u32 v8, v3, v4
  v_mov_b32 v9, 64
  v_mov_b32 v10, 1
  v_mov_b32 v11, 0
  s_mov_b32 s84, s71
  s_mov_b32 s85, s71
  s_mov_b32 s89, 0
  s_mov_b32 s90, 65536
  s_mov_b32 s27, 0
  s_mov_b32 s26, 1
  s_lshl_b32 s60, s70, 7
  s_add_u32 s60, s60, 147456
  v_writelane_b32 v8, s60, 63
  v_writelane_b32 v9, 0, 63
  v_writelane_b32 v10, 0, 63
  s_mov_b32 s75, 0
  v_mov_b32 v13, 12
IW_28:
  buffer_load_dword v12, v13, s[36:39], 0 offen sc1
  s_waitcnt vmcnt(0)
  v_readfirstlane_b32 s60, v12
  s_cmp_ge_u32 s60, 256
  s_cbranch_scc1 IWD_29
  s_add_u32 s64, s64, 1
  s_cmp_lt_u32 s64, 131072
  s_cbranch_scc1 SPOK_30
  s_mov_b32 s63, 1
  s_branch L_ABORT
SPOK_30:
  s_sleep 8
  s_branch IW_28
IWD_29:
  s_mov_b32 s64, 0
  s_barrier
  v_and_b32 v3, 15, v1
  v_lshrrev_b32 v4, 4, v1
  v_add_u32 v5, 0, v4
  v_xor_b32 v5, v5, v3
  v_lshlrev_b32 v5, 4, v5
  v_lshl_add_u32 v40, v3, 10, v5
  v_add_u32 v5, 4, v4
  v_xor_b32 v5, v5, v3
  v_lshlrev_b32 v5, 4, v5
  v_lshl_add_u32 v41, v3, 10, v5
  v_add_u32 v5, 8, v4
  v_xor_b32 v5, v5, v3
  v_lshlrev_b32 v5, 4, v5
  v_lshl_add_u32 v42, v3, 10, v5
  v_add_u32 v5, 12, v4
  v_xor_b32 v5, v5, v3
  v_lshlrev_b32 v5, 4, v5
  v_lshl_add_u32 v43, v3, 10, v5
  s_branch L_QKV_FIRST
L_QKV_IDLE:
  s_cmp_eq_u32 s27, 0
  s_cbranch_scc1 FS_35
  s_waitcnt vmcnt(2)
  v_mov_b32 v16, 1
  v_mov_b32 v17, 0
  buffer_store_dword v16, v17, s[32:35], s27 offen sc1
  s_mov_b32 s27, 0
FS_35:
  s_cmp_eq_u32 s89, 0
  s_cbranch_scc1 FS_36
  s_waitcnt vmcnt(0)
  v_mov_b32 v16, 1
  v_mov_b32 v17, 0
  buffer_store_dword v16, v17, s[32:35], s89 offen sc1
  s_mov_b32 s89, 0
FS_36:
  s_waitcnt lgkmcnt(0)
  s_barrier
  v_mov_b32 v13, s90
  ds_read_b32 v12, v13
  s_xor_b32 s90, s90, 4
  s_waitcnt lgkmcnt(0)
  v_readfirstlane_b32 s60, v12
  s_lshr_b32 s86, s60, 6
  s_and_b32 s87, s60, 63
  s_cmp_eq_u32 s86, 0
  s_cselect_b32 s61, 2, 0
  s_add_u32 s84, s84, s61
  s_cmp_eq_u32 s86, 1
  s_cselect_b32 s61, 2, 0
  s_add_u32 s85, s85, s61
  s_cmp_lt_u32 s86, 2
  s_cselect_b32 s88, 1, 0
  s_cselect_b32 s86, s86, 0
  s_cselect_b32 s87, s87, 0
  v_mul_u32_u24 v3, s88, v2
  s_cmp_lg_u32 s88, 0
  s_cbranch_scc1 PKH_34
L_QKV_FIRST:
  s_min_u32 s60, s84, s85
  s_cmp_ge_u32 s60, 64
  s_cbranch_scc1 L_END
  s_cmp_lg_u32 s56, 0
  s_cbranch_scc1 PKW_33
  s_min_u32 s60, s84, 63
  s_min_u32 s61, s85, 63
  v_mov_b32 v12, s60
  v_mov_b32 v13, s61
  v_cndmask_b32 v12, v12, v13, s[66:67]
  v_mad_u32_u24 v13, v12, v9, v8
  v_mad_u32_u24 v14, v12, v11, v10
  buffer_load_dword v12, v13, s[32:35], 0 offen sc1
PK_31:
  s_waitcnt vmcnt(0)
  v_cmp_ge_u32 vcc, v12, v14
  s_add_u32 s61, s85, 64
  s_cmp_lt_u32 s85, 64
  s_cselect_b32 s61, s61, 255
  s_cmp_eq_u32 vcc_lo, -1
  s_cselect_b32 s61, s61, 255
  s_cmp_lt_u32 s84, 64
  s_cselect_b32 s60, s84, 255
  s_cmp_eq_u32 vcc_hi, -1
  s_cselect_b32 s60, s60, 255
  v_readlane_b32 s62, v12, 63
  s_add_u32 s62, s62, 8
  s_cmp_le_u32 s84, s62
  s_cselect_b32 s26, 1, 0
  s_min_u32 s62, s60, s61
  s_cmp_eq_u32 s61, 255
  s_cselect_b32 s60, s60, s61
  s_cmp_eq_u32 s26, 1
  s_cselect_b32 s60, s62, s60
  s_cmp_lg_u32 s60, 255
  s_cbranch_scc1 PKG_32
  s_add_u32 s64, s64, 1
  s_cmp_lt_u32 s64, 131072
  s_cbranch_scc1 SPOK_37
  s_mov_b32 s63, 3
  s_branch L_ABORT
SPOK_37:
  s_sleep 2
  buffer_load_dword v12, v13, s[32:35], 0 offen sc1
  s_branch PK_31
PKG_32:
  s_mov_b32 s64, 0
  v_mov_b32 v12, s60
  v_mov_b32 v13, s90
  ds_write_b32 v13, v12
  s_waitcnt lgkmcnt(0)
PKW_33:
  s_barrier
  v_mov_b32 v13, s90
  ds_read_b32 v12, v13
  s_xor_b32 s90, s90, 4
  s_waitcnt lgkmcnt(0)
  v_readfirstlane_b32 s60, v12
  s_lshr_b32 s86, s60, 6
  s_and_b32 s87, s60, 63
  s_cmp_eq_u32 s86, 0
  s_cselect_b32 s61, 2, 0
  s_add_u32 s84, s84, s61
  s_cmp_eq_u32 s86, 1
  s_cselect_b32 s61, 2, 0
  s_add_u32 s85, s85, s61
  s_cmp_lt_u32 s86, 2
  s_cselect_b32 s88, 1, 0
  s_cselect_b32 s86, s86, 0
  s_cselect_b32 s87, s87, 0
  v_mul_u32_u24 v3, s88, v2
PKH_34:
  s_mov_b32 s76, 0
  s_lshl_b32 s60, s87, 15
  s_add_u32 s76, s76, s60
  s_add_u32 s76, s76, 4194304
  s_lshl_b32 s60, s56, 13
  s_add_u32 m0, s60, s75
  s_add_u32 s60, s60, s76
  buffer_load_dwordx4 v3, s[32:35], s60 offen offset:0 sc1 lds
  buffer_load_dwordx4 v3, s[32:35], s60 offen offset:1024 sc1 lds
  buffer_load_dwordx4 v3, s[32:35], s60 offen offset:2048 sc1 lds
  buffer_load_dwordx4 v3, s[32:35], s60 offen offset:3072 sc1 lds
  s_add_u32 m0, m0, 4096
  s_add_u32 s60, s60, 4096
  buffer_load_dwordx4 v3, s[32:35], s60 offen offset:0 sc1 lds
  buffer_load_dwordx4 v3, s[32:35], s60 offen offset:1024 sc1 lds
  buffer_load_dwordx4 v3, s[32:35], s60 offen offset:2048 sc1 lds
  buffer_load_dwordx4 v3, s[32:35], s60 offen offset:3072 sc1 lds
  s_cmp_lg_u32 s56, 0
  s_cbranch_scc1 W0_38
  s_min_u32 s60, s84, 63
  s_min_u32 s61, s85, 63
  v_mov_b32 v12, s60
  v_mov_b32 v13, s61
  v_cndmask_b32 v12, v12, v13, s[66:67]
  v_mad_u32_u24 v13, v12, v9, v8
  v_mad_u32_u24 v14, v12, v11, v10
  buffer_load_dword v12, v13, s[32:35], 0 offen sc1
W0_38:
  s_waitcnt vmcnt(0)
  s_cmp_lg_u32 s56, 0
  s_cbranch_scc1 W0_39
  s_waitcnt vmcnt(0)
  v_cmp_ge_u32 vcc, v12, v14
  s_add_u32 s61, s85, 64
  s_cmp_lt_u32 s85, 64
  s_cselect_b32 s61, s61, 255
  s_cmp_eq_u32 vcc_lo, -1
  s_cselect_b32 s61, s61, 255
  s_cmp_lt_u32 s84, 64
  s_cselect_b32 s60, s84, 255
  s_cmp_eq_u32 vcc_hi, -1
  s_cselect_b32 s60, s60, 255
  v_readlane_b32 s62, v12, 63
  s_add_u32 s62, s62, 8
  s_cmp_le_u32 s84, s62
  s_cselect_b32 s26, 1, 0
  s_min_u32 s62, s60, s61
  s_cmp_eq_u32 s61, 255
  s_cselect_b32 s60, s60, s61
  s_cmp_eq_u32 s26, 1
  s_cselect_b32 s60, s62, s60
  v_mov_b32 v12, s60
  v_mov_b32 v13, s90
  ds_write_b32 v13, v12
W0_39:
  s_waitcnt lgkmcnt(0)
L_QKV_TOP:
  s_mov_b32 s91, s86
  s_mov_b32 s92, s87
  v_add_u32 v20, s75, v40
  v_add_u32 v21, s75, v41
  v_add_u32 v22, s75, v42
  v_add_u32 v23, s75, v43
  s_xor_b32 s75, s75, 0x8000
  s_waitcnt vmcnt(6) lgkmcnt(0)
  s_barrier
  v_mov_b32 v13, s90
  ds_read_b32 v12, v13
  s_xor_b32 s90, s90, 4
  ds_read_b128 v[24:27], v20 offset:0
  ds_read_b128 v[28:31], v20 offset:16384
  ds_read_b128 v[32:35], v21 offset:0
  ds_read_b128 v[36:39], v21 offset:16384
  ds_read_b128 v[96:99], v22 offset:0
  ds_read_b128 v[100:103], v22 offset:16384
  s_waitcnt lgkmcnt(6)
  v_readfirstlane_b32 s60, v12
  s_lshr_b32 s86, s60, 6
  s_and_b32 s87, s60, 63
  s_cmp_eq_u32 s86, 0
  s_cselect_b32 s61, 2, 0
  s_add_u32 s84, s84, s61
  s_cmp_eq_u32 s86, 1
  s_cselect_b32 s61, 2, 0
  s_add_u32 s85, s85, s61
  s_cmp_lt_u32 s86, 2
  s_cselect_b32 s88, 1, 0
  s_cselect_b32 s86, s86, 0
  s_cselect_b32 s87, s87, 0
  v_mul_u32_u24 v3, s88, v2
  ds_read_b128 v[104:107], v23 offset:0
  ds_read_b128 v[108:111], v23 offset:16384
  s_waitcnt lgkmcnt(6)
  v_mfma_f32_16x16x32_bf16 v[48:51], a[0:3], v[24:27], 0
  s_mov_b32 s76, 0
  v_mfma_f32_16x16x32_bf16 v[52:55], a[64:67], v[24:27], 0
  s_lshl_b32 s60, s87, 15
  v_mfma_f32_16x16x32_bf16 v[56:59], a[0:3], v[28:31], 0
  s_add_u32 s76, s76, s60
  v_mfma_f32_16x16x32_bf16 v[60:63], a[64:67], v[28:31], 0
  s_add_u32 s76, s76, 4194304
  v_mfma_f32_16x16x32_bf16 v[64:67], v[24:27], a[128:131], 0
  s_lshl_b32 s60, s56, 13
  v_mfma_f32_16x16x32_bf16 v[68:71], v[24:27], a[192:195], 0
  s_add_u32 m0, s60, s75
  v_mfma_f32_16x16x32_bf16 v[72:75], v[28:31], a[128:131], 0
  s_add_u32 s60, s60, s76
  v_mfma_f32_16x16x32_bf16 v[76:79], v[28:31], a[192:195], 0
  buffer_load_dwordx4 v3, s[32:35], s60 offen offset:0 sc1 lds
  ds_read_b128 v[24:27], v20 offset:256
  ds_read_b128 v[28:31], v20 offset:16640
  s_waitcnt lgkmcnt(6)
  v_mfma_f32_16x16x32_bf16 v[48:51], a[4:7], v[32:35], v[48:51]
  v_mfma_f32_16x16x32_bf16 v[52:55], a[68:71], v[32:35], v[52:55]
  v_mfma_f32_16x16x32_bf16 v[56:59], a[4:7], v[36:39], v[56:59]
  v_mfma_f32_16x16x32_bf16 v[60:63], a[68:71], v[36:39], v[60:63]
  v_mfma_f32_16x16x32_bf16 v[64:67], v[32:35], a[132:135], v[64:67]
  v_mfma_f32_16x16x32_bf16 v[68:71], v[32:35], a[196:199], v[68:71]
  v_mfma_f32_16x16x32_bf16 v[72:75], v[36:39], a[132:135], v[72:75]
  v_mfma_f32_16x16x32_bf16 v[76:79], v[36:39], a[196:199], v[76:79]
  s_cmp_eq_u32 s27, 0
  s_cbranch_scc1 FS_40
  s_waitcnt vmcnt(3)
  v_mov_b32 v16, 1
  v_mov_b32 v17, 0
  buffer_store_dword v16, v17, s[32:35], s27 offen sc1
  s_mov_b32 s27, 0
FS_40:
  ds_read_b128 v[32:35], v21 offset:256
  ds_read_b128 v[36:39], v21 offset:16640
  s_waitcnt lgkmcnt(6)
  v_mfma_f32_16x16x32_bf16 v[48:51], a[8:11], v[96:99], v[48:51]
  v_mfma_f32_16x16x32_bf16 v[52:55], a[72:75], v[96:99], v[52:55]
  buffer_load_dwordx4 v3, s[32:35], s60 offen offset:1024 sc1 lds
  v_mfma_f32_16x16x32_bf16 v[56:59], a[8:11], v[100:103], v[56:59]
  v_mfma_f32_16x16x32_bf16 v[60:63], a[72:75], v[100:103], v[60:63]
  v_mfma_f32_16x16x32_bf16 v[64:67], v[96:99], a[136:139], v[64:67]
  v_mfma_f32_16x16x32_bf16 v[68:71], v[96:99], a[200:203], v[68:71]
  v_mfma_f32_16x16x32_bf16 v[72:75], v[100:103], a[136:139], v[72:75]
  v_mfma_f32_16x16x32_bf16 v[76:79], v[100:103], a[200:203], v[76:79]
  ds_read_b128 v[96:99], v22 offset:256
  ds_read_b128 v[100:103], v22 offset:16640
  s_waitcnt lgkmcnt(6)
  v_mfma_f32_16x16x32_bf16 v[48:51], a[12:15], v[104:107], v[48:51]
  v_mfma_f32_16x16x32_bf16 v[52:55], a[76:79], v[104:107], v[52:55]
  v_mfma_f32_16x16x32_bf16 v[56:59], a[12:15], v[108:111], v[56:59]
  v_mfma_f32_16x16x32_bf16 v[60:63], a[76:79], v[108:111], v[60:63]
  buffer_load_dwordx4 v3, s[32:35], s60 offen offset:2048 sc1 lds
  v_mfma_f32_16x16x32_bf16 v[64:67], v[104:107], a[140:143], v[64:67]
  v_mfma_f32_16x16x32_bf16 v[68:71], v[104:107], a[204:207], v[68:71]
  v_mfma_f32_16x16x32_bf16 v[72:75], v[108:111], a[140:143], v[72:75]
  v_mfma_f32_16x16x32_bf16 v[76:79], v[108:111], a[204:207], v[76:79]
  ds_read_b128 v[104:107], v23 offset:256
  ds_read_b128 v[108:111], v23 offset:16640
  s_waitcnt lgkmcnt(6)
  v_mfma_f32_16x16x32_bf16 v[48:51], a[16:19], v[24:27], v[48:51]
  v_mfma_f32_16x16x32_bf16 v[52:55], a[80:83], v[24:27], v[52:55]
  v_mfma_f32_16x16x32_bf16 v[56:59], a[16:19], v[28:31], v[56:59]
  v_mfma_f32_16x16x32_bf16 v[60:63], a[80:83], v[28:31], v[60:63]
  v_mfma_f32_16x16x32_bf16 v[64:67], v[24:27], a[144:147], v[64:67]
  v_mfma_f32_16x16x32_bf16 v[68:71], v[24:27], a[208:211], v[68:71]
  buffer_load_dwordx4 v3, s[32:35], s60 offen offset:3072 sc1 lds
  v_mfma_f32_16x16x32_bf16 v[72:75], v[28:31], a[144:147], v[72:75]
  s_add_u32 m0, m0, 4096
  v_mfma_f32_16x16x32_bf16 v[76:79], v[28:31], a[208:211], v[76:79]
  s_add_u32 s60, s60, 4096
  ds_read_b128 v[24:27], v20 offset:512
  ds_read_b128 v[28:31], v20 offset:16896
  s_waitcnt lgkmcnt(6)
  v_mfma_f32_16x16x32_bf16 v[48:51], a[20:23], v[32:35], v[48:51]
  v_mfma_f32_16x16x32_bf16 v[52:55], a[84:87], v[32:35], v[52:55]
  v_mfma_f32_16x16x32_bf16 v[56:59], a[20:23], v[36:39], v[56:59]
  v_mfma_f32_16x16x32_bf16 v[60:63], a[84:87], v[36:39], v[60:63]
  v_mfma_f32_16x16x32_bf16 v[64:67], v[32:35], a[148:151], v[64:67]
  v_mfma_f32_16x16x32_bf16 v[68:71], v[32:35], a[212:215], v[68:71]
  v_mfma_f32_16x16x32_bf16 v[72:75], v[36:39], a[148:151], v[72:75]
  v_mfma_f32_16x16x32_bf16 v[76:79], v[36:39], a[212:215], v[76:79]
  buffer_load_dwordx4 v3, s[32:35], s60 offen offset:0 sc1 lds
  ds_read_b128 v[32:35], v21 offset:512
  ds_read_b128 v[36:39], v21 offset:16896
  s_waitcnt lgkmcnt(6)
  v_mfma_f32_16x16x32_bf16 v[48:51], a[24:27], v[96:99], v[48:51]
  v_mfma_f32_16x16x32_bf16 v[52:55], a[88:91], v[96:99], v[52:55]
  v_mfma_f32_16x16x32_bf16 v[56:59], a[24:27], v[100:103], v[56:59]
  v_mfma_f32_16x16x32_bf16 v[60:63], a[88:91], v[100:103], v[60:63]
  v_mfma_f32_16x16x32_bf16 v[64:67], v[96:99], a[152:155], v[64:67]
  v_mfma_f32_16x16x32_bf16 v[68:71], v[96:99], a[216:219], v[68:71]
  v_mfma_f32_16x16x32_bf16 v[72:75], v[100:103], a[152:155], v[72:75]
  v_mfma_f32_16x16x32_bf16 v[76:79], v[100:103], a[216:219], v[76:79]
  ds_read_b128 v[96:99], v22 offset:512
  ds_read_b128 v[100:103], v22 offset:16896
  s_waitcnt lgkmcnt(6)
  v_mfma_f32_16x16x32_bf16 v[48:51], a[28:31], v[104:107], v[48:51]
  v_mfma_f32_16x16x32_bf16 v[52:55], a[92:95], v[104:107], v[52:55]
  buffer_load_dwordx4 v3, s[32:35], s60 offen offset:1024 sc1 lds
  v_mfma_f32_16x16x32_bf16 v[56:59], a[28:31], v[108:111], v[56:59]
  v_mfma_f32_16x16x32_bf16 v[60:63], a[92:95], v[108:111], v[60:63]
  v_mfma_f32_16x16x32_bf16 v[64:67], v[104:107], a[156:159], v[64:67]
  v_mfma_f32_16x16x32_bf16 v[68:71], v[104:107], a[220:223], v[68:71]
  v_mfma_f32_16x16x32_bf16 v[72:75], v[108:111], a[156:159], v[72:75]
  v_mfma_f32_16x16x32_bf16 v[76:79], v[108:111], a[220:223], v[76:79]
  ds_read_b128 v[104:107], v23 offset:512
  ds_read_b128 v[108:111], v23 offset:16896
  s_waitcnt lgkmcnt(6)
  v_mfma_f32_16x16x32_bf16 v[48:51], a[32:35], v[24:27], v[48:51]
  v_mfma_f32_16x16x32_bf16 v[52:55], a[96:99], v[24:27], v[52:55]
  v_mfma_f32_16x16x32_bf16 v[56:59], a[32:35], v[28:31], v[56:59]
  v_mfma_f32_16x16x32_bf16 v[60:63], a[96:99], v[28:31], v[60:63]
  buffer_load_dwordx4 v3, s[32:35], s60 offen offset:2048 sc1 lds
  v_mfma_f32_16x16x32_bf16 v[64:67], v[24:27], a[160:163], v[64:67]
  v_mfma_f32_16x16x32_bf16 v[68:71], v[24:27], a[224:227], v[68:71]
  v_mfma_f32_16x16x32_bf16 v[72:75], v[28:31], a[160:163], v[72:75]
  v_mfma_f32_16x16x32_bf16 v[76:79], v[28:31], a[224:227], v[76:79]
  s_cmp_eq_u32 s89, 0
  s_cbranch_scc1 FS_41
  s_waitcnt vmcnt(7)
  v_mov_b32 v16, 1
  v_mov_b32 v17, 0
  buffer_store_dword v16, v17, s[32:35], s89 offen sc1
  s_mov_b32 s89, 0
FS_41:
  ds_read_b128 v[24:27], v20 offset:768
  ds_read_b128 v[28:31], v20 offset:17152
  s_waitcnt lgkmcnt(6)
  v_mfma_f32_16x16x32_bf16 v[48:51], a[36:39], v[32:35], v[48:51]
  v_mfma_f32_16x16x32_bf16 v[52:55], a[100:103], v[32:35], v[52:55]
  v_mfma_f32_16x16x32_bf16 v[56:59], a[36:39], v[36:39], v[56:59]
  v_mfma_f32_16x16x32_bf16 v[60:63], a[100:103], v[36:39], v[60:63]
  v_mfma_f32_16x16x32_bf16 v[64:67], v[32:35], a[164:167], v[64:67]
  v_mfma_f32_16x16x32_bf16 v[68:71], v[32:35], a[228:231], v[68:71]
  buffer_load_dwordx4 v3, s[32:35], s60 offen offset:3072 sc1 lds
  v_mfma_f32_16x16x32_bf16 v[72:75], v[36:39], a[164:167], v[72:75]
  s_mov_b32 s77, 0
  v_mfma_f32_16x16x32_bf16 v[76:79], v[36:39], a[228:231], v[76:79]
  s_lshl_b32 s60, s92, 18
  ds_read_b128 v[32:35], v21 offset:768
  ds_read_b128 v[36:39], v21 offset:17152
  s_waitcnt lgkmcnt(6)
  v_mfma_f32_16x16x32_bf16 v[48:51], a[40:43], v[96:99], v[48:51]
  s_add_u32 s77, s77, s60
  v_mfma_f32_16x16x32_bf16 v[52:55], a[104:107], v[96:99], v[52:55]
  s_lshl_b32 s60, s70, 13
  v_mfma_f32_16x16x32_bf16 v[56:59], a[40:43], v[100:103], v[56:59]
  s_add_u32 s77, s77, s60
  v_mfma_f32_16x16x32_bf16 v[60:63], a[104:107], v[100:103], v[60:63]
  s_lshl_b32 s60, s56, 11
  v_mfma_f32_16x16x32_bf16 v[64:67], v[96:99], a[168:171], v[64:67]
  s_add_u32 s78, s77, s60
  v_mfma_f32_16x16x32_bf16 v[68:71], v[96:99], a[232:235], v[68:71]
  s_add_u32 s78, s78, 104857600
  v_mfma_f32_16x16x32_bf16 v[72:75], v[100:103], a[168:171], v[72:75]
  s_lshl_b32 s60, s56, 10
  v_mfma_f32_16x16x32_bf16 v[76:79], v[100:103], a[232:235], v[76:79]
  s_add_u32 s77, s77, s60
  ds_read_b128 v[96:99], v22 offset:768
  ds_read_b128 v[100:103], v22 offset:17152
  s_waitcnt lgkmcnt(6)
  v_mfma_f32_16x16x32_bf16 v[48:51], a[44:47], v[104:107], v[48:51]
  s_add_u32 s79, s77, 37748736
  v_mfma_f32_16x16x32_bf16 v[52:55], a[108:111], v[104:107], v[52:55]
  s_add_u32 s77, s77, 71303168
  v_mfma_f32_16x16x32_bf16 v[56:59], a[44:47], v[108:111], v[56:59]
  s_lshl_b32 s80, s91, 15
  v_mfma_f32_16x16x32_bf16 v[60:63], a[108:111], v[108:111], v[60:63]
  s_lshl_b32 s60, s92, 9
  v_mfma_f32_16x16x32_bf16 v[64:67], v[104:107], a[172:175], v[64:67]
  s_add_u32 s80, s80, s60
  v_mfma_f32_16x16x32_bf16 v[68:71], v[104:107], a[236:239], v[68:71]
  s_lshl_b32 s60, s70, 4
  v_mfma_f32_16x16x32_bf16 v[72:75], v[108:111], a[172:175], v[72:75]
  s_add_u32 s80, s80, s60
  v_mfma_f32_16x16x32_bf16 v[76:79], v[108:111], a[236:239], v[76:79]
  s_lshl_b32 s60, s56, 2
  ds_read_b128 v[104:107], v23 offset:768
  ds_read_b128 v[108:111], v23 offset:17152
  s_waitcnt lgkmcnt(6)
  v_mfma_f32_16x16x32_bf16 v[48:51], a[48:51], v[24:27], v[48:51]
  s_add_u32 s80, s80, s60
  v_mfma_f32_16x16x32_bf16 v[52:55], a[112:115], v[24:27], v[52:55]
  v_mfma_f32_16x16x32_bf16 v[56:59], a[48:51], v[28:31], v[56:59]
  v_mfma_f32_16x16x32_bf16 v[60:63], a[112:115], v[28:31], v[60:63]
  v_mfma_f32_16x16x32_bf16 v[64:67], v[24:27], a[176:179], v[64:67]
  v_mfma_f32_16x16x32_bf16 v[68:71], v[24:27], a[240:243], v[68:71]
  v_mfma_f32_16x16x32_bf16 v[72:75], v[28:31], a[176:179], v[72:75]
  v_mfma_f32_16x16x32_bf16 v[76:79], v[28:31], a[240:243], v[76:79]
  ds_read_b128 v[24:27], v20 offset:0
  ds_read_b128 v[28:31], v20 offset:16384
  s_waitcnt lgkmcnt(6)
  v_mfma_f32_16x16x32_bf16 v[48:51], a[52:55], v[32:35], v[48:51]
  v_mfma_f32_16x16x32_bf16 v[52:55], a[116:119], v[32:35], v[52:55]
  v_mfma_f32_16x16x32_bf16 v[56:59], a[52:55], v[36:39], v[56:59]
  v_mfma_f32_16x16x32_bf16 v[60:63], a[116:119], v[36:39], v[60:63]
  v_mfma_f32_16x16x32_bf16 v[64:67], v[32:35], a[180:183], v[64:67]
  v_mfma_f32_16x16x32_bf16 v[68:71], v[32:35], a[244:247], v[68:71]
  v_mfma_f32_16x16x32_bf16 v[72:75], v[36:39], a[180:183], v[72:75]
  v_mfma_f32_16x16x32_bf16 v[76:79], v[36:39], a[244:247], v[76:79]
  ds_read_b128 v[32:35], v21 offset:0
  ds_read_b128 v[36:39], v21 offset:16384
  s_waitcnt lgkmcnt(6)
  v_mfma_f32_16x16x32_bf16 v[48:51], a[56:59], v[96:99], v[48:51]
  v_mfma_f32_16x16x32_bf16 v[52:55], a[120:123], v[96:99], v[52:55]
  v_mfma_f32_16x16x32_bf16 v[56:59], a[56:59], v[100:103], v[56:59]
  v_mfma_f32_16x16x32_bf16 v[60:63], a[120:123], v[100:103], v[60:63]
  v_mfma_f32_16x16x32_bf16 v[64:67], v[96:99], a[184:187], v[64:67]
  v_mfma_f32_16x16x32_bf16 v[68:71], v[96:99], a[248:251], v[68:71]
  v_mfma_f32_16x16x32_bf16 v[72:75], v[100:103], a[184:187], v[72:75]
  v_mfma_f32_16x16x32_bf16 v[76:79], v[100:103], a[248:251], v[76:79]
  ds_read_b128 v[96:99], v22 offset:0
  ds_read_b128 v[100:103], v22 offset:16384
  s_waitcnt lgkmcnt(6)
  v_mfma_f32_16x16x32_bf16 v[48:51], a[60:63], v[104:107], v[48:51]
  v_mfma_f32_16x16x32_bf16 v[52:55], a[124:127], v[104:107], v[52:55]
  v_mfma_f32_16x16x32_bf16 v[56:59], a[60:63], v[108:111], v[56:59]
  v_mfma_f32_16x16x32_bf16 v[60:63], a[124:127], v[108:111], v[60:63]
  v_mfma_f32_16x16x32_bf16 v[64:67], v[104:107], a[188:191], v[64:67]
  v_mfma_f32_16x16x32_bf16 v[68:71], v[104:107], a[252:255], v[68:71]
  v_mfma_f32_16x16x32_bf16 v[72:75], v[108:111], a[188:191], v[72:75]
  v_mfma_f32_16x16x32_bf16 v[76:79], v[108:111], a[252:255], v[76:79]
  s_cmp_lg_u32 s56, 0
  s_cbranch_scc1 W0_42
  s_min_u32 s60, s84, 63
  s_min_u32 s61, s85, 63
  v_mov_b32 v12, s60
  v_mov_b32 v13, s61
  v_cndmask_b32 v12, v12, v13, s[66:67]
  v_mad_u32_u24 v13, v12, v9, v8
  v_mad_u32_u24 v14, v12, v11, v10
  buffer_load_dword v12, v13, s[32:35], 0 offen sc1
W0_42:
  ds_read_b128 v[104:107], v23 offset:0
  ds_read_b128 v[108:111], v23 offset:16384
  s_waitcnt lgkmcnt(6)
  v_mfma_f32_16x16x32_bf16 v[80:83], v[128:131], v[24:27], 0
  v_cvt_pk_bf16_f32 v112, v48, v52
  v_mfma_f32_16x16x32_bf16 v[84:87], v[192:195], v[24:27], 0
  v_cvt_pk_bf16_f32 v113, v49, v53
  v_mfma_f32_16x16x32_bf16 v[88:91], v[128:131], v[28:31], 0
  v_cvt_pk_bf16_f32 v114, v50, v54
  v_mfma_f32_16x16x32_bf16 v[92:95], v[192:195], v[28:31], 0
  v_cvt_pk_bf16_f32 v115, v51, v55
  ds_read_b128 v[24:27], v20 offset:256
  ds_read_b128 v[28:31], v20 offset:16640
  s_waitcnt lgkmcnt(6)
  v_mfma_f32_16x16x32_bf16 v[80:83], v[132:135], v[32:35], v[80:83]
  buffer_store_dwordx4 v[112:115], v2, s[32:35], s77 offen sc1
  v_mfma_f32_16x16x32_bf16 v[84:87], v[196:199], v[32:35], v[84:87]
  s_add_u32 s77, s77, 4096
  v_mfma_f32_16x16x32_bf16 v[88:91], v[132:135], v[36:39], v[88:91]
  v_cvt_pk_bf16_f32 v116, v56, v60
  v_mfma_f32_16x16x32_bf16 v[92:95], v[196:199], v[36:39], v[92:95]
  v_cvt_pk_bf16_f32 v117, v57, v61
  ds_read_b128 v[32:35], v21 offset:256
  ds_read_b128 v[36:39], v21 offset:16640
  s_waitcnt lgkmcnt(6)
  v_mfma_f32_16x16x32_bf16 v[80:83], v[136:139], v[96:99], v[80:83]
  v_cvt_pk_bf16_f32 v118, v58, v62
  v_mfma_f32_16x16x32_bf16 v[84:87], v[200:203], v[96:99], v[84:87]
  v_cvt_pk_bf16_f32 v119, v59, v63
  v_mfma_f32_16x16x32_bf16 v[88:91], v[136:139], v[100:103], v[88:91]
  buffer_store_dwordx4 v[116:119], v2, s[32:35], s77 offen sc1
  v_mfma_f32_16x16x32_bf16 v[92:95], v[200:203], v[100:103], v[92:95]
  v_cvt_pk_bf16_f32 v120, v64, v65
  ds_read_b128 v[96:99], v22 offset:256
  ds_read_b128 v[100:103], v22 offset:16640
  s_waitcnt lgkmcnt(6)
  v_mfma_f32_16x16x32_bf16 v[80:83], v[140:143], v[104:107], v[80:83]
  v_cvt_pk_bf16_f32 v121, v66, v67
  v_mfma_f32_16x16x32_bf16 v[84:87], v[204:207], v[104:107], v[84:87]
  v_cvt_pk_bf16_f32 v122, v72, v73
  v_mfma_f32_16x16x32_bf16 v[88:91], v[140:143], v[108:111], v[88:91]
  v_cvt_pk_bf16_f32 v123, v74, v75
  v_mfma_f32_16x16x32_bf16 v[92:95], v[204:207], v[108:111], v[92:95]
  ds_read_b128 v[104:107], v23 offset:256
  ds_read_b128 v[108:111], v23 offset:16640
  s_waitcnt lgkmcnt(6)
  v_mfma_f32_16x16x32_bf16 v[80:83], v[144:147], v[24:27], v[80:83]
  buffer_store_dwordx4 v[120:123], v2, s[32:35], s78 offen offset:0 sc1
  v_mfma_f32_16x16x32_bf16 v[84:87], v[208:211], v[24:27], v[84:87]
  v_cvt_pk_bf16_f32 v124, v68, v69
  v_mfma_f32_16x16x32_bf16 v[88:91], v[144:147], v[28:31], v[88:91]
  v_cvt_pk_bf16_f32 v125, v70, v71
  v_mfma_f32_16x16x32_bf16 v[92:95], v[208:211], v[28:31], v[92:95]
  v_cvt_pk_bf16_f32 v126, v76, v77
  ds_read_b128 v[24:27], v20 offset:512
  ds_read_b128 v[28:31], v20 offset:16896
  s_waitcnt lgkmcnt(6)
  v_mfma_f32_16x16x32_bf16 v[80:83], v[148:151], v[32:35], v[80:83]
  v_cvt_pk_bf16_f32 v127, v78, v79
  v_mfma_f32_16x16x32_bf16 v[84:87], v[212:215], v[32:35], v[84:87]
  v_mfma_f32_16x16x32_bf16 v[88:91], v[148:151], v[36:39], v[88:91]
  buffer_store_dwordx4 v[124:127], v2, s[32:35], s78 offen offset:1024 sc1
  v_mfma_f32_16x16x32_bf16 v[92:95], v[212:215], v[36:39], v[92:95]
  ds_read_b128 v[32:35], v21 offset:512
  ds_read_b128 v[36:39], v21 offset:16896
  s_waitcnt lgkmcnt(6)
  v_mfma_f32_16x16x32_bf16 v[80:83], v[152:155], v[96:99], v[80:83]
  v_mfma_f32_16x16x32_bf16 v[84:87], v[216:219], v[96:99], v[84:87]
  v_mfma_f32_16x16x32_bf16 v[88:91], v[152:155], v[100:103], v[88:91]
  v_mfma_f32_16x16x32_bf16 v[92:95], v[216:219], v[100:103], v[92:95]
  ds_read_b128 v[96:99], v22 offset:512
  ds_read_b128 v[100:103], v22 offset:16896
  s_waitcnt lgkmcnt(6)
  v_mfma_f32_16x16x32_bf16 v[80:83], v[156:159], v[104:107], v[80:83]
  v_mfma_f32_16x16x32_bf16 v[84:87], v[220:223], v[104:107], v[84:87]
  v_mfma_f32_16x16x32_bf16 v[88:91], v[156:159], v[108:111], v[88:91]
  v_mfma_f32_16x16x32_bf16 v[92:95], v[220:223], v[108:111], v[92:95]
  ds_read_b128 v[104:107], v23 offset:512
  ds_read_b128 v[108:111], v23 offset:16896
  s_waitcnt lgkmcnt(6)
  v_mfma_f32_16x16x32_bf16 v[80:83], v[160:163], v[24:27], v[80:83]
  v_mfma_f32_16x16x32_bf16 v[84:87], v[224:227], v[24:27], v[84:87]
  v_mfma_f32_16x16x32_bf16 v[88:91], v[160:163], v[28:31], v[88:91]
  v_mfma_f32_16x16x32_bf16 v[92:95], v[224:227], v[28:31], v[92:95]
  ds_read_b128 v[24:27], v20 offset:768
  ds_read_b128 v[28:31], v20 offset:17152
  s_waitcnt lgkmcnt(6)
  v_mfma_f32_16x16x32_bf16 v[80:83], v[164:167], v[32:35], v[80:83]
  v_mfma_f32_16x16x32_bf16 v[84:87], v[228:231], v[32:35], v[84:87]
  v_mfma_f32_16x16x32_bf16 v[88:91], v[164:167], v[36:39], v[88:91]
  v_mfma_f32_16x16x32_bf16 v[92:95], v[228:231], v[36:39], v[92:95]
  ds_read_b128 v[32:35], v21 offset:768
  ds_read_b128 v[36:39], v21 offset:17152
  s_waitcnt lgkmcnt(6)
  v_mfma_f32_16x16x32_bf16 v[80:83], v[168:171], v[96:99], v[80:83]
  v_mfma_f32_16x16x32_bf16 v[84:87], v[232:235], v[96:99], v[84:87]
  v_mfma_f32_16x16x32_bf16 v[88:91], v[168:171], v[100:103], v[88:91]
  v_mfma_f32_16x16x32_bf16 v[92:95], v[232:235], v[100:103], v[92:95]
  ds_read_b128 v[96:99], v22 offset:768
  ds_read_b128 v[100:103], v22 offset:17152
  s_waitcnt lgkmcnt(6)
  v_mfma_f32_16x16x32_bf16 v[80:83], v[172:175], v[104:107], v[80:83]
  v_mfma_f32_16x16x32_bf16 v[84:87], v[236:239], v[104:107], v[84:87]
  v_mfma_f32_16x16x32_bf16 v[88:91], v[172:175], v[108:111], v[88:91]
  v_mfma_f32_16x16x32_bf16 v[92:95], v[236:239], v[108:111], v[92:95]
  ds_read_b128 v[104:107], v23 offset:768
  ds_read_b128 v[108:111], v23 offset:17152
  s_waitcnt lgkmcnt(6)
  v_mfma_f32_16x16x32_bf16 v[80:83], v[176:179], v[24:27], v[80:83]
  v_mfma_f32_16x16x32_bf16 v[84:87], v[240:243], v[24:27], v[84:87]
  v_mfma_f32_16x16x32_bf16 v[88:91], v[176:179], v[28:31], v[88:91]
  v_mfma_f32_16x16x32_bf16 v[92:95], v[240:243], v[28:31], v[92:95]
  s_waitcnt lgkmcnt(4)
  v_mfma_f32_16x16x32_bf16 v[80:83], v[180:183], v[32:35], v[80:83]
  v_mfma_f32_16x16x32_bf16 v[84:87], v[244:247], v[32:35], v[84:87]
  v_mfma_f32_16x16x32_bf16 v[88:91], v[180:183], v[36:39], v[88:91]
  v_mfma_f32_16x16x32_bf16 v[92:95], v[244:247], v[36:39], v[92:95]
  s_waitcnt lgkmcnt(2)
  v_mfma_f32_16x16x32_bf16 v[80:83], v[184:187], v[96:99], v[80:83]
  v_mfma_f32_16x16x32_bf16 v[84:87], v[248:251], v[96:99], v[84:87]
  v_mfma_f32_16x16x32_bf16 v[88:91], v[184:187], v[100:103], v[88:91]
  v_mfma_f32_16x16x32_bf16 v[92:95], v[248:251], v[100:103], v[92:95]
  s_waitcnt lgkmcnt(0)
  v_mfma_f32_16x16x32_bf16 v[80:83], v[188:191], v[104:107], v[80:83]
  v_mfma_f32_16x16x32_bf16 v[84:87], v[252:255], v[104:107], v[84:87]
  v_mfma_f32_16x16x32_bf16 v[88:91], v[188:191], v[108:111], v[88:91]
  v_mfma_f32_16x16x32_bf16 v[92:95], v[252:255], v[108:111], v[92:95]
  s_add_u32 s27, s80, 16384
  s_cmp_lg_u32 s56, 0
  s_cbranch_scc1 W0_43
  s_waitcnt vmcnt(4)
  v_cmp_ge_u32 vcc, v12, v14
  s_add_u32 s61, s85, 64
  s_cmp_lt_u32 s85, 64
  s_cselect_b32 s61, s61, 255
  s_cmp_eq_u32 vcc_lo, -1
  s_cselect_b32 s61, s61, 255
  s_cmp_lt_u32 s84, 64
  s_cselect_b32 s60, s84, 255
  s_cmp_eq_u32 vcc_hi, -1
  s_cselect_b32 s60, s60, 255
  v_readlane_b32 s62, v12, 63
  s_add_u32 s62, s62, 8
  s_cmp_le_u32 s84, s62
  s_cselect_b32 s26, 1, 0
  s_min_u32 s62, s60, s61
  s_cmp_eq_u32 s61, 255
  s_cselect_b32 s60, s60, s61
  s_cmp_eq_u32 s26, 1
  s_cselect_b32 s60, s62, s60
  v_mov_b32 v12, s60
  v_mov_b32 v13, s90
  ds_write_b32 v13, v12
W0_43:
  s_nop 2
  v_cvt_pk_bf16_f32 v112, v80, v84
  v_cvt_pk_bf16_f32 v113, v81, v85
  v_cvt_pk_bf16_f32 v114, v82, v86
  v_cvt_pk_bf16_f32 v115, v83, v87
  buffer_store_dwordx4 v[112:115], v2, s[32:35], s79 offen sc1
  s_add_u32 s79, s79, 4096
  v_cvt_pk_bf16_f32 v116, v88, v92
  v_cvt_pk_bf16_f32 v117, v89, v93
  v_cvt_pk_bf16_f32 v118, v90, v94
  v_cvt_pk_bf16_f32 v119, v91, v95
  buffer_store_dwordx4 v[116:119], v2, s[32:35], s79 offen sc1
  s_add_u32 s89, s80, 81920
  s_cmp_lg_u32 s88, 0
  s_cbranch_scc1 L_QKV_TOP
  s_branch L_QKV_IDLE
L_CHAIN:
  s_lshr_b32 s70, s57, 5
  s_and_b32 s71, s57, 31
  s_lshl_b32 s93, s70, 2
  s_cmp_lg_u32 s56, 0
  s_cbranch_scc1 IA_44
  s_waitcnt vmcnt(0)
  s_mov_b64 exec, 1
  v_mov_b32 v30, 1
  v_mov_b32 v31, 12
  buffer_atomic_add v30, v31, s[36:39], 0 offen
  s_mov_b64 exec, -1
IA_44:
  s_mov_b32 s40, s8
  s_and_b32 s41, s9, 0xffff
  s_mov_b32 s42, 4194304
  s_mov_b32 s43, 0x20000
  s_mov_b32 s44, s10
  s_and_b32 s45, s11, 0xffff
  s_mov_b32 s46, 4194304
  s_mov_b32 s47, 0x20000
  s_mov_b32 s48, s12
  s_and_b32 s49, s13, 0xffff
  s_mov_b32 s50, 4194304
  s_mov_b32 s51, 0x20000
  s_mov_b32 s52, s14
  s_and_b32 s53, s15, 0xffff
  s_mov_b32 s54, 4194304
  s_mov_b32 s55, 0x20000
  s_lshl_b32 s78, s70, 19
  s_add_u32 s78, s78, 1048576
  s_lshl_b32 s60, s71, 13
  s_add_u32 s77, s78, s60
  s_lshl_b32 s79, s70, 15
  s_add_u32 s79, s79, 2097152
  v_mov_b32 v4, -1
  v_mov_b32 v5, -1
  v_mov_b32 v6, -1
  v_mov_b32 v7, -1
  s_lshl_b32 s60, s56, 11
  s_add_u32 s60, s60, s77
  buffer_store_dwordx4 v[4:7], v2, s[32:35], s60 offen offset:0 sc1
  buffer_store_dwordx4 v[4:7], v2, s[32:35], s60 offen offset:1024 sc1
  s_add_u32 s60, s60, 262144
  buffer_store_dwordx4 v[4:7], v2, s[32:35], s60 offen offset:0 sc1
  buffer_store_dwordx4 v[4:7], v2, s[32:35], s60 offen offset:1024 sc1
  v_bfe_u32 v3, v1, 2, 2
  v_bfe_u32 v8, v1, 4, 1
  v_lshl_add_u32 v3, v3, 1, v8
  v_and_b32 v8, 3, v1
  v_bfe_u32 v9, v1, 2, 2
  v_lshlrev_b32 v9, 6, v9
  v_bfe_u32 v12, v1, 1, 1
  v_lshl_add_u32 v9, v12, 5, v9
  v_bfe_u32 v12, v1, 4, 1
  v_lshl_add_u32 v9, v12, 4, v9
  v_and_b32 v12, 1, v1
  v_lshl_add_u32 v10, v12, 3, v9
  s_lshl_b32 s86, s71, 8
  s_add_u32 s86, s86, s79
  s_cmp_lg_u32 s56, 0
  s_cbranch_scc1 CI_45
  s_mov_b64 exec, s[66:67]
  s_mov_b32 s96, s6
  s_and_b32 s97, s7, 0xffff
  s_mov_b32 s98, 8192
  s_mov_b32 s99, 0x20000
  v_lshlrev_b32 v9, 10, v3
  v_lshl_add_u32 v9, v8, 1, v9
  s_lshl_b32 s60, s71, 5
  buffer_load_ushort v26, v9, s[96:99], s60 offen offset:0
  buffer_load_ushort v27, v9, s[96:99], s60 offen offset:8
  buffer_load_ushort v28, v9, s[96:99], s60 offen offset:16
  buffer_load_ushort v29, v9, s[96:99], s60 offen offset:24
  s_waitcnt vmcnt(0)
  s_cmp_lg_u32 s56, 0
  s_cbranch_scc1 CM0_46
  s_mov_b64 exec, s[66:67]
  v_lshl_or_b32 v26, v27, 16, v26
  v_lshl_or_b32 v27, v29, 16, v28
  v_min_u32 v27, -2, v27
  buffer_store_dwordx2 v[26:27], v10, s[32:35], s86 offen sc1
  s_mov_b64 exec, -1
CM0_46:
  s_mov_b64 exec, s[66:67]
  s_add_u32 s60, s86, 8192
  buffer_store_dwordx2 v[4:5], v10, s[32:35], s60 offen sc1
  s_add_u32 s60, s86, 16384
  buffer_store_dwordx2 v[4:5], v10, s[32:35], s60 offen sc1
  s_add_u32 s60, s86, 24576
  buffer_store_dwordx2 v[4:5], v10, s[32:35], s60 offen sc1
  s_mov_b64 exec, 1
  s_lshl_b32 s60, 1, s58
  v_mov_b32 v12, s60
  s_lshl_b32 s60, s70, 2
  v_mov_b32 v13, 16
  buffer_atomic_or v12, v13, s[36:39], s60 offen
  s_mov_b64 exec, -1
CI_45:
  s_cmp_eq_u32 s70, 0
  s_cbranch_scc1 CE_47
CE_47:
  v_mov_b32 v4, -1
  v_mov_b32 v6, -1
  s_lshl_b32 s74, s71, 8
  s_lshl_b32 s60, s56, 18
  s_add_u32 s74, s74, s60
  s_lshl_b32 s75, s71, 17
  s_lshl_b32 s60, s56, 8
  s_add_u32 s75, s75, s60
  v_bfe_u32 v16, v1, 5, 1
  v_bfe_u32 v17, v1, 4, 1
  v_bfe_u32 v18, v1, 3, 1
  v_bfe_u32 v19, v1, 2, 1
  v_and_b32 v20, 3, v1
  v_lshl_add_u32 v22, v18, 1, v17
  v_lshlrev_b32 v21, 4, v16
  v_lshl_add_u32 v21, v19, 2, v21
  v_add_u32 v21, v21, v22
  v_lshlrev_b32 v21, 8, v21
  v_lshl_add_u32 v21, v20, 4, v21
  v_xor_b32 v22, s56, v22
  v_lshl_add_u32 v12, v22, 6, v21
  v_add_u32 v13, 0x10000, v12
  v_lshlrev_b32 v21, 4, v16
  v_lshl_add_u32 v21, v18, 3, v21
  v_lshl_add_u32 v21, v17, 2, v21
  v_add_u32 v21, v21, v19
  v_lshlrev_b32 v21, 7, v21
  v_lshl_add_u32 v21, v20, 5, v21
  s_lshl_b32 s60, s56, 13
  v_add_u32 v14, s60, v21
  v_add_u32 v15, 0x10000, v14
  v_add_u32 v24, s60, v2
  v_add_u32 v25, 0x10000, v24
  s_mov_b32 s73, 8192
  v_lshrrev_b32 v3, 4, v1
  v_mul_lo_u32 v16, v3, s73
  v_lshlrev_b32 v3, 2, v3
  v_and_b32 v4, 15, v1
  v_xor_b32 v3, v3, v4
  v_lshl_add_u32 v16, v3, 4, v16
  s_mov_b32 s73, 1024
  v_lshrrev_b32 v3, 3, v1
  v_mul_lo_u32 v17, v3, s73
  v_and_b32 v3, 7, v1
  v_lshl_add_u32 v17, v3, 4, v17
  s_lshl_b32 s73, s56, 13
  s_add_u32 m0, s73, 98304
  s_add_u32 s73, s74, 0
  buffer_load_dwordx4 v16, s[40:43], s73 offen lds
  s_add_u32 m0, m0, 1024
  s_add_u32 s73, s73, 32768
  buffer_load_dwordx4 v16, s[40:43], s73 offen lds
  s_add_u32 m0, m0, 1024
  s_add_u32 s73, s73, 32768
  buffer_load_dwordx4 v16, s[40:43], s73 offen lds
  s_add_u32 m0, m0, 1024
  s_add_u32 s73, s73, 32768
  buffer_load_dwordx4 v16, s[40:43], s73 offen lds
  s_add_u32 m0, m0, 1024
  s_add_u32 s73, s73, 32768
  buffer_load_dwordx4 v16, s[40:43], s73 offen lds
  s_add_u32 m0, m0, 1024
  s_add_u32 s73, s73, 32768
  buffer_load_dwordx4 v16, s[40:43], s73 offen lds
  s_add_u32 m0, m0, 1024
  s_add_u32 s73, s73, 32768
  buffer_load_dwordx4 v16, s[40:43], s73 offen lds
  s_add_u32 m0, m0, 1024
  s_add_u32 s73, s73, 32768
  buffer_load_dwordx4 v16, s[40:43], s73 offen lds
  s_lshl_b32 s73, s56, 13
  s_add_u32 m0, s73, 131072
  s_add_u32 s73, s74, 1048576
  buffer_load_dwordx4 v16, s[40:43], s73 offen lds
  s_add_u32 m0, m0, 1024
  s_add_u32 s73, s73, 32768
  buffer_load_dwordx4 v16, s[40:43], s73 offen lds
  s_add_u32 m0, m0, 1024
  s_add_u32 s73, s73, 32768
  buffer_load_dwordx4 v16, s[40:43], s73 offen lds
  s_add_u32 m0, m0, 1024
  s_add_u32 s73, s73, 32768
  buffer_load_dwordx4 v16, s[40:43], s73 offen lds
  s_add_u32 m0, m0, 1024
  s_add_u32 s73, s73, 32768
  buffer_load_dwordx4 v16, s[40:43], s73 offen lds
  s_add_u32 m0, m0, 1024
  s_add_u32 s73, s73, 32768
  buffer_load_dwordx4 v16, s[40:43], s73 offen lds
  s_add_u32 m0, m0, 1024
  s_add_u32 s73, s73, 32768
  buffer_load_dwordx4 v16, s[40:43], s73 offen lds
  s_add_u32 m0, m0, 1024
  s_add_u32 s73, s73, 32768
  buffer_load_dwordx4 v16, s[40:43], s73 offen lds
  s_lshl_b32 s73, s56, 13
  s_add_u32 m0, s73, 0
  s_add_u32 s73, s74, 2097152
  buffer_load_dwordx4 v16, s[40:43], s73 offen lds
  s_add_u32 m0, m0, 1024
  s_add_u32 s73, s73, 32768
  buffer_load_dwordx4 v16, s[40:43], s73 offen lds
  s_add_u32 m0, m0, 1024
  s_add_u32 s73, s73, 32768
  buffer_load_dwordx4 v16, s[40:43], s73 offen lds
  s_add_u32 m0, m0, 1024
  s_add_u32 s73, s73, 32768
  buffer_load_dwordx4 v16, s[40:43], s73 offen lds
  s_add_u32 m0, m0, 1024
  s_add_u32 s73, s73, 32768
  buffer_load_dwordx4 v16, s[40:43], s73 offen lds
  s_add_u32 m0, m0, 1024
  s_add_u32 s73, s73, 32768
  buffer_load_dwordx4 v16, s[40:43], s73 offen lds
  s_add_u32 m0, m0, 1024
  s_add_u32 s73, s73, 32768
  buffer_load_dwordx4 v16, s[40:43], s73 offen lds
  s_add_u32 m0, m0, 1024
  s_add_u32 s73, s73, 32768
  buffer_load_dwordx4 v16, s[40:43], s73 offen lds
  s_lshl_b32 s73, s56, 13
  s_add_u32 m0, s73, 32768
  s_add_u32 s73, s74, 3145728
  buffer_load_dwordx4 v16, s[40:43], s73 offen lds
  s_add_u32 m0, m0, 1024
  s_add_u32 s73, s73, 32768
  buffer_load_dwordx4 v16, s[40:43], s73 offen lds
  s_add_u32 m0, m0, 1024
  s_add_u32 s73, s73, 32768
  buffer_load_dwordx4 v16, s[40:43], s73 offen lds
  s_add_u32 m0, m0, 1024
  s_add_u32 s73, s73, 32768
  buffer_load_dwordx4 v16, s[40:43], s73 offen lds
  s_add_u32 m0, m0, 1024
  s_add_u32 s73, s73, 32768
  buffer_load_dwordx4 v16, s[40:43], s73 offen lds
  s_add_u32 m0, m0, 1024
  s_add_u32 s73, s73, 32768
  buffer_load_dwordx4 v16, s[40:43], s73 offen lds
  s_add_u32 m0, m0, 1024
  s_add_u32 s73, s73, 32768
  buffer_load_dwordx4 v16, s[40:43], s73 offen lds
  s_add_u32 m0, m0, 1024
  s_add_u32 s73, s73, 32768
  buffer_load_dwordx4 v16, s[40:43], s73 offen lds
  s_lshl_b32 s73, s56, 13
  s_add_u32 m0, s73, 65536
  s_add_u32 s73, s74, 0
  buffer_load_dwordx4 v16, s[44:47], s73 offen lds
  s_add_u32 m0, m0, 1024
  s_add_u32 s73, s73, 32768
  buffer_load_dwordx4 v16, s[44:47], s73 offen lds
  s_add_u32 m0, m0, 1024
  s_add_u32 s73, s73, 32768
  buffer_load_dwordx4 v16, s[44:47], s73 offen lds
  s_add_u32 m0, m0, 1024
  s_add_u32 s73, s73, 32768
  buffer_load_dwordx4 v16, s[44:47], s73 offen lds
  s_add_u32 m0, m0, 1024
  s_add_u32 s73, s73, 32768
  buffer_load_dwordx4 v16, s[44:47], s73 offen lds
  s_add_u32 m0, m0, 1024
  s_add_u32 s73, s73, 32768
  buffer_load_dwordx4 v16, s[44:47], s73 offen lds
  s_add_u32 m0, m0, 1024
  s_add_u32 s73, s73, 32768
  buffer_load_dwordx4 v16, s[44:47], s73 offen lds
  s_add_u32 m0, m0, 1024
  s_add_u32 s73, s73, 32768
  buffer_load_dwordx4 v16, s[44:47], s73 offen lds
  s_waitcnt vmcnt(32)
  s_barrier
  s_cmp_lg_u32 s56, 0
  s_cbranch_scc1 RCN_49
  ds_read_b64_tr_b16 a[0:1], v13 offset:32768
  ds_read_b64_tr_b16 a[2:3], v13 offset:34816
  ds_read_b64_tr_b16 a[4:5], v13 offset:40960
  ds_read_b64_tr_b16 a[6:7], v13 offset:43008
  ds_read_b64_tr_b16 a[64:65], v13 offset:32776
  ds_read_b64_tr_b16 a[66:67], v13 offset:34824
  ds_read_b64_tr_b16 a[68:69], v13 offset:40968
  ds_read_b64_tr_b16 a[70:71], v13 offset:43016
  ds_read_b64_tr_b16 a[8:9], v13 offset:49152
  ds_read_b64_tr_b16 a[10:11], v13 offset:51200
  ds_read_b64_tr_b16 a[12:13], v13 offset:57344
  ds_read_b64_tr_b16 a[14:15], v13 offset:59392
  ds_read_b64_tr_b16 a[72:73], v13 offset:49160
  ds_read_b64_tr_b16 a[74:75], v13 offset:51208
  ds_read_b64_tr_b16 a[76:77], v13 offset:57352
  ds_read_b64_tr_b16 a[78:79], v13 offset:59400
  s_branch RCE_48
RCN_49:
  s_cmp_lg_u32 s56, 1
  s_cbranch_scc1 RCN_50
  ds_read_b64_tr_b16 a[16:17], v13 offset:32768
  ds_read_b64_tr_b16 a[18:19], v13 offset:34816
  ds_read_b64_tr_b16 a[20:21], v13 offset:40960
  ds_read_b64_tr_b16 a[22:23], v13 offset:43008
  ds_read_b64_tr_b16 a[80:81], v13 offset:32776
  ds_read_b64_tr_b16 a[82:83], v13 offset:34824
  ds_read_b64_tr_b16 a[84:85], v13 offset:40968
  ds_read_b64_tr_b16 a[86:87], v13 offset:43016
  ds_read_b64_tr_b16 a[24:25], v13 offset:49152
  ds_read_b64_tr_b16 a[26:27], v13 offset:51200
  ds_read_b64_tr_b16 a[28:29], v13 offset:57344
  ds_read_b64_tr_b16 a[30:31], v13 offset:59392
  ds_read_b64_tr_b16 a[88:89], v13 offset:49160
  ds_read_b64_tr_b16 a[90:91], v13 offset:51208
  ds_read_b64_tr_b16 a[92:93], v13 offset:57352
  ds_read_b64_tr_b16 a[94:95], v13 offset:59400
  s_branch RCE_48
RCN_50:
  s_cmp_lg_u32 s56, 2
  s_cbranch_scc1 RCN_51
  ds_read_b64_tr_b16 a[32:33], v13 offset:32768
  ds_read_b64_tr_b16 a[34:35], v13 offset:34816
  ds_read_b64_tr_b16 a[36:37], v13 offset:40960
  ds_read_b64_tr_b16 a[38:39], v13 offset:43008
  ds_read_b64_tr_b16 a[96:97], v13 offset:32776
  ds_read_b64_tr_b16 a[98:99], v13 offset:34824
  ds_read_b64_tr_b16 a[100:101], v13 offset:40968
  ds_read_b64_tr_b16 a[102:103], v13 offset:43016
  ds_read_b64_tr_b16 a[40:41], v13 offset:49152
  ds_read_b64_tr_b16 a[42:43], v13 offset:51200
  ds_read_b64_tr_b16 a[44:45], v13 offset:57344
  ds_read_b64_tr_b16 a[46:47], v13 offset:59392
  ds_read_b64_tr_b16 a[104:105], v13 offset:49160
  ds_read_b64_tr_b16 a[106:107], v13 offset:51208
  ds_read_b64_tr_b16 a[108:109], v13 offset:57352
  ds_read_b64_tr_b16 a[110:111], v13 offset:59400
  s_branch RCE_48
RCN_51:
  ds_read_b64_tr_b16 a[48:49], v13 offset:32768
  ds_read_b64_tr_b16 a[50:51], v13 offset:34816
  ds_read_b64_tr_b16 a[52:53], v13 offset:40960
  ds_read_b64_tr_b16 a[54:55], v13 offset:43008
  ds_read_b64_tr_b16 a[112:113], v13 offset:32776
  ds_read_b64_tr_b16 a[114:115], v13 offset:34824
  ds_read_b64_tr_b16 a[116:117], v13 offset:40968
  ds_read_b64_tr_b16 a[118:119], v13 offset:43016
  ds_read_b64_tr_b16 a[56:57], v13 offset:49152
  ds_read_b64_tr_b16 a[58:59], v13 offset:51200
  ds_read_b64_tr_b16 a[60:61], v13 offset:57344
  ds_read_b64_tr_b16 a[62:63], v13 offset:59392
  ds_read_b64_tr_b16 a[120:121], v13 offset:49160
  ds_read_b64_tr_b16 a[122:123], v13 offset:51208
  ds_read_b64_tr_b16 a[124:125], v13 offset:57352
  ds_read_b64_tr_b16 a[126:127], v13 offset:59400
RCE_48:
  s_waitcnt lgkmcnt(0)
  s_waitcnt vmcnt(24)
  s_barrier
  s_lshl_b32 s73, s56, 13
  s_add_u32 m0, s73, 98304
  s_add_u32 s73, s74, 1048576
  buffer_load_dwordx4 v16, s[44:47], s73 offen lds
  s_add_u32 m0, m0, 1024
  s_add_u32 s73, s73, 32768
  buffer_load_dwordx4 v16, s[44:47], s73 offen lds
  s_add_u32 m0, m0, 1024
  s_add_u32 s73, s73, 32768
  buffer_load_dwordx4 v16, s[44:47], s73 offen lds
  s_add_u32 m0, m0, 1024
  s_add_u32 s73, s73, 32768
  buffer_load_dwordx4 v16, s[44:47], s73 offen lds
  s_add_u32 m0, m0, 1024
  s_add_u32 s73, s73, 32768
  buffer_load_dwordx4 v16, s[44:47], s73 offen lds
  s_add_u32 m0, m0, 1024
  s_add_u32 s73, s73, 32768
  buffer_load_dwordx4 v16, s[44:47], s73 offen lds
  s_add_u32 m0, m0, 1024
  s_add_u32 s73, s73, 32768
  buffer_load_dwordx4 v16, s[44:47], s73 offen lds
  s_add_u32 m0, m0, 1024
  s_add_u32 s73, s73, 32768
  buffer_load_dwordx4 v16, s[44:47], s73 offen lds
  s_cmp_lg_u32 s56, 0
  s_cbranch_scc1 RCN_54
  v_add_u32 v5, 0x10000, v13
  ds_read_b64_tr_b16 a[16:17], v5 offset:0
  ds_read_b64_tr_b16 a[18:19], v5 offset:2048
  ds_read_b64_tr_b16 a[20:21], v5 offset:8192
  ds_read_b64_tr_b16 a[22:23], v5 offset:10240
  ds_read_b64_tr_b16 a[80:81], v5 offset:8
  ds_read_b64_tr_b16 a[82:83], v5 offset:2056
  ds_read_b64_tr_b16 a[84:85], v5 offset:8200
  ds_read_b64_tr_b16 a[86:87], v5 offset:10248
  ds_read_b64_tr_b16 a[24:25], v5 offset:16384
  ds_read_b64_tr_b16 a[26:27], v5 offset:18432
  ds_read_b64_tr_b16 a[28:29], v5 offset:24576
  ds_read_b64_tr_b16 a[30:31], v5 offset:26624
  ds_read_b64_tr_b16 a[88:89], v5 offset:16392
  ds_read_b64_tr_b16 a[90:91], v5 offset:18440
  ds_read_b64_tr_b16 a[92:93], v5 offset:24584
  ds_read_b64_tr_b16 a[94:95], v5 offset:26632
  s_branch RCE_53
RCN_54:
  s_cmp_lg_u32 s56, 1
  s_cbranch_scc1 RCN_55
  v_add_u32 v5, 0x10000, v13
  ds_read_b64_tr_b16 a[0:1], v5 offset:0
  ds_read_b64_tr_b16 a[2:3], v5 offset:2048
  ds_read_b64_tr_b16 a[4:5], v5 offset:8192
  ds_read_b64_tr_b16 a[6:7], v5 offset:10240
  ds_read_b64_tr_b16 a[64:65], v5 offset:8
  ds_read_b64_tr_b16 a[66:67], v5 offset:2056
  ds_read_b64_tr_b16 a[68:69], v5 offset:8200
  ds_read_b64_tr_b16 a[70:71], v5 offset:10248
  ds_read_b64_tr_b16 a[8:9], v5 offset:16384
  ds_read_b64_tr_b16 a[10:11], v5 offset:18432
  ds_read_b64_tr_b16 a[12:13], v5 offset:24576
  ds_read_b64_tr_b16 a[14:15], v5 offset:26624
  ds_read_b64_tr_b16 a[72:73], v5 offset:16392
  ds_read_b64_tr_b16 a[74:75], v5 offset:18440
  ds_read_b64_tr_b16 a[76:77], v5 offset:24584
  ds_read_b64_tr_b16 a[78:79], v5 offset:26632
  s_branch RCE_53
RCN_55:
  s_cmp_lg_u32 s56, 2
  s_cbranch_scc1 RCN_56
  v_add_u32 v5, 0x10000, v13
  ds_read_b64_tr_b16 a[48:49], v5 offset:0
  ds_read_b64_tr_b16 a[50:51], v5 offset:2048
  ds_read_b64_tr_b16 a[52:53], v5 offset:8192
  ds_read_b64_tr_b16 a[54:55], v5 offset:10240
  ds_read_b64_tr_b16 a[112:113], v5 offset:8
  ds_read_b64_tr_b16 a[114:115], v5 offset:2056
  ds_read_b64_tr_b16 a[116:117], v5 offset:8200
  ds_read_b64_tr_b16 a[118:119], v5 offset:10248
  ds_read_b64_tr_b16 a[56:57], v5 offset:16384
  ds_read_b64_tr_b16 a[58:59], v5 offset:18432
  ds_read_b64_tr_b16 a[60:61], v5 offset:24576
  ds_read_b64_tr_b16 a[62:63], v5 offset:26624
  ds_read_b64_tr_b16 a[120:121], v5 offset:16392
  ds_read_b64_tr_b16 a[122:123], v5 offset:18440
  ds_read_b64_tr_b16 a[124:125], v5 offset:24584
  ds_read_b64_tr_b16 a[126:127], v5 offset:26632
  s_branch RCE_53
RCN_56:
  v_add_u32 v5, 0x10000, v13
  ds_read_b64_tr_b16 a[32:33], v5 offset:0
  ds_read_b64_tr_b16 a[34:35], v5 offset:2048
  ds_read_b64_tr_b16 a[36:37], v5 offset:8192
  ds_read_b64_tr_b16 a[38:39], v5 offset:10240
  ds_read_b64_tr_b16 a[96:97], v5 offset:8
  ds_read_b64_tr_b16 a[98:99], v5 offset:2056
  ds_read_b64_tr_b16 a[100:101], v5 offset:8200
  ds_read_b64_tr_b16 a[102:103], v5 offset:10248
  ds_read_b64_tr_b16 a[40:41], v5 offset:16384
  ds_read_b64_tr_b16 a[42:43], v5 offset:18432
  ds_read_b64_tr_b16 a[44:45], v5 offset:24576
  ds_read_b64_tr_b16 a[46:47], v5 offset:26624
  ds_read_b64_tr_b16 a[104:105], v5 offset:16392
  ds_read_b64_tr_b16 a[106:107], v5 offset:18440
  ds_read_b64_tr_b16 a[108:109], v5 offset:24584
  ds_read_b64_tr_b16 a[110:111], v5 offset:26632
RCE_53:
  s_waitcnt lgkmcnt(0)
  s_waitcnt vmcnt(24)
  s_barrier
  s_lshl_b32 s73, s56, 13
  s_add_u32 m0, s73, 131072
  s_add_u32 s73, s74, 2097152
  buffer_load_dwordx4 v16, s[44:47], s73 offen lds
  s_add_u32 m0, m0, 1024
  s_add_u32 s73, s73, 32768
  buffer_load_dwordx4 v16, s[44:47], s73 offen lds
  s_add_u32 m0, m0, 1024
  s_add_u32 s73, s73, 32768
  buffer_load_dwordx4 v16, s[44:47], s73 offen lds
  s_add_u32 m0, m0, 1024
  s_add_u32 s73, s73, 32768
  buffer_load_dwordx4 v16, s[44:47], s73 offen lds
  s_add_u32 m0, m0, 1024
  s_add_u32 s73, s73, 32768
  buffer_load_dwordx4 v16, s[44:47], s73 offen lds
  s_add_u32 m0, m0, 1024
  s_add_u32 s73, s73, 32768
  buffer_load_dwordx4 v16, s[44:47], s73 offen lds
  s_add_u32 m0, m0, 1024
  s_add_u32 s73, s73, 32768
  buffer_load_dwordx4 v16, s[44:47], s73 offen lds
  s_add_u32 m0, m0, 1024
  s_add_u32 s73, s73, 32768
  buffer_load_dwordx4 v16, s[44:47], s73 offen lds
  s_cmp_lg_u32 s56, 0
  s_cbranch_scc1 RCN_59
  ds_read_b64_tr_b16 a[32:33], v12 offset:0
  ds_read_b64_tr_b16 a[34:35], v12 offset:2048
  ds_read_b64_tr_b16 a[36:37], v12 offset:8192
  ds_read_b64_tr_b16 a[38:39], v12 offset:10240
  ds_read_b64_tr_b16 a[96:97], v12 offset:8
  ds_read_b64_tr_b16 a[98:99], v12 offset:2056
  ds_read_b64_tr_b16 a[100:101], v12 offset:8200
  ds_read_b64_tr_b16 a[102:103], v12 offset:10248
  ds_read_b64_tr_b16 a[40:41], v12 offset:16384
  ds_read_b64_tr_b16 a[42:43], v12 offset:18432
  ds_read_b64_tr_b16 a[44:45], v12 offset:24576
  ds_read_b64_tr_b16 a[46:47], v12 offset:26624
  ds_read_b64_tr_b16 a[104:105], v12 offset:16392
  ds_read_b64_tr_b16 a[106:107], v12 offset:18440
  ds_read_b64_tr_b16 a[108:109], v12 offset:24584
  ds_read_b64_tr_b16 a[110:111], v12 offset:26632
  s_branch RCE_58
RCN_59:
  s_cmp_lg_u32 s56, 1
  s_cbranch_scc1 RCN_60
  ds_read_b64_tr_b16 a[48:49], v12 offset:0
  ds_read_b64_tr_b16 a[50:51], v12 offset:2048
  ds_read_b64_tr_b16 a[52:53], v12 offset:8192
  ds_read_b64_tr_b16 a[54:55], v12 offset:10240
  ds_read_b64_tr_b16 a[112:113], v12 offset:8
  ds_read_b64_tr_b16 a[114:115], v12 offset:2056
  ds_read_b64_tr_b16 a[116:117], v12 offset:8200
  ds_read_b64_tr_b16 a[118:119], v12 offset:10248
  ds_read_b64_tr_b16 a[56:57], v12 offset:16384
  ds_read_b64_tr_b16 a[58:59], v12 offset:18432
  ds_read_b64_tr_b16 a[60:61], v12 offset:24576
  ds_read_b64_tr_b16 a[62:63], v12 offset:26624
  ds_read_b64_tr_b16 a[120:121], v12 offset:16392
  ds_read_b64_tr_b16 a[122:123], v12 offset:18440
  ds_read_b64_tr_b16 a[124:125], v12 offset:24584
  ds_read_b64_tr_b16 a[126:127], v12 offset:26632
  s_branch RCE_58
RCN_60:
  s_cmp_lg_u32 s56, 2
  s_cbranch_scc1 RCN_61
  ds_read_b64_tr_b16 a[0:1], v12 offset:0
  ds_read_b64_tr_b16 a[2:3], v12 offset:2048
  ds_read_b64_tr_b16 a[4:5], v12 offset:8192
  ds_read_b64_tr_b16 a[6:7], v12 offset:10240
  ds_read_b64_tr_b16 a[64:65], v12 offset:8
  ds_read_b64_tr_b16 a[66:67], v12 offset:2056
  ds_read_b64_tr_b16 a[68:69], v12 offset:8200
  ds_read_b64_tr_b16 a[70:71], v12 offset:10248
  ds_read_b64_tr_b16 a[8:9], v12 offset:16384
  ds_read_b64_tr_b16 a[10:11], v12 offset:18432
  ds_read_b64_tr_b16 a[12:13], v12 offset:24576
  ds_read_b64_tr_b16 a[14:15], v12 offset:26624
  ds_read_b64_tr_b16 a[72:73], v12 offset:16392
  ds_read_b64_tr_b16 a[74:75], v12 offset:18440
  ds_read_b64_tr_b16 a[76:77], v12 offset:24584
  ds_read_b64_tr_b16 a[78:79], v12 offset:26632
  s_branch RCE_58
RCN_61:
  ds_read_b64_tr_b16 a[16:17], v12 offset:0
  ds_read_b64_tr_b16 a[18:19], v12 offset:2048
  ds_read_b64_tr_b16 a[20:21], v12 offset:8192
  ds_read_b64_tr_b16 a[22:23], v12 offset:10240
  ds_read_b64_tr_b16 a[80:81], v12 offset:8
  ds_read_b64_tr_b16 a[82:83], v12 offset:2056
  ds_read_b64_tr_b16 a[84:85], v12 offset:8200
  ds_read_b64_tr_b16 a[86:87], v12 offset:10248
  ds_read_b64_tr_b16 a[24:25], v12 offset:16384
  ds_read_b64_tr_b16 a[26:27], v12 offset:18432
  ds_read_b64_tr_b16 a[28:29], v12 offset:24576
  ds_read_b64_tr_b16 a[30:31], v12 offset:26624
  ds_read_b64_tr_b16 a[88:89], v12 offset:16392
  ds_read_b64_tr_b16 a[90:91], v12 offset:18440
  ds_read_b64_tr_b16 a[92:93], v12 offset:24584
  ds_read_b64_tr_b16 a[94:95], v12 offset:26632
RCE_58:
  s_waitcnt lgkmcnt(0)
  s_waitcnt vmcnt(24)
  s_barrier
  s_lshl_b32 s73, s56, 13
  s_add_u32 m0, s73, 0
  s_add_u32 s73, s74, 3145728
  buffer_load_dwordx4 v16, s[44:47], s73 offen lds
  s_add_u32 m0, m0, 1024
  s_add_u32 s73, s73, 32768
  buffer_load_dwordx4 v16, s[44:47], s73 offen lds
  s_add_u32 m0, m0, 1024
  s_add_u32 s73, s73, 32768
  buffer_load_dwordx4 v16, s[44:47], s73 offen lds
  s_add_u32 m0, m0, 1024
  s_add_u32 s73, s73, 32768
  buffer_load_dwordx4 v16, s[44:47], s73 offen lds
  s_add_u32 m0, m0, 1024
  s_add_u32 s73, s73, 32768
  buffer_load_dwordx4 v16, s[44:47], s73 offen lds
  s_add_u32 m0, m0, 1024
  s_add_u32 s73, s73, 32768
  buffer_load_dwordx4 v16, s[44:47], s73 offen lds
  s_add_u32 m0, m0, 1024
  s_add_u32 s73, s73, 32768
  buffer_load_dwordx4 v16, s[44:47], s73 offen lds
  s_add_u32 m0, m0, 1024
  s_add_u32 s73, s73, 32768
  buffer_load_dwordx4 v16, s[44:47], s73 offen lds
  s_cmp_lg_u32 s56, 0
  s_cbranch_scc1 RCN_64
  ds_read_b64_tr_b16 a[48:49], v12 offset:32768
  ds_read_b64_tr_b16 a[50:51], v12 offset:34816
  ds_read_b64_tr_b16 a[52:53], v12 offset:40960
  ds_read_b64_tr_b16 a[54:55], v12 offset:43008
  ds_read_b64_tr_b16 a[112:113], v12 offset:32776
  ds_read_b64_tr_b16 a[114:115], v12 offset:34824
  ds_read_b64_tr_b16 a[116:117], v12 offset:40968
  ds_read_b64_tr_b16 a[118:119], v12 offset:43016
  ds_read_b64_tr_b16 a[56:57], v12 offset:49152
  ds_read_b64_tr_b16 a[58:59], v12 offset:51200
  ds_read_b64_tr_b16 a[60:61], v12 offset:57344
  ds_read_b64_tr_b16 a[62:63], v12 offset:59392
  ds_read_b64_tr_b16 a[120:121], v12 offset:49160
  ds_read_b64_tr_b16 a[122:123], v12 offset:51208
  ds_read_b64_tr_b16 a[124:125], v12 offset:57352
  ds_read_b64_tr_b16 a[126:127], v12 offset:59400
  s_branch RCE_63
RCN_64:
  s_cmp_lg_u32 s56, 1
  s_cbranch_scc1 RCN_65
  ds_read_b64_tr_b16 a[32:33], v12 offset:32768
  ds_read_b64_tr_b16 a[34:35], v12 offset:34816
  ds_read_b64_tr_b16 a[36:37], v12 offset:40960
  ds_read_b64_tr_b16 a[38:39], v12 offset:43008
  ds_read_b64_tr_b16 a[96:97], v12 offset:32776
  ds_read_b64_tr_b16 a[98:99], v12 offset:34824
  ds_read_b64_tr_b16 a[100:101], v12 offset:40968
  ds_read_b64_tr_b16 a[102:103], v12 offset:43016
  ds_read_b64_tr_b16 a[40:41], v12 offset:49152
  ds_read_b64_tr_b16 a[42:43], v12 offset:51200
  ds_read_b64_tr_b16 a[44:45], v12 offset:57344
  ds_read_b64_tr_b16 a[46:47], v12 offset:59392
  ds_read_b64_tr_b16 a[104:105], v12 offset:49160
  ds_read_b64_tr_b16 a[106:107], v12 offset:51208
  ds_read_b64_tr_b16 a[108:109], v12 offset:57352
  ds_read_b64_tr_b16 a[110:111], v12 offset:59400
  s_branch RCE_63
RCN_65:
  s_cmp_lg_u32 s56, 2
  s_cbranch_scc1 RCN_66
  ds_read_b64_tr_b16 a[16:17], v12 offset:32768
  ds_read_b64_tr_b16 a[18:19], v12 offset:34816
  ds_read_b64_tr_b16 a[20:21], v12 offset:40960
  ds_read_b64_tr_b16 a[22:23], v12 offset:43008
  ds_read_b64_tr_b16 a[80:81], v12 offset:32776
  ds_read_b64_tr_b16 a[82:83], v12 offset:34824
  ds_read_b64_tr_b16 a[84:85], v12 offset:40968
  ds_read_b64_tr_b16 a[86:87], v12 offset:43016
  ds_read_b64_tr_b16 a[24:25], v12 offset:49152
  ds_read_b64_tr_b16 a[26:27], v12 offset:51200
  ds_read_b64_tr_b16 a[28:29], v12 offset:57344
  ds_read_b64_tr_b16 a[30:31], v12 offset:59392
  ds_read_b64_tr_b16 a[88:89], v12 offset:49160
  ds_read_b64_tr_b16 a[90:91], v12 offset:51208
  ds_read_b64_tr_b16 a[92:93], v12 offset:57352
  ds_read_b64_tr_b16 a[94:95], v12 offset:59400
  s_branch RCE_63
RCN_66:
  ds_read_b64_tr_b16 a[0:1], v12 offset:32768
  ds_read_b64_tr_b16 a[2:3], v12 offset:34816
  ds_read_b64_tr_b16 a[4:5], v12 offset:40960
  ds_read_b64_tr_b16 a[6:7], v12 offset:43008
  ds_read_b64_tr_b16 a[64:65], v12 offset:32776
  ds_read_b64_tr_b16 a[66:67], v12 offset:34824
  ds_read_b64_tr_b16 a[68:69], v12 offset:40968
  ds_read_b64_tr_b16 a[70:71], v12 offset:43016
  ds_read_b64_tr_b16 a[8:9], v12 offset:49152
  ds_read_b64_tr_b16 a[10:11], v12 offset:51200
  ds_read_b64_tr_b16 a[12:13], v12 offset:57344
  ds_read_b64_tr_b16 a[14:15], v12 offset:59392
  ds_read_b64_tr_b16 a[72:73], v12 offset:49160
  ds_read_b64_tr_b16 a[74:75], v12 offset:51208
  ds_read_b64_tr_b16 a[76:77], v12 offset:57352
  ds_read_b64_tr_b16 a[78:79], v12 offset:59400
RCE_63:
  s_waitcnt lgkmcnt(0)
  s_waitcnt vmcnt(24)
  s_barrier
  s_lshl_b32 s73, s56, 13
  s_add_u32 m0, s73, 32768
  s_add_u32 s73, s74, 0
  buffer_load_dwordx4 v16, s[48:51], s73 offen lds
  s_add_u32 m0, m0, 1024
  s_add_u32 s73, s73, 32768
  buffer_load_dwordx4 v16, s[48:51], s73 offen lds
  s_add_u32 m0, m0, 1024
  s_add_u32 s73, s73, 32768
  buffer_load_dwordx4 v16, s[48:51], s73 offen lds
  s_add_u32 m0, m0, 1024
  s_add_u32 s73, s73, 32768
  buffer_load_dwordx4 v16, s[48:51], s73 offen lds
  s_add_u32 m0, m0, 1024
  s_add_u32 s73, s73, 32768
  buffer_load_dwordx4 v16, s[48:51], s73 offen lds
  s_add_u32 m0, m0, 1024
  s_add_u32 s73, s73, 32768
  buffer_load_dwordx4 v16, s[48:51], s73 offen lds
  s_add_u32 m0, m0, 1024
  s_add_u32 s73, s73, 32768
  buffer_load_dwordx4 v16, s[48:51], s73 offen lds
  s_add_u32 m0, m0, 1024
  s_add_u32 s73, s73, 32768
  buffer_load_dwordx4 v16, s[48:51], s73 offen lds
  s_cmp_lg_u32 s56, 0
  s_cbranch_scc1 RCN_69
  ds_read_b64_tr_b16 a[128:129], v13 offset:0
  ds_read_b64_tr_b16 a[130:131], v13 offset:2048
  ds_read_b64_tr_b16 a[132:133], v13 offset:8192
  ds_read_b64_tr_b16 a[134:135], v13 offset:10240
  ds_read_b64_tr_b16 a[192:193], v13 offset:8
  ds_read_b64_tr_b16 a[194:195], v13 offset:2056
  ds_read_b64_tr_b16 a[196:197], v13 offset:8200
  ds_read_b64_tr_b16 a[198:199], v13 offset:10248
  ds_read_b64_tr_b16 a[136:137], v13 offset:16384
  ds_read_b64_tr_b16 a[138:139], v13 offset:18432
  ds_read_b64_tr_b16 a[140:141], v13 offset:24576
  ds_read_b64_tr_b16 a[142:143], v13 offset:26624
  ds_read_b64_tr_b16 a[200:201], v13 offset:16392
  ds_read_b64_tr_b16 a[202:203], v13 offset:18440
  ds_read_b64_tr_b16 a[204:205], v13 offset:24584
  ds_read_b64_tr_b16 a[206:207], v13 offset:26632
  s_branch RCE_68
RCN_69:
  s_cmp_lg_u32 s56, 1
  s_cbranch_scc1 RCN_70
  ds_read_b64_tr_b16 a[144:145], v13 offset:0
  ds_read_b64_tr_b16 a[146:147], v13 offset:2048
  ds_read_b64_tr_b16 a[148:149], v13 offset:8192
  ds_read_b64_tr_b16 a[150:151], v13 offset:10240
  ds_read_b64_tr_b16 a[208:209], v13 offset:8
  ds_read_b64_tr_b16 a[210:211], v13 offset:2056
  ds_read_b64_tr_b16 a[212:213], v13 offset:8200
  ds_read_b64_tr_b16 a[214:215], v13 offset:10248
  ds_read_b64_tr_b16 a[152:153], v13 offset:16384
  ds_read_b64_tr_b16 a[154:155], v13 offset:18432
  ds_read_b64_tr_b16 a[156:157], v13 offset:24576
  ds_read_b64_tr_b16 a[158:159], v13 offset:26624
  ds_read_b64_tr_b16 a[216:217], v13 offset:16392
  ds_read_b64_tr_b16 a[218:219], v13 offset:18440
  ds_read_b64_tr_b16 a[220:221], v13 offset:24584
  ds_read_b64_tr_b16 a[222:223], v13 offset:26632
  s_branch RCE_68
RCN_70:
  s_cmp_lg_u32 s56, 2
  s_cbranch_scc1 RCN_71
  ds_read_b64_tr_b16 a[160:161], v13 offset:0
  ds_read_b64_tr_b16 a[162:163], v13 offset:2048
  ds_read_b64_tr_b16 a[164:165], v13 offset:8192
  ds_read_b64_tr_b16 a[166:167], v13 offset:10240
  ds_read_b64_tr_b16 a[224:225], v13 offset:8
  ds_read_b64_tr_b16 a[226:227], v13 offset:2056
  ds_read_b64_tr_b16 a[228:229], v13 offset:8200
  ds_read_b64_tr_b16 a[230:231], v13 offset:10248
  ds_read_b64_tr_b16 a[168:169], v13 offset:16384
  ds_read_b64_tr_b16 a[170:171], v13 offset:18432
  ds_read_b64_tr_b16 a[172:173], v13 offset:24576
  ds_read_b64_tr_b16 a[174:175], v13 offset:26624
  ds_read_b64_tr_b16 a[232:233], v13 offset:16392
  ds_read_b64_tr_b16 a[234:235], v13 offset:18440
  ds_read_b64_tr_b16 a[236:237], v13 offset:24584
  ds_read_b64_tr_b16 a[238:239], v13 offset:26632
  s_branch RCE_68
RCN_71:
  ds_read_b64_tr_b16 a[176:177], v13 offset:0
  ds_read_b64_tr_b16 a[178:179], v13 offset:2048
  ds_read_b64_tr_b16 a[180:181], v13 offset:8192
  ds_read_b64_tr_b16 a[182:183], v13 offset:10240
  ds_read_b64_tr_b16 a[240:241], v13 offset:8
  ds_read_b64_tr_b16 a[242:243], v13 offset:2056
  ds_read_b64_tr_b16 a[244:245], v13 offset:8200
  ds_read_b64_tr_b16 a[246:247], v13 offset:10248
  ds_read_b64_tr_b16 a[184:185], v13 offset:16384
  ds_read_b64_tr_b16 a[186:187], v13 offset:18432
  ds_read_b64_tr_b16 a[188:189], v13 offset:24576
  ds_read_b64_tr_b16 a[190:191], v13 offset:26624
  ds_read_b64_tr_b16 a[248:249], v13 offset:16392
  ds_read_b64_tr_b16 a[250:251], v13 offset:18440
  ds_read_b64_tr_b16 a[252:253], v13 offset:24584
  ds_read_b64_tr_b16 a[254:255], v13 offset:26632
RCE_68:
  s_waitcnt lgkmcnt(0)
  s_waitcnt vmcnt(24)
  s_barrier
  s_lshl_b32 s73, s56, 13
  s_add_u32 m0, s73, 65536
  s_add_u32 s73, s74, 1048576
  buffer_load_dwordx4 v16, s[48:51], s73 offen lds
  s_add_u32 m0, m0, 1024
  s_add_u32 s73, s73, 32768
  buffer_load_dwordx4 v16, s[48:51], s73 offen lds
  s_add_u32 m0, m0, 1024
  s_add_u32 s73, s73, 32768
  buffer_load_dwordx4 v16, s[48:51], s73 offen lds
  s_add_u32 m0, m0, 1024
  s_add_u32 s73, s73, 32768
  buffer_load_dwordx4 v16, s[48:51], s73 offen lds
  s_add_u32 m0, m0, 1024
  s_add_u32 s73, s73, 32768
  buffer_load_dwordx4 v16, s[48:51], s73 offen lds
  s_add_u32 m0, m0, 1024
  s_add_u32 s73, s73, 32768
  buffer_load_dwordx4 v16, s[48:51], s73 offen lds
  s_add_u32 m0, m0, 1024
  s_add_u32 s73, s73, 32768
  buffer_load_dwordx4 v16, s[48:51], s73 offen lds
  s_add_u32 m0, m0, 1024
  s_add_u32 s73, s73, 32768
  buffer_load_dwordx4 v16, s[48:51], s73 offen lds
  s_cmp_lg_u32 s56, 0
  s_cbranch_scc1 RCN_74
  ds_read_b64_tr_b16 a[144:145], v13 offset:32768
  ds_read_b64_tr_b16 a[146:147], v13 offset:34816
  ds_read_b64_tr_b16 a[148:149], v13 offset:40960
  ds_read_b64_tr_b16 a[150:151], v13 offset:43008
  ds_read_b64_tr_b16 a[208:209], v13 offset:32776
  ds_read_b64_tr_b16 a[210:211], v13 offset:34824
  ds_read_b64_tr_b16 a[212:213], v13 offset:40968
  ds_read_b64_tr_b16 a[214:215], v13 offset:43016
  ds_read_b64_tr_b16 a[152:153], v13 offset:49152
  ds_read_b64_tr_b16 a[154:155], v13 offset:51200
  ds_read_b64_tr_b16 a[156:157], v13 offset:57344
  ds_read_b64_tr_b16 a[158:159], v13 offset:59392
  ds_read_b64_tr_b16 a[216:217], v13 offset:49160
  ds_read_b64_tr_b16 a[218:219], v13 offset:51208
  ds_read_b64_tr_b16 a[220:221], v13 offset:57352
  ds_read_b64_tr_b16 a[222:223], v13 offset:59400
  s_branch RCE_73
RCN_74:
  s_cmp_lg_u32 s56, 1
  s_cbranch_scc1 RCN_75
  ds_read_b64_tr_b16 a[128:129], v13 offset:32768
  ds_read_b64_tr_b16 a[130:131], v13 offset:34816
  ds_read_b64_tr_b16 a[132:133], v13 offset:40960
  ds_read_b64_tr_b16 a[134:135], v13 offset:43008
  ds_read_b64_tr_b16 a[192:193], v13 offset:32776
  ds_read_b64_tr_b16 a[194:195], v13 offset:34824
  ds_read_b64_tr_b16 a[196:197], v13 offset:40968
  ds_read_b64_tr_b16 a[198:199], v13 offset:43016
  ds_read_b64_tr_b16 a[136:137], v13 offset:49152
  ds_read_b64_tr_b16 a[138:139], v13 offset:51200
  ds_read_b64_tr_b16 a[140:141], v13 offset:57344
  ds_read_b64_tr_b16 a[142:143], v13 offset:59392
  ds_read_b64_tr_b16 a[200:201], v13 offset:49160
  ds_read_b64_tr_b16 a[202:203], v13 offset:51208
  ds_read_b64_tr_b16 a[204:205], v13 offset:57352
  ds_read_b64_tr_b16 a[206:207], v13 offset:59400
  s_branch RCE_73
RCN_75:
  s_cmp_lg_u32 s56, 2
  s_cbranch_scc1 RCN_76
  ds_read_b64_tr_b16 a[176:177], v13 offset:32768
  ds_read_b64_tr_b16 a[178:179], v13 offset:34816
  ds_read_b64_tr_b16 a[180:181], v13 offset:40960
  ds_read_b64_tr_b16 a[182:183], v13 offset:43008
  ds_read_b64_tr_b16 a[240:241], v13 offset:32776
  ds_read_b64_tr_b16 a[242:243], v13 offset:34824
  ds_read_b64_tr_b16 a[244:245], v13 offset:40968
  ds_read_b64_tr_b16 a[246:247], v13 offset:43016
  ds_read_b64_tr_b16 a[184:185], v13 offset:49152
  ds_read_b64_tr_b16 a[186:187], v13 offset:51200
  ds_read_b64_tr_b16 a[188:189], v13 offset:57344
  ds_read_b64_tr_b16 a[190:191], v13 offset:59392
  ds_read_b64_tr_b16 a[248:249], v13 offset:49160
  ds_read_b64_tr_b16 a[250:251], v13 offset:51208
  ds_read_b64_tr_b16 a[252:253], v13 offset:57352
  ds_read_b64_tr_b16 a[254:255], v13 offset:59400
  s_branch RCE_73
RCN_76:
  ds_read_b64_tr_b16 a[160:161], v13 offset:32768
  ds_read_b64_tr_b16 a[162:163], v13 offset:34816
  ds_read_b64_tr_b16 a[164:165], v13 offset:40960
  ds_read_b64_tr_b16 a[166:167], v13 offset:43008
  ds_read_b64_tr_b16 a[224:225], v13 offset:32776
  ds_read_b64_tr_b16 a[226:227], v13 offset:34824
  ds_read_b64_tr_b16 a[228:229], v13 offset:40968
  ds_read_b64_tr_b16 a[230:231], v13 offset:43016
  ds_read_b64_tr_b16 a[168:169], v13 offset:49152
  ds_read_b64_tr_b16 a[170:171], v13 offset:51200
  ds_read_b64_tr_b16 a[172:173], v13 offset:57344
  ds_read_b64_tr_b16 a[174:175], v13 offset:59392
  ds_read_b64_tr_b16 a[232:233], v13 offset:49160
  ds_read_b64_tr_b16 a[234:235], v13 offset:51208
  ds_read_b64_tr_b16 a[236:237], v13 offset:57352
  ds_read_b64_tr_b16 a[238:239], v13 offset:59400
RCE_73:
  s_waitcnt lgkmcnt(0)
  s_waitcnt vmcnt(24)
  s_barrier
  s_cmp_lg_u32 s56, 0
  s_cbranch_scc1 IA_78
  s_mov_b64 exec, 1
  v_mov_b32 v30, 1
  v_mov_b32 v31, 136
  buffer_atomic_add v30, v31, s[36:39], s93 offen
  s_mov_b64 exec, -1
IA_78:
  s_lshl_b32 s73, s56, 13
  s_add_u32 m0, s73, 98304
  s_add_u32 s73, s75, 0
  buffer_load_dwordx4 v17, s[52:55], s73 offen lds
  s_add_u32 m0, m0, 1024
  s_add_u32 s73, s73, 8192
  buffer_load_dwordx4 v17, s[52:55], s73 offen lds
  s_add_u32 m0, m0, 1024
  s_add_u32 s73, s73, 8192
  buffer_load_dwordx4 v17, s[52:55], s73 offen lds
  s_add_u32 m0, m0, 1024
  s_add_u32 s73, s73, 8192
  buffer_load_dwordx4 v17, s[52:55], s73 offen lds
  s_add_u32 m0, m0, 1024
  s_add_u32 s73, s73, 8192
  buffer_load_dwordx4 v17, s[52:55], s73 offen lds
  s_add_u32 m0, m0, 1024
  s_add_u32 s73, s73, 8192
  buffer_load_dwordx4 v17, s[52:55], s73 offen lds
  s_add_u32 m0, m0, 1024
  s_add_u32 s73, s73, 8192
  buffer_load_dwordx4 v17, s[52:55], s73 offen lds
  s_add_u32 m0, m0, 1024
  s_add_u32 s73, s73, 8192
  buffer_load_dwordx4 v17, s[52:55], s73 offen lds
  s_cmp_lg_u32 s56, 0
  s_cbranch_scc1 RCN_80
  v_add_u32 v5, 0x10000, v13
  ds_read_b64_tr_b16 a[160:161], v5 offset:0
  ds_read_b64_tr_b16 a[162:163], v5 offset:2048
  ds_read_b64_tr_b16 a[164:165], v5 offset:8192
  ds_read_b64_tr_b16 a[166:167], v5 offset:10240
  ds_read_b64_tr_b16 a[224:225], v5 offset:8
  ds_read_b64_tr_b16 a[226:227], v5 offset:2056
  ds_read_b64_tr_b16 a[228:229], v5 offset:8200
  ds_read_b64_tr_b16 a[230:231], v5 offset:10248
  ds_read_b64_tr_b16 a[168:169], v5 offset:16384
  ds_read_b64_tr_b16 a[170:171], v5 offset:18432
  ds_read_b64_tr_b16 a[172:173], v5 offset:24576
  ds_read_b64_tr_b16 a[174:175], v5 offset:26624
  ds_read_b64_tr_b16 a[232:233], v5 offset:16392
  ds_read_b64_tr_b16 a[234:235], v5 offset:18440
  ds_read_b64_tr_b16 a[236:237], v5 offset:24584
  ds_read_b64_tr_b16 a[238:239], v5 offset:26632
  s_branch RCE_79
RCN_80:
  s_cmp_lg_u32 s56, 1
  s_cbranch_scc1 RCN_81
  v_add_u32 v5, 0x10000, v13
  ds_read_b64_tr_b16 a[176:177], v5 offset:0
  ds_read_b64_tr_b16 a[178:179], v5 offset:2048
  ds_read_b64_tr_b16 a[180:181], v5 offset:8192
  ds_read_b64_tr_b16 a[182:183], v5 offset:10240
  ds_read_b64_tr_b16 a[240:241], v5 offset:8
  ds_read_b64_tr_b16 a[242:243], v5 offset:2056
  ds_read_b64_tr_b16 a[244:245], v5 offset:8200
  ds_read_b64_tr_b16 a[246:247], v5 offset:10248
  ds_read_b64_tr_b16 a[184:185], v5 offset:16384
  ds_read_b64_tr_b16 a[186:187], v5 offset:18432
  ds_read_b64_tr_b16 a[188:189], v5 offset:24576
  ds_read_b64_tr_b16 a[190:191], v5 offset:26624
  ds_read_b64_tr_b16 a[248:249], v5 offset:16392
  ds_read_b64_tr_b16 a[250:251], v5 offset:18440
  ds_read_b64_tr_b16 a[252:253], v5 offset:24584
  ds_read_b64_tr_b16 a[254:255], v5 offset:26632
  s_branch RCE_79
RCN_81:
  s_cmp_lg_u32 s56, 2
  s_cbranch_scc1 RCN_82
  v_add_u32 v5, 0x10000, v13
  ds_read_b64_tr_b16 a[128:129], v5 offset:0
  ds_read_b64_tr_b16 a[130:131], v5 offset:2048
  ds_read_b64_tr_b16 a[132:133], v5 offset:8192
  ds_read_b64_tr_b16 a[134:135], v5 offset:10240
  ds_read_b64_tr_b16 a[192:193], v5 offset:8
  ds_read_b64_tr_b16 a[194:195], v5 offset:2056
  ds_read_b64_tr_b16 a[196:197], v5 offset:8200
  ds_read_b64_tr_b16 a[198:199], v5 offset:10248
  ds_read_b64_tr_b16 a[136:137], v5 offset:16384
  ds_read_b64_tr_b16 a[138:139], v5 offset:18432
  ds_read_b64_tr_b16 a[140:141], v5 offset:24576
  ds_read_b64_tr_b16 a[142:143], v5 offset:26624
  ds_read_b64_tr_b16 a[200:201], v5 offset:16392
  ds_read_b64_tr_b16 a[202:203], v5 offset:18440
  ds_read_b64_tr_b16 a[204:205], v5 offset:24584
  ds_read_b64_tr_b16 a[206:207], v5 offset:26632
  s_branch RCE_79
RCN_82:
  v_add_u32 v5, 0x10000, v13
  ds_read_b64_tr_b16 a[144:145], v5 offset:0
  ds_read_b64_tr_b16 a[146:147], v5 offset:2048
  ds_read_b64_tr_b16 a[148:149], v5 offset:8192
  ds_read_b64_tr_b16 a[150:151], v5 offset:10240
  ds_read_b64_tr_b16 a[208:209], v5 offset:8
  ds_read_b64_tr_b16 a[210:211], v5 offset:2056
  ds_read_b64_tr_b16 a[212:213], v5 offset:8200
  ds_read_b64_tr_b16 a[214:215], v5 offset:10248
  ds_read_b64_tr_b16 a[152:153], v5 offset:16384
  ds_read_b64_tr_b16 a[154:155], v5 offset:18432
  ds_read_b64_tr_b16 a[156:157], v5 offset:24576
  ds_read_b64_tr_b16 a[158:159], v5 offset:26624
  ds_read_b64_tr_b16 a[216:217], v5 offset:16392
  ds_read_b64_tr_b16 a[218:219], v5 offset:18440
  ds_read_b64_tr_b16 a[220:221], v5 offset:24584
  ds_read_b64_tr_b16 a[222:223], v5 offset:26632
RCE_79:
  s_waitcnt lgkmcnt(0)
  s_waitcnt vmcnt(24)
  s_barrier
  s_lshl_b32 s73, s56, 13
  s_add_u32 m0, s73, 131072
  s_add_u32 s73, s75, 65536
  buffer_load_dwordx4 v17, s[52:55], s73 offen lds
  s_add_u32 m0, m0, 1024
  s_add_u32 s73, s73, 8192
  buffer_load_dwordx4 v17, s[52:55], s73 offen lds
  s_add_u32 m0, m0, 1024
  s_add_u32 s73, s73, 8192
  buffer_load_dwordx4 v17, s[52:55], s73 offen lds
  s_add_u32 m0, m0, 1024
  s_add_u32 s73, s73, 8192
  buffer_load_dwordx4 v17, s[52:55], s73 offen lds
  s_add_u32 m0, m0, 1024
  s_add_u32 s73, s73, 8192
  buffer_load_dwordx4 v17, s[52:55], s73 offen lds
  s_add_u32 m0, m0, 1024
  s_add_u32 s73, s73, 8192
  buffer_load_dwordx4 v17, s[52:55], s73 offen lds
  s_add_u32 m0, m0, 1024
  s_add_u32 s73, s73, 8192
  buffer_load_dwordx4 v17, s[52:55], s73 offen lds
  s_add_u32 m0, m0, 1024
  s_add_u32 s73, s73, 8192
  buffer_load_dwordx4 v17, s[52:55], s73 offen lds
  s_cmp_lg_u32 s56, 0
  s_cbranch_scc1 RCN_85
  ds_read_b64_tr_b16 a[176:177], v12 offset:0
  ds_read_b64_tr_b16 a[178:179], v12 offset:2048
  ds_read_b64_tr_b16 a[180:181], v12 offset:8192
  ds_read_b64_tr_b16 a[182:183], v12 offset:10240
  ds_read_b64_tr_b16 a[240:241], v12 offset:8
  ds_read_b64_tr_b16 a[242:243], v12 offset:2056
  ds_read_b64_tr_b16 a[244:245], v12 offset:8200
  ds_read_b64_tr_b16 a[246:247], v12 offset:10248
  ds_read_b64_tr_b16 a[184:185], v12 offset:16384
  ds_read_b64_tr_b16 a[186:187], v12 offset:18432
  ds_read_b64_tr_b16 a[188:189], v12 offset:24576
  ds_read_b64_tr_b16 a[190:191], v12 offset:26624
  ds_read_b64_tr_b16 a[248:249], v12 offset:16392
  ds_read_b64_tr_b16 a[250:251], v12 offset:18440
  ds_read_b64_tr_b16 a[252:253], v12 offset:24584
  ds_read_b64_tr_b16 a[254:255], v12 offset:26632
  s_branch RCE_84
RCN_85:
  s_cmp_lg_u32 s56, 1
  s_cbranch_scc1 RCN_86
  ds_read_b64_tr_b16 a[160:161], v12 offset:0
  ds_read_b64_tr_b16 a[162:163], v12 offset:2048
  ds_read_b64_tr_b16 a[164:165], v12 offset:8192
  ds_read_b64_tr_b16 a[166:167], v12 offset:10240
  ds_read_b64_tr_b16 a[224:225], v12 offset:8
  ds_read_b64_tr_b16 a[226:227], v12 offset:2056
  ds_read_b64_tr_b16 a[228:229], v12 offset:8200
  ds_read_b64_tr_b16 a[230:231], v12 offset:10248
  ds_read_b64_tr_b16 a[168:169], v12 offset:16384
  ds_read_b64_tr_b16 a[170:171], v12 offset:18432
  ds_read_b64_tr_b16 a[172:173], v12 offset:24576
  ds_read_b64_tr_b16 a[174:175], v12 offset:26624
  ds_read_b64_tr_b16 a[232:233], v12 offset:16392
  ds_read_b64_tr_b16 a[234:235], v12 offset:18440
  ds_read_b64_tr_b16 a[236:237], v12 offset:24584
  ds_read_b64_tr_b16 a[238:239], v12 offset:26632
  s_branch RCE_84
RCN_86:
  s_cmp_lg_u32 s56, 2
  s_cbranch_scc1 RCN_87
  ds_read_b64_tr_b16 a[144:145], v12 offset:0
  ds_read_b64_tr_b16 a[146:147], v12 offset:2048
  ds_read_b64_tr_b16 a[148:149], v12 offset:8192
  ds_read_b64_tr_b16 a[150:151], v12 offset:10240
  ds_read_b64_tr_b16 a[208:209], v12 offset:8
  ds_read_b64_tr_b16 a[210:211], v12 offset:2056
  ds_read_b64_tr_b16 a[212:213], v12 offset:8200
  ds_read_b64_tr_b16 a[214:215], v12 offset:10248
  ds_read_b64_tr_b16 a[152:153], v12 offset:16384
  ds_read_b64_tr_b16 a[154:155], v12 offset:18432
  ds_read_b64_tr_b16 a[156:157], v12 offset:24576
  ds_read_b64_tr_b16 a[158:159], v12 offset:26624
  ds_read_b64_tr_b16 a[216:217], v12 offset:16392
  ds_read_b64_tr_b16 a[218:219], v12 offset:18440
  ds_read_b64_tr_b16 a[220:221], v12 offset:24584
  ds_read_b64_tr_b16 a[222:223], v12 offset:26632
  s_branch RCE_84
RCN_87:
  ds_read_b64_tr_b16 a[128:129], v12 offset:0
  ds_read_b64_tr_b16 a[130:131], v12 offset:2048
  ds_read_b64_tr_b16 a[132:133], v12 offset:8192
  ds_read_b64_tr_b16 a[134:135], v12 offset:10240
  ds_read_b64_tr_b16 a[192:193], v12 offset:8
  ds_read_b64_tr_b16 a[194:195], v12 offset:2056
  ds_read_b64_tr_b16 a[196:197], v12 offset:8200
  ds_read_b64_tr_b16 a[198:199], v12 offset:10248
  ds_read_b64_tr_b16 a[136:137], v12 offset:16384
  ds_read_b64_tr_b16 a[138:139], v12 offset:18432
  ds_read_b64_tr_b16 a[140:141], v12 offset:24576
  ds_read_b64_tr_b16 a[142:143], v12 offset:26624
  ds_read_b64_tr_b16 a[200:201], v12 offset:16392
  ds_read_b64_tr_b16 a[202:203], v12 offset:18440
  ds_read_b64_tr_b16 a[204:205], v12 offset:24584
  ds_read_b64_tr_b16 a[206:207], v12 offset:26632
RCE_84:
  s_waitcnt lgkmcnt(0)
  s_waitcnt vmcnt(24)
  s_barrier
  s_lshl_b32 s73, s56, 13
  s_add_u32 m0, s73, 0
  s_add_u32 s73, s74, 2097152
  buffer_load_dwordx4 v16, s[48:51], s73 offen lds
  s_add_u32 m0, m0, 1024
  s_add_u32 s73, s73, 32768
  buffer_load_dwordx4 v16, s[48:51], s73 offen lds
  s_add_u32 m0, m0, 1024
  s_add_u32 s73, s73, 32768
  buffer_load_dwordx4 v16, s[48:51], s73 offen lds
  s_add_u32 m0, m0, 1024
  s_add_u32 s73, s73, 32768
  buffer_load_dwordx4 v16, s[48:51], s73 offen lds
  s_add_u32 m0, m0, 1024
  s_add_u32 s73, s73, 32768
  buffer_load_dwordx4 v16, s[48:51], s73 offen lds
  s_add_u32 m0, m0, 1024
  s_add_u32 s73, s73, 32768
  buffer_load_dwordx4 v16, s[48:51], s73 offen lds
  s_add_u32 m0, m0, 1024
  s_add_u32 s73, s73, 32768
  buffer_load_dwordx4 v16, s[48:51], s73 offen lds
  s_add_u32 m0, m0, 1024
  s_add_u32 s73, s73, 32768
  buffer_load_dwordx4 v16, s[48:51], s73 offen lds
  ds_read_b64_tr_b16 v[128:129], v12 offset:32768
  ds_read_b64_tr_b16 v[130:131], v12 offset:34816
  ds_read_b64_tr_b16 v[132:133], v12 offset:40960
  ds_read_b64_tr_b16 v[134:135], v12 offset:43008
  ds_read_b64_tr_b16 v[136:137], v12 offset:32776
  ds_read_b64_tr_b16 v[138:139], v12 offset:34824
  ds_read_b64_tr_b16 v[140:141], v12 offset:40968
  ds_read_b64_tr_b16 v[142:143], v12 offset:43016
  ds_read_b64_tr_b16 v[144:145], v12 offset:49152
  ds_read_b64_tr_b16 v[146:147], v12 offset:51200
  ds_read_b64_tr_b16 v[148:149], v12 offset:57344
  ds_read_b64_tr_b16 v[150:151], v12 offset:59392
  ds_read_b64_tr_b16 v[152:153], v12 offset:49160
  ds_read_b64_tr_b16 v[154:155], v12 offset:51208
  ds_read_b64_tr_b16 v[156:157], v12 offset:57352
  ds_read_b64_tr_b16 v[158:159], v12 offset:59400
  s_waitcnt lgkmcnt(0)
  s_waitcnt vmcnt(24)
  s_barrier
  s_lshl_b32 s73, s56, 13
  s_add_u32 m0, s73, 32768
  s_add_u32 s73, s74, 3145728
  buffer_load_dwordx4 v16, s[48:51], s73 offen lds
  s_add_u32 m0, m0, 1024
  s_add_u32 s73, s73, 32768
  buffer_load_dwordx4 v16, s[48:51], s73 offen lds
  s_add_u32 m0, m0, 1024
  s_add_u32 s73, s73, 32768
  buffer_load_dwordx4 v16, s[48:51], s73 offen lds
  s_add_u32 m0, m0, 1024
  s_add_u32 s73, s73, 32768
  buffer_load_dwordx4 v16, s[48:51], s73 offen lds
  s_add_u32 m0, m0, 1024
  s_add_u32 s73, s73, 32768
  buffer_load_dwordx4 v16, s[48:51], s73 offen lds
  s_add_u32 m0, m0, 1024
  s_add_u32 s73, s73, 32768
  buffer_load_dwordx4 v16, s[48:51], s73 offen lds
  s_add_u32 m0, m0, 1024
  s_add_u32 s73, s73, 32768
  buffer_load_dwordx4 v16, s[48:51], s73 offen lds
  s_add_u32 m0, m0, 1024
  s_add_u32 s73, s73, 32768
  buffer_load_dwordx4 v16, s[48:51], s73 offen lds
  ds_read_b64_tr_b16 v[160:161], v13 offset:0
  ds_read_b64_tr_b16 v[162:163], v13 offset:2048
  ds_read_b64_tr_b16 v[164:165], v13 offset:8192
  ds_read_b64_tr_b16 v[166:167], v13 offset:10240
  ds_read_b64_tr_b16 v[168:169], v13 offset:8
  ds_read_b64_tr_b16 v[170:171], v13 offset:2056
  ds_read_b64_tr_b16 v[172:173], v13 offset:8200
  ds_read_b64_tr_b16 v[174:175], v13 offset:10248
  ds_read_b64_tr_b16 v[176:177], v13 offset:16384
  ds_read_b64_tr_b16 v[178:179], v13 offset:18432
  ds_read_b64_tr_b16 v[180:181], v13 offset:24576
  ds_read_b64_tr_b16 v[182:183], v13 offset:26624
  ds_read_b64_tr_b16 v[184:185], v13 offset:16392
  ds_read_b64_tr_b16 v[186:187], v13 offset:18440
  ds_read_b64_tr_b16 v[188:189], v13 offset:24584
  ds_read_b64_tr_b16 v[190:191], v13 offset:26632
  s_waitcnt lgkmcnt(0)
  s_waitcnt vmcnt(24)
  s_barrier
  s_lshl_b32 s73, s56, 13
  s_add_u32 m0, s73, 65536
  s_add_u32 s73, s75, 128
  buffer_load_dwordx4 v17, s[52:55], s73 offen lds
  s_add_u32 m0, m0, 1024
  s_add_u32 s73, s73, 8192
  buffer_load_dwordx4 v17, s[52:55], s73 offen lds
  s_add_u32 m0, m0, 1024
  s_add_u32 s73, s73, 8192
  buffer_load_dwordx4 v17, s[52:55], s73 offen lds
  s_add_u32 m0, m0, 1024
  s_add_u32 s73, s73, 8192
  buffer_load_dwordx4 v17, s[52:55], s73 offen lds
  s_add_u32 m0, m0, 1024
  s_add_u32 s73, s73, 8192
  buffer_load_dwordx4 v17, s[52:55], s73 offen lds
  s_add_u32 m0, m0, 1024
  s_add_u32 s73, s73, 8192
  buffer_load_dwordx4 v17, s[52:55], s73 offen lds
  s_add_u32 m0, m0, 1024
  s_add_u32 s73, s73, 8192
  buffer_load_dwordx4 v17, s[52:55], s73 offen lds
  s_add_u32 m0, m0, 1024
  s_add_u32 s73, s73, 8192
  buffer_load_dwordx4 v17, s[52:55], s73 offen lds
  ds_read_b64_tr_b16 v[192:193], v15 offset:32768
  ds_read_b64_tr_b16 v[194:195], v15 offset:33024
  ds_read_b64_tr_b16 v[196:197], v15 offset:36864
  ds_read_b64_tr_b16 v[198:199], v15 offset:37120
  ds_read_b64_tr_b16 v[208:209], v15 offset:32776
  ds_read_b64_tr_b16 v[210:211], v15 offset:33032
  ds_read_b64_tr_b16 v[212:213], v15 offset:36872
  ds_read_b64_tr_b16 v[214:215], v15 offset:37128
  ds_read_b64_tr_b16 v[224:225], v15 offset:32784
  ds_read_b64_tr_b16 v[226:227], v15 offset:33040
  ds_read_b64_tr_b16 v[228:229], v15 offset:36880
  ds_read_b64_tr_b16 v[230:231], v15 offset:37136
  ds_read_b64_tr_b16 v[240:241], v15 offset:32792
  ds_read_b64_tr_b16 v[242:243], v15 offset:33048
  ds_read_b64_tr_b16 v[244:245], v15 offset:36888
  ds_read_b64_tr_b16 v[246:247], v15 offset:37144
  s_waitcnt lgkmcnt(0)
  s_waitcnt vmcnt(24)
  s_barrier
  s_lshl_b32 s73, s56, 13
  s_add_u32 m0, s73, 98304
  s_add_u32 s73, s75, 65664
  buffer_load_dwordx4 v17, s[52:55], s73 offen lds
  s_add_u32 m0, m0, 1024
  s_add_u32 s73, s73, 8192
  buffer_load_dwordx4 v17, s[52:55], s73 offen lds
  s_add_u32 m0, m0, 1024
  s_add_u32 s73, s73, 8192
  buffer_load_dwordx4 v17, s[52:55], s73 offen lds
  s_add_u32 m0, m0, 1024
  s_add_u32 s73, s73, 8192
  buffer_load_dwordx4 v17, s[52:55], s73 offen lds
  s_add_u32 m0, m0, 1024
  s_add_u32 s73, s73, 8192
  buffer_load_dwordx4 v17, s[52:55], s73 offen lds
  s_add_u32 m0, m0, 1024
  s_add_u32 s73, s73, 8192
  buffer_load_dwordx4 v17, s[52:55], s73 offen lds
  s_add_u32 m0, m0, 1024
  s_add_u32 s73, s73, 8192
  buffer_load_dwordx4 v17, s[52:55], s73 offen lds
  s_add_u32 m0, m0, 1024
  s_add_u32 s73, s73, 8192
  buffer_load_dwordx4 v17, s[52:55], s73 offen lds
  v_add_u32 v5, 0x10000, v15
  ds_read_b64_tr_b16 v[200:201], v5 offset:0
  ds_read_b64_tr_b16 v[202:203], v5 offset:256
  ds_read_b64_tr_b16 v[204:205], v5 offset:4096
  ds_read_b64_tr_b16 v[206:207], v5 offset:4352
  ds_read_b64_tr_b16 v[216:217], v5 offset:8
  ds_read_b64_tr_b16 v[218:219], v5 offset:264
  ds_read_b64_tr_b16 v[220:221], v5 offset:4104
  ds_read_b64_tr_b16 v[222:223], v5 offset:4360
  ds_read_b64_tr_b16 v[232:233], v5 offset:16
  ds_read_b64_tr_b16 v[234:235], v5 offset:272
  ds_read_b64_tr_b16 v[236:237], v5 offset:4112
  ds_read_b64_tr_b16 v[238:239], v5 offset:4368
  ds_read_b64_tr_b16 v[248:249], v5 offset:24
  ds_read_b64_tr_b16 v[250:251], v5 offset:280
  ds_read_b64_tr_b16 v[252:253], v5 offset:4120
  ds_read_b64_tr_b16 v[254:255], v5 offset:4376
  s_waitcnt lgkmcnt(0)
  s_waitcnt vmcnt(24)
  s_barrier
  ds_read_b64_tr_b16 v[32:33], v12 offset:0
  ds_read_b64_tr_b16 v[34:35], v12 offset:2048
  ds_read_b64_tr_b16 v[36:37], v12 offset:8192
  ds_read_b64_tr_b16 v[38:39], v12 offset:10240
  ds_read_b64_tr_b16 v[40:41], v12 offset:8
  ds_read_b64_tr_b16 v[42:43], v12 offset:2056
  ds_read_b64_tr_b16 v[44:45], v12 offset:8200
  ds_read_b64_tr_b16 v[46:47], v12 offset:10248
  ds_read_b64_tr_b16 v[48:49], v12 offset:16384
  ds_read_b64_tr_b16 v[50:51], v12 offset:18432
  ds_read_b64_tr_b16 v[52:53], v12 offset:24576
  ds_read_b64_tr_b16 v[54:55], v12 offset:26624
  ds_read_b64_tr_b16 v[56:57], v12 offset:16392
  ds_read_b64_tr_b16 v[58:59], v12 offset:18440
  ds_read_b64_tr_b16 v[60:61], v12 offset:24584
  ds_read_b64_tr_b16 v[62:63], v12 offset:26632
  s_waitcnt lgkmcnt(0)
  s_barrier
  ds_write_b128 v24, v[32:35] offset:0
  ds_write_b128 v24, v[36:39] offset:1024
  ds_write_b128 v24, v[40:43] offset:2048
  ds_write_b128 v24, v[44:47] offset:3072
  ds_write_b128 v24, v[48:51] offset:4096
  ds_write_b128 v24, v[52:55] offset:5120
  ds_write_b128 v24, v[56:59] offset:6144
  ds_write_b128 v24, v[60:63] offset:7168
  s_waitcnt lgkmcnt(0)
  s_waitcnt vmcnt(16)
  s_barrier
  ds_read_b64_tr_b16 v[32:33], v12 offset:32768
  ds_read_b64_tr_b16 v[34:35], v12 offset:34816
  ds_read_b64_tr_b16 v[36:37], v12 offset:40960
  ds_read_b64_tr_b16 v[38:39], v12 offset:43008
  ds_read_b64_tr_b16 v[40:41], v12 offset:32776
  ds_read_b64_tr_b16 v[42:43], v12 offset:34824
  ds_read_b64_tr_b16 v[44:45], v12 offset:40968
  ds_read_b64_tr_b16 v[46:47], v12 offset:43016
  ds_read_b64_tr_b16 v[48:49], v12 offset:49152
  ds_read_b64_tr_b16 v[50:51], v12 offset:51200
  ds_read_b64_tr_b16 v[52:53], v12 offset:57344
  ds_read_b64_tr_b16 v[54:55], v12 offset:59392
  ds_read_b64_tr_b16 v[56:57], v12 offset:49160
  ds_read_b64_tr_b16 v[58:59], v12 offset:51208
  ds_read_b64_tr_b16 v[60:61], v12 offset:57352
  ds_read_b64_tr_b16 v[62:63], v12 offset:59400
  s_waitcnt lgkmcnt(0)
  s_barrier
  ds_write_b128 v24, v[32:35] offset:32768
  ds_write_b128 v24, v[36:39] offset:33792
  ds_write_b128 v24, v[40:43] offset:34816
  ds_write_b128 v24, v[44:47] offset:35840
  ds_write_b128 v24, v[48:51] offset:36864
  ds_write_b128 v24, v[52:55] offset:37888
  ds_write_b128 v24, v[56:59] offset:38912
  ds_write_b128 v24, v[60:63] offset:39936
  s_waitcnt lgkmcnt(0)
  s_waitcnt vmcnt(8)
  s_barrier
  ds_read_b64_tr_b16 v[32:33], v15 offset:0
  ds_read_b64_tr_b16 v[34:35], v15 offset:256
  ds_read_b64_tr_b16 v[36:37], v15 offset:4096
  ds_read_b64_tr_b16 v[38:39], v15 offset:4352
  ds_read_b64_tr_b16 v[40:41], v15 offset:8
  ds_read_b64_tr_b16 v[42:43], v15 offset:264
  ds_read_b64_tr_b16 v[44:45], v15 offset:4104
  ds_read_b64_tr_b16 v[46:47], v15 offset:4360
  ds_read_b64_tr_b16 v[48:49], v15 offset:16
  ds_read_b64_tr_b16 v[50:51], v15 offset:272
  ds_read_b64_tr_b16 v[52:53], v15 offset:4112
  ds_read_b64_tr_b16 v[54:55], v15 offset:4368
  ds_read_b64_tr_b16 v[56:57], v15 offset:24
  ds_read_b64_tr_b16 v[58:59], v15 offset:280
  ds_read_b64_tr_b16 v[60:61], v15 offset:4120
  ds_read_b64_tr_b16 v[62:63], v15 offset:4376
  s_waitcnt lgkmcnt(0)
  s_barrier
  ds_write_b128 v25, v[32:35] offset:0
  ds_write_b128 v25, v[36:39] offset:1024
  ds_write_b128 v25, v[40:43] offset:2048
  ds_write_b128 v25, v[44:47] offset:3072
  ds_write_b128 v25, v[48:51] offset:4096
  ds_write_b128 v25, v[52:55] offset:5120
  ds_write_b128 v25, v[56:59] offset:6144
  ds_write_b128 v25, v[60:63] offset:7168
  s_waitcnt lgkmcnt(0)
  s_waitcnt vmcnt(0)
  s_barrier
  ds_read_b64_tr_b16 v[32:33], v15 offset:32768
  ds_read_b64_tr_b16 v[34:35], v15 offset:33024
  ds_read_b64_tr_b16 v[36:37], v15 offset:36864
  ds_read_b64_tr_b16 v[38:39], v15 offset:37120
  ds_read_b64_tr_b16 v[40:41], v15 offset:32776
  ds_read_b64_tr_b16 v[42:43], v15 offset:33032
  ds_read_b64_tr_b16 v[44:45], v15 offset:36872
  ds_read_b64_tr_b16 v[46:47], v15 offset:37128
  ds_read_b64_tr_b16 v[48:49], v15 offset:32784
  ds_read_b64_tr_b16 v[50:51], v15 offset:33040
  ds_read_b64_tr_b16 v[52:53], v15 offset:36880
  ds_read_b64_tr_b16 v[54:55], v15 offset:37136
  ds_read_b64_tr_b16 v[56:57], v15 offset:32792
  ds_read_b64_tr_b16 v[58:59], v15 offset:33048
  ds_read_b64_tr_b16 v[60:61], v15 offset:36888
  ds_read_b64_tr_b16 v[62:63], v15 offset:37144
  s_waitcnt lgkmcnt(0)
  s_barrier
  ds_write_b128 v25, v[32:35] offset:32768
  ds_write_b128 v25, v[36:39] offset:33792
  ds_write_b128 v25, v[40:43] offset:34816
  ds_write_b128 v25, v[44:47] offset:35840
  ds_write_b128 v25, v[48:51] offset:36864
  ds_write_b128 v25, v[52:55] offset:37888
  ds_write_b128 v25, v[56:59] offset:38912
  ds_write_b128 v25, v[60:63] offset:39936
  s_waitcnt lgkmcnt(0)
  s_barrier
  v_mov_b32 v4, -1
  v_mov_b32 v5, -1
  v_mov_b32 v6, -1
  v_mov_b32 v7, -1
  s_cmp_lg_u32 s70, 0
  s_cbranch_scc1 CE_89
  v_mov_b32 v4, -1
CE_89:
  v_mov_b32 v9, v25
  v_mov_b32 v3, v24
  v_bfe_u32 v28, v1, 1, 1
  v_cmp_eq_u32 vcc, 1, v28
  v_mov_b32 v29, 0x4444
  v_mov_b32 v30, 0xeeee
  v_cndmask_b32 v11, v29, v30, vcc
  v_and_b32 v28, 15, v1
  v_mov_b32 v29, 0x3f80
  v_mov_b32 v30, 0x3f800000
  v_cmp_eq_u32 vcc, 0, v28
  s_nop 1
  v_cndmask_b32 v12, 0, v29, vcc
  v_cmp_eq_u32 vcc, 4, v28
  s_nop 1
  v_cndmask_b32 v12, v12, v30, vcc
  v_mov_b32 v29, 0x3f80
  v_mov_b32 v30, 0x3f800000
  v_cmp_eq_u32 vcc, 1, v28
  s_nop 1
  v_cndmask_b32 v13, 0, v29, vcc
  v_cmp_eq_u32 vcc, 5, v28
  s_nop 1
  v_cndmask_b32 v13, v13, v30, vcc
  v_mov_b32 v29, 0x3f80
  v_mov_b32 v30, 0x3f800000
  v_cmp_eq_u32 vcc, 2, v28
  s_nop 1
  v_cndmask_b32 v14, 0, v29, vcc
  v_cmp_eq_u32 vcc, 6, v28
  s_nop 1
  v_cndmask_b32 v14, v14, v30, vcc
  v_mov_b32 v29, 0x3f80
  v_mov_b32 v30, 0x3f800000
  v_cmp_eq_u32 vcc, 3, v28
  s_nop 1
  v_cndmask_b32 v15, 0, v29, vcc
  v_cmp_eq_u32 vcc, 7, v28
  s_nop 1
  v_cndmask_b32 v15, v15, v30, vcc
  v_lshrrev_b32 v29, 4, v1
  v_mul_u32_u24 v30, 576, v29
  v_lshl_add_u32 v30, v28, 2, v30
  s_lshl_b32 s60, s56, 6
  s_add_u32 s60, s60, 155648
  v_add_u32 v16, s60, v30
  v_and_b32 v30, 7, v1
  v_mul_u32_u24 v30, 288, v30
  v_lshl_add_u32 v30, v29, 4, v30
  v_add_u32 v17, 155648, v30
  v_lshrrev_b32 v30, 2, v28
  v_and_b32 v31, 1, v28
  v_lshl_add_u32 v30, v30, 1, v31
  v_lshl_add_u32 v31, v29, 3, v30
  v_lshlrev_b32 v22, 4, v31
  v_mul_u32_u24 v30, 288, v30
  v_lshl_add_u32 v30, v29, 4, v30
  v_add_u32 v18, 157952, v30
  v_and_b32 v30, 7, v1
  v_mul_u32_u24 v30, 320, v30
  v_lshl_add_u32 v30, v29, 4, v30
  s_lshl_b32 s60, s56, 6
  s_add_u32 s60, s60, 160256
  v_add_u32 v19, s60, v30
  v_lshrrev_b32 v30, 2, v28
  v_and_b32 v31, 1, v28
  v_lshl_add_u32 v30, v30, 1, v31
  v_mul_u32_u24 v30, 320, v30
  v_lshl_add_u32 v30, v29, 5, v30
  v_bfe_u32 v31, v28, 1, 1
  v_lshl_add_u32 v30, v31, 4, v30
  v_add_u32 v20, 160256, v30
  v_lshrrev_b32 v30, 2, v28
  v_lshlrev_b32 v30, 13, v30
  v_and_b32 v31, 3, v28
  v_lshl_add_u32 v31, v29, 2, v31
  v_lshl_add_u32 v21, v31, 4, v30
  v_lshlrev_b32 v23, 3, v1
  s_lshl_b32 s60, s56, 11
  s_add_u32 s60, s60, 131072
  v_add_u32 v24, s60, v2
  v_mov_b32 v25, 0
  s_mov_b32 s90, 0x00ff00ff
  s_mov_b32 s91, 0x00ff00ff
  s_lshl_b32 s60, s56, 16
  s_add_u32 s78, s78, s60
  s_lshl_b32 s60, s71, 8
  s_add_u32 s78, s78, s60
  s_mov_b32 s80, 0
  s_lshl_b32 s60, s71, 13
  s_add_u32 s80, s80, s60
  s_lshl_b32 s60, s56, 11
  s_add_u32 s81, s80, s60
  s_add_u32 s81, s81, 104857600
  s_lshl_b32 s60, s56, 10
  s_add_u32 s80, s80, s60
  s_add_u32 s80, s80, 71303168
  s_lshl_b32 s82, s70, 15
  s_lshl_b32 s60, s71, 4
  s_add_u32 s82, s82, s60
  s_lshl_b32 s60, s56, 2
  s_add_u32 s82, s82, s60
  s_add_u32 s82, s82, 16384
  s_mov_b32 s83, 0
  s_lshl_b32 s60, s71, 11
  s_add_u32 s83, s83, s60
  s_lshl_b32 s60, s56, 9
  s_add_u32 s83, s83, s60
  s_add_u32 s84, s83, 29360128
  s_add_u32 s83, s83, 20971520
  s_lshl_b32 s85, s70, 12
  s_lshl_b32 s60, s71, 7
  s_add_u32 s85, s85, s60
  s_lshl_b32 s60, s56, 2
  s_add_u32 s85, s85, s60
  s_add_u32 s85, s85, 147456
  s_mov_b32 s88, 0x3e0293ee
  v_mov_b32 v29, 12
IW_90:
  buffer_load_dword v28, v29, s[36:39], 0 offen sc1
  s_waitcnt vmcnt(0)
  v_readfirstlane_b32 s60, v28
  s_cmp_ge_u32 s60, 256
  s_cbranch_scc1 IWD_91
  s_add_u32 s64, s64, 1
  s_cmp_lt_u32 s64, 131072
  s_cbranch_scc1 SPOK_92
  s_mov_b32 s63, 1
  s_branch L_ABORT
SPOK_92:
  s_sleep 8
  s_branch IW_90
IWD_91:
  s_mov_b32 s64, 0
  v_mov_b32 v29, 136
IW_93:
  buffer_load_dword v28, v29, s[36:39], s93 offen sc1
  s_waitcnt vmcnt(0)
  v_readfirstlane_b32 s60, v28
  s_cmp_ge_u32 s60, 32
  s_cbranch_scc1 IWD_94
  s_add_u32 s64, s64, 1
  s_cmp_lt_u32 s64, 131072
  s_cbranch_scc1 SPOK_95
  s_mov_b32 s63, 1
  s_branch L_ABORT
SPOK_95:
  s_sleep 8
  s_branch IW_93
IWD_94:
  s_mov_b32 s64, 0
  s_lshl_b32 s60, s70, 2
  v_mov_b32 v29, 16
  buffer_load_dword v28, v29, s[36:39], s60 offen sc1
  s_waitcnt vmcnt(0)
  v_readfirstlane_b32 s60, v28
  s_bcnt1_i32_b32 s60, s60
  s_mov_b32 s76, 0
  s_cmp_eq_u32 s60, 1
  s_cbranch_scc0 L_CH_SLOW
  v_add_u32 v0, 131072, v2
  s_lshl_b32 s60, s56, 6
  v_add_u32 v27, s60, v18
  s_mov_b32 s30, s88
  s_mov_b32 s31, s88
  s_mov_b32 s16, 0
  v_mov_b32 v26, 0
  s_lshl_b32 s60, s56, 11
  s_add_u32 s20, s79, s60
  s_add_u32 s29, s77, s60
  s_add_u32 s29, s29, 262144
  s_mov_b32 s64, 0
  ds_read_b128 v[48:51], v3 offset:0
  ds_read_b128 v[52:55], v3 offset:1024
  ds_read_b128 v[56:59], v3 offset:2048
  ds_read_b128 v[60:63], v3 offset:3072
  ds_read_b128 v[64:67], v3 offset:4096
  ds_read_b128 v[68:71], v3 offset:5120
  ds_read_b128 v[72:75], v3 offset:6144
  ds_read_b128 v[76:79], v3 offset:7168
  v_mov_b64 v[96:97], 0
  v_mov_b64 v[98:99], 0
  v_mov_b64 v[100:101], 0
  v_mov_b64 v[102:103], 0
  v_mov_b64 v[104:105], 0
  v_mov_b64 v[106:107], 0
  v_mov_b64 v[108:109], 0
  v_mov_b64 v[110:111], 0
  v_mov_b64 v[112:113], 0
  v_mov_b64 v[114:115], 0
  v_mov_b64 v[116:117], 0
  v_mov_b64 v[118:119], 0
  s_and_b32 s60, s76, 1
  s_lshl_b32 s61, s60, 13
  v_add_u32 v8, s61, v0
  s_lshl_b32 s60, s60, 18
  s_add_u32 s21, s60, s78
  s_add_u32 s22, s21, 32768
  s_lshl_b32 s60, s76, 16
  s_add_u32 s27, s60, s83
  s_add_u32 s28, s60, s84
  s_add_u32 s87, s76, 1
  s_min_u32 s87, s87, 63
L_CH_TOPF:
  s_cmp_eq_u32 s16, 0
  s_cbranch_scc1 CHL_97
CHV_96:
  s_sleep 1
  buffer_load_dwordx4 v[120:123], v2, s[32:35], s20 offen offset:0 sc1
  buffer_load_dwordx4 v[124:127], v2, s[32:35], s20 offen offset:1024 sc1
  ds_read_b128 v[80:83], v3 offset:32768
  ds_read_b128 v[84:87], v3 offset:33792
  ds_read_b128 v[88:91], v3 offset:34816
  ds_read_b128 v[92:95], v3 offset:35840
  v_xor_b32 v29, 2048, v24
  v_xor_b32 v30, 4096, v24
  v_xor_b32 v31, 6144, v24
  s_sleep 1
  buffer_load_dwordx4 v[120:123], v2, s[32:35], s20 offen offset:0 sc1
  buffer_load_dwordx4 v[124:127], v2, s[32:35], s20 offen offset:1024 sc1
CG2_100:
  s_waitcnt vmcnt(2)
  v_max_u32 v28, v121, v123
  v_max3_u32 v28, v28, v125, v127
  v_cmp_eq_u32 vcc, -1, v28
  s_cbranch_vccnz CG_98
  ds_write_b128 v24, v[120:123]
  ds_write_b128 v24, v[124:127] offset:1024
  v_smfmac_f32_16x16x64_bf16 v[96:99], v[120:123], a[0:7], v11
  v_smfmac_f32_16x16x64_bf16 v[100:103], v[120:123], a[64:71], v11
  v_smfmac_f32_16x16x64_bf16 v[104:107], v[120:123], a[128:135], v11
  v_smfmac_f32_16x16x64_bf16 v[108:111], v[120:123], a[192:199], v11
  s_waitcnt lgkmcnt(0)
  s_barrier
  ds_read_b128 v[32:35], v29 offset:0
  ds_read_b128 v[36:39], v29 offset:1024
  ds_read_b128 v[40:43], v30 offset:0
  ds_read_b128 v[44:47], v30 offset:1024
  v_readfirstlane_b32 s16, v26
  v_smfmac_f32_16x16x64_bf16 v[96:99], v[124:127], a[8:15], v11
  v_smfmac_f32_16x16x64_bf16 v[100:103], v[124:127], a[72:79], v11
  v_smfmac_f32_16x16x64_bf16 v[104:107], v[124:127], a[136:143], v11
  v_smfmac_f32_16x16x64_bf16 v[108:111], v[124:127], a[200:207], v11
  s_waitcnt lgkmcnt(3)
  v_smfmac_f32_16x16x64_bf16 v[96:99], v[32:35], a[16:23], v11
  v_mov_b32 v28, s76
  buffer_store_dword v28, v25, s[32:35], s85 offen sc1
  v_smfmac_f32_16x16x64_bf16 v[100:103], v[32:35], a[80:87], v11
  s_lshl_b32 s60, s76, 18
  s_add_u32 s60, s60, s81
  v_smfmac_f32_16x16x64_bf16 v[104:107], v[32:35], a[144:151], v11
  buffer_load_dwordx4 v[120:123], v2, s[32:35], s60 offen offset:0 sc1
  buffer_load_dwordx4 v[124:127], v2, s[32:35], s60 offen offset:1024 sc1
  v_smfmac_f32_16x16x64_bf16 v[108:111], v[32:35], a[208:215], v11
  buffer_store_dwordx4 v[4:7], v2, s[32:35], s29 offen offset:0
  buffer_store_dwordx4 v[4:7], v2, s[32:35], s29 offen offset:1024
  ds_read_b128 v[32:35], v31 offset:0
  s_waitcnt lgkmcnt(3)
  v_smfmac_f32_16x16x64_bf16 v[96:99], v[36:39], a[24:31], v11
  s_xor_b32 s29, s29, 262144
  s_and_b32 s60, s76, 1
  v_smfmac_f32_16x16x64_bf16 v[100:103], v[36:39], a[88:95], v11
  s_lshl_b32 s60, s60, 18
  s_add_u32 s23, s60, s77
  v_smfmac_f32_16x16x64_bf16 v[104:107], v[36:39], a[152:159], v11
  s_add_u32 s24, s23, 4096
  s_and_b32 s60, s76, 3
  v_smfmac_f32_16x16x64_bf16 v[108:111], v[36:39], a[216:223], v11
  s_lshl_b32 s60, s60, 13
  s_add_u32 s26, s60, s86
  ds_read_b128 v[36:39], v31 offset:1024
  s_waitcnt lgkmcnt(3)
  v_smfmac_f32_16x16x64_bf16 v[96:99], v[40:43], a[32:39], v11
  s_add_u32 s60, s76, 1
  s_and_b32 s60, s60, 3
  v_smfmac_f32_16x16x64_bf16 v[100:103], v[40:43], a[96:103], v11
  s_lshl_b32 s60, s60, 13
  s_add_u32 s25, s60, s86
  v_smfmac_f32_16x16x64_bf16 v[104:107], v[40:43], a[160:167], v11
  s_add_u32 s20, s60, s79
  s_lshl_b32 s60, s56, 11
  v_smfmac_f32_16x16x64_bf16 v[108:111], v[40:43], a[224:231], v11
  s_add_u32 s20, s20, s60
  s_mov_b32 s64, 0
  ds_read_b128 v[40:43], v0 offset:4096
  s_waitcnt lgkmcnt(3)
  v_smfmac_f32_16x16x64_bf16 v[96:99], v[44:47], a[40:47], v11
  s_lshl_b32 s60, s87, 18
  s_add_u32 s61, s60, s80
  v_smfmac_f32_16x16x64_bf16 v[100:103], v[44:47], a[104:111], v11
  s_and_b32 s60, s87, 1
  s_lshl_b32 s60, s60, 3
  v_smfmac_f32_16x16x64_bf16 v[104:107], v[44:47], a[168:175], v11
  s_add_u32 s60, s60, s56
  s_lshl_b32 s60, s60, 10
  v_smfmac_f32_16x16x64_bf16 v[108:111], v[44:47], a[232:239], v11
  s_add_u32 m0, s60, 139264
  s_add_u32 s62, s61, 4096
  ds_read_b128 v[44:47], v0 offset:5120
  s_waitcnt lgkmcnt(3)
  v_smfmac_f32_16x16x64_bf16 v[96:99], v[32:35], a[48:55], v11
  buffer_load_dwordx4 v2, s[32:35], s61 offen sc1 lds
  s_add_u32 m0, m0, 4096
  v_smfmac_f32_16x16x64_bf16 v[100:103], v[32:35], a[112:119], v11
  s_nop 0
  buffer_load_dwordx4 v2, s[32:35], s62 offen sc1 lds
  v_smfmac_f32_16x16x64_bf16 v[104:107], v[32:35], a[176:183], v11
  s_add_u32 s60, s87, 1
  s_min_u32 s60, s60, 63
  v_smfmac_f32_16x16x64_bf16 v[108:111], v[32:35], a[240:247], v11
  s_lshl_b32 s61, s60, 9
  s_add_u32 s61, s61, s82
  ds_read_b128 v[32:35], v0 offset:6144
  s_waitcnt lgkmcnt(3)
  v_smfmac_f32_16x16x64_bf16 v[96:99], v[36:39], a[56:63], v11
  buffer_load_dword v26, v25, s[32:35], s61 offen sc1
  v_smfmac_f32_16x16x64_bf16 v[100:103], v[36:39], a[120:127], v11
  v_smfmac_f32_16x16x64_bf16 v[104:107], v[36:39], a[184:191], v11
  v_smfmac_f32_16x16x64_bf16 v[108:111], v[36:39], a[248:255], v11
  ds_read_b128 v[36:39], v0 offset:7168
  s_waitcnt lgkmcnt(3)
  v_smfmac_f32_16x16x64_bf16 v[112:115], v[40:43], v[48:55], v11
  ds_read_b128 v[48:51], v3 offset:36864
  ds_read_b128 v[52:55], v3 offset:37888
  v_smfmac_f32_16x16x64_bf16 v[116:119], v[40:43], v[56:63], v11
  ds_read_b128 v[56:59], v3 offset:38912
  ds_read_b128 v[60:63], v3 offset:39936
  ds_read_b128 v[40:43], v0 offset:0
  v_pk_add_f32 v[96:97], v[96:97], v[98:99]
  v_pk_add_f32 v[100:101], v[100:101], v[102:103]
  s_waitcnt lgkmcnt(7)
  v_smfmac_f32_16x16x64_bf16 v[112:115], v[44:47], v[64:71], v11
  v_cvt_pk_bf16_f32 v28, v96, v100
  v_cvt_pk_bf16_f32 v29, v97, v101
  v_smfmac_f32_16x16x64_bf16 v[116:119], v[44:47], v[72:79], v11
  ds_read_b128 v[44:47], v0 offset:1024
  ds_write_b32 v16, v28 offset:0
  ds_write_b32 v16, v29 offset:288
  s_waitcnt lgkmcnt(9)
  v_smfmac_f32_16x16x64_bf16 v[112:115], v[32:35], v[80:87], v11
  v_pk_add_f32 v[104:105], v[104:105], v[106:107]
  v_pk_add_f32 v[108:109], v[108:109], v[110:111]
  v_smfmac_f32_16x16x64_bf16 v[116:119], v[32:35], v[88:95], v11
  ds_read_b128 v[32:35], v0 offset:2048
  v_cvt_pk_bf16_f32 v30, v104, v108
  v_cvt_pk_bf16_f32 v31, v105, v109
  s_waitcnt lgkmcnt(7)
  v_smfmac_f32_16x16x64_bf16 v[112:115], v[36:39], v[48:55], v11
  ds_write_b32 v16, v30 offset:2304
  ds_write_b32 v16, v31 offset:2592
  s_waitcnt lgkmcnt(7)
  v_smfmac_f32_16x16x64_bf16 v[116:119], v[36:39], v[56:63], v11
  ds_read_b128 v[36:39], v0 offset:3072
  ds_read_b128 v[48:51], v8 offset:8192
  ds_read_b128 v[52:55], v8 offset:9216
  ds_read_b128 v[56:59], v8 offset:10240
  ds_read_b128 v[60:63], v8 offset:11264
  ds_read_b128 v[64:67], v8 offset:12288
  ds_read_b128 v[68:71], v8 offset:13312
  ds_read_b128 v[72:75], v8 offset:14336
  ds_read_b128 v[76:79], v8 offset:15360
  s_waitcnt lgkmcnt(9)
  s_barrier
  ds_read_b128 v[96:99], v17 offset:0
  v_smfmac_f32_16x16x64_bf16 v[112:115], v[40:43], v[128:135], v11
  ds_read_b128 v[80:83], v18 offset:0
  v_smfmac_f32_16x16x64_bf16 v[116:119], v[40:43], v[136:143], v11
  ds_read_b128 v[100:103], v17 offset:64
  v_smfmac_f32_16x16x64_bf16 v[112:115], v[44:47], v[144:151], v11
  ds_read_b128 v[84:87], v18 offset:64
  v_smfmac_f32_16x16x64_bf16 v[116:119], v[44:47], v[152:159], v11
  ds_read_b128 v[104:107], v17 offset:128
  v_smfmac_f32_16x16x64_bf16 v[112:115], v[32:35], v[160:167], v11
  ds_read_b128 v[88:91], v18 offset:128
  v_smfmac_f32_16x16x64_bf16 v[116:119], v[32:35], v[168:175], v11
  ds_read_b128 v[108:111], v17 offset:192
  s_waitcnt lgkmcnt(15)
  v_smfmac_f32_16x16x64_bf16 v[112:115], v[36:39], v[176:183], v11
  ds_read_b128 v[92:95], v18 offset:192
  v_smfmac_f32_16x16x64_bf16 v[116:119], v[36:39], v[184:191], v11
  ds_read_b128 v[32:35], v27
  s_waitcnt lgkmcnt(7)
  v_mfma_f32_16x16x32_bf16 v[36:39], v[48:51], v[96:99], 0
  v_mfma_f32_16x16x32_bf16 v[40:43], v[64:67], v[96:99], 0
  v_mfma_f32_16x16x32_bf16 v[44:47], v[80:83], v[96:99], 0
  s_nop 0
  v_pk_add_f32 v[112:113], v[112:113], v[114:115]
  s_nop 0
  v_pk_add_f32 v[116:117], v[116:117], v[118:119]
  s_waitcnt lgkmcnt(5)
  v_mfma_f32_16x16x32_bf16 v[36:39], v[52:55], v[100:103], v[36:39]
  v_cvt_pk_bf16_f32 v30, v112, v113
  v_cvt_pk_bf16_f32 v31, v116, v117
  v_mfma_f32_16x16x32_bf16 v[40:43], v[68:71], v[100:103], v[40:43]
  buffer_store_dwordx2 v[30:31], v23, s[32:35], s28 offen sc1
  v_mov_b32 v112, v30
  v_mfma_f32_16x16x32_bf16 v[44:47], v[84:87], v[100:103], v[44:47]
  v_mov_b32 v113, 0
  v_mov_b32 v114, v31
  s_waitcnt lgkmcnt(3)
  v_mfma_f32_16x16x32_bf16 v[36:39], v[56:59], v[104:107], v[36:39]
  v_mov_b32 v115, 0
  v_mfma_f32_16x16x32_bf16 v[40:43], v[72:75], v[104:107], v[40:43]
  v_mfma_f32_16x16x32_bf16 v[44:47], v[88:91], v[104:107], v[44:47]
  s_waitcnt lgkmcnt(1)
  v_mfma_f32_16x16x32_bf16 v[36:39], v[60:63], v[108:111], v[36:39]
  v_mfma_f32_16x16x32_bf16 v[40:43], v[76:79], v[108:111], v[40:43]
  v_mfma_f32_16x16x32_bf16 v[44:47], v[92:95], v[108:111], v[44:47]
  s_waitcnt lgkmcnt(0)
  buffer_store_dwordx4 v[32:35], v22, s[32:35], s27 offen sc1
  s_cmp_eq_u32 s76, 63
  s_cbranch_scc1 L_CH_FINF
  ds_read_b128 v[80:83], v9 offset:0
  ds_read_b128 v[84:87], v9 offset:1024
  ds_read_b128 v[88:91], v9 offset:2048
  ds_read_b128 v[92:95], v9 offset:3072
  ds_read_b128 v[96:99], v9 offset:4096
  ds_read_b128 v[100:103], v9 offset:5120
  ds_read_b128 v[104:107], v9 offset:6144
  ds_read_b128 v[108:111], v9 offset:7168
  v_max3_f32 v28, v36, v37, v38
  v_max3_f32 v29, v39, v40, v41
  v_max3_f32 v28, v28, v42, v43
  v_max3_f32 v29, v29, v44, v45
  v_max_f32 v28, v28, v29
  v_mov_b32 v29, v28
  v_mov_b64 v[78:79], 0
  v_mov_b64 v[76:77], 0
  v_permlane16_swap_b32 v28, v29
  v_max_f32 v28, v28, v29
  v_mov_b32 v29, v28
  v_mov_b64 v[74:75], 0
  v_mov_b64 v[72:73], 0
  v_permlane32_swap_b32 v28, v29
  v_max_f32 v28, v28, v29
  v_mul_f32 v28, s88, v28
  v_pk_fma_f32 v[36:37], v[36:37], s[30:31], v[28:29] op_sel_hi:[1,1,0] neg_lo:[0,0,1] neg_hi:[0,0,1]
  v_pk_fma_f32 v[38:39], v[38:39], s[30:31], v[28:29] op_sel_hi:[1,1,0] neg_lo:[0,0,1] neg_hi:[0,0,1]
  v_pk_fma_f32 v[40:41], v[40:41], s[30:31], v[28:29] op_sel_hi:[1,1,0] neg_lo:[0,0,1] neg_hi:[0,0,1]
  v_pk_fma_f32 v[42:43], v[42:43], s[30:31], v[28:29] op_sel_hi:[1,1,0] neg_lo:[0,0,1] neg_hi:[0,0,1]
  v_pk_fma_f32 v[44:45], v[44:45], s[30:31], v[28:29] op_sel_hi:[1,1,0] neg_lo:[0,0,1] neg_hi:[0,0,1]
  v_exp_f32 v36, v36
  v_exp_f32 v37, v37
  v_exp_f32 v38, v38
  v_exp_f32 v39, v39
  v_exp_f32 v40, v40
  v_exp_f32 v41, v41
  v_exp_f32 v42, v42
  v_exp_f32 v43, v43
  v_exp_f32 v44, v44
  v_exp_f32 v45, v45
  v_mov_b32 v117, 0
  v_cvt_pk_bf16_f32 v32, v36, v37
  v_cvt_pk_bf16_f32 v33, v38, v39
  v_cvt_pk_bf16_f32 v34, v40, v41
  v_cvt_pk_bf16_f32 v35, v42, v43
  v_cvt_pk_bf16_f32 v116, v44, v45
  v_pk_add_f32 v[28:29], v[36:37], v[38:39]
  v_pk_add_f32 v[30:31], v[40:41], v[42:43]
  s_waitcnt vmcnt(5)
  v_mfma_f32_16x16x32_bf16 v[36:39], v[120:123], v[32:35], 0
  v_mfma_f32_16x16x32_bf16 v[40:43], v[124:127], v[32:35], 0
  v_mfma_f32_16x16x16_bf16 v[36:39], v[112:113], v[116:117], v[36:39]
  v_mfma_f32_16x16x16_bf16 v[40:43], v[114:115], v[116:117], v[40:43]
  v_pk_add_f32 v[28:29], v[28:29], v[44:45]
  v_pk_add_f32 v[28:29], v[28:29], v[30:31]
  v_add_f32 v28, v28, v29
  v_mov_b32 v29, v28
  v_mov_b64 v[70:71], 0
  v_mov_b64 v[68:69], 0
  v_permlane16_swap_b32 v28, v29
  v_add_f32 v28, v28, v29
  v_mov_b32 v29, v28
  v_mov_b64 v[66:67], 0
  v_mov_b64 v[64:65], 0
  v_permlane32_swap_b32 v28, v29
  v_add_f32 v28, v28, v29
  v_rcp_f32 v28, v28
  v_mov_b64 v[62:63], 0
  v_pk_mul_f32 v[36:37], v[36:37], v[28:29] op_sel_hi:[1,0]
  v_pk_mul_f32 v[38:39], v[38:39], v[28:29] op_sel_hi:[1,0]
  v_pk_mul_f32 v[40:41], v[40:41], v[28:29] op_sel_hi:[1,0]
  v_pk_mul_f32 v[42:43], v[42:43], v[28:29] op_sel_hi:[1,0]
  v_cvt_pk_bf16_f32 v44, v36, v37
  v_cvt_pk_bf16_f32 v45, v38, v39
  v_cvt_pk_bf16_f32 v46, v40, v41
  v_cvt_pk_bf16_f32 v47, v42, v43
  s_mov_b64 exec, s[90:91]
  ds_write_b128 v19, v[44:47]
  s_mov_b64 exec, -1
  v_mov_b64 v[60:61], 0
  v_mov_b64 v[58:59], 0
  v_mov_b64 v[56:57], 0
  v_mov_b64 v[54:55], 0
  v_mov_b64 v[52:53], 0
  v_mov_b64 v[50:51], 0
  v_mov_b64 v[48:49], 0
  s_waitcnt lgkmcnt(0)
  s_barrier
  ds_read_b128 v[120:123], v20 offset:0
  ds_read_b128 v[124:127], v20 offset:128
  s_waitcnt lgkmcnt(1)
  v_smfmac_f32_16x16x64_bf16 v[64:67], v[120:123], v[80:87], v11
  ds_read_b128 v[80:83], v9 offset:32768
  ds_read_b128 v[84:87], v9 offset:33792
  v_smfmac_f32_16x16x64_bf16 v[68:71], v[120:123], v[88:95], v11
  ds_read_b128 v[88:91], v9 offset:34816
  ds_read_b128 v[92:95], v9 offset:35840
  v_smfmac_f32_16x16x64_bf16 v[72:75], v[120:123], v[96:103], v11
  ds_read_b128 v[96:99], v9 offset:36864
  ds_read_b128 v[100:103], v9 offset:37888
  v_smfmac_f32_16x16x64_bf16 v[76:79], v[120:123], v[104:111], v11
  ds_read_b128 v[104:107], v9 offset:38912
  ds_read_b128 v[108:111], v9 offset:39936
  v_smfmac_f32_16x16x64_bf16 v[48:51], v[120:123], v[192:199], v11
  v_smfmac_f32_16x16x64_bf16 v[52:55], v[120:123], v[208:215], v11
  v_smfmac_f32_16x16x64_bf16 v[56:59], v[120:123], v[224:231], v11
  v_smfmac_f32_16x16x64_bf16 v[60:63], v[120:123], v[240:247], v11
  s_waitcnt lgkmcnt(8)
  v_smfmac_f32_16x16x64_bf16 v[48:51], v[124:127], v[200:207], v11
  v_smfmac_f32_16x16x64_bf16 v[52:55], v[124:127], v[216:223], v11
  v_smfmac_f32_16x16x64_bf16 v[56:59], v[124:127], v[232:239], v11
  v_smfmac_f32_16x16x64_bf16 v[60:63], v[124:127], v[248:255], v11
  s_waitcnt lgkmcnt(0)
  v_smfmac_f32_16x16x64_bf16 v[64:67], v[124:127], v[80:87], v11
  s_nop 2
  v_pk_add_f32 v[48:49], v[48:49], v[50:51]
  v_smfmac_f32_16x16x64_bf16 v[68:71], v[124:127], v[88:95], v11
  v_cvt_pk_bf16_f32 v32, v48, v49
  v_pk_add_f32 v[52:53], v[52:53], v[54:55]
  v_cvt_pk_bf16_f32 v33, v52, v53
  v_smfmac_f32_16x16x64_bf16 v[72:75], v[124:127], v[96:103], v11
  v_pk_add_f32 v[56:57], v[56:57], v[58:59]
  v_cvt_pk_bf16_f32 v34, v56, v57
  v_pk_add_f32 v[60:61], v[60:61], v[62:63]
  v_smfmac_f32_16x16x64_bf16 v[76:79], v[124:127], v[104:111], v11
  v_cvt_pk_bf16_f32 v35, v60, v61
  v_min_u32 v35, -2, v35
  buffer_store_dwordx4 v[32:35], v21, s[32:35], s21 offen
  v_pk_add_f32 v[64:65], v[64:65], v[66:67]
  v_cvt_pk_bf16_f32 v36, v64, v65
  v_pk_add_f32 v[68:69], v[68:69], v[70:71]
  v_cvt_pk_bf16_f32 v37, v68, v69
  v_pk_add_f32 v[72:73], v[72:73], v[74:75]
  v_cvt_pk_bf16_f32 v38, v72, v73
  v_pk_add_f32 v[76:77], v[76:77], v[78:79]
  v_cvt_pk_bf16_f32 v39, v76, v77
  v_min_u32 v39, -2, v39
  buffer_store_dwordx4 v[36:39], v21, s[32:35], s22 offen
  ds_read_b128 v[48:51], v3 offset:0
  ds_read_b128 v[52:55], v3 offset:1024
  ds_read_b128 v[56:59], v3 offset:2048
  ds_read_b128 v[60:63], v3 offset:3072
  ds_read_b128 v[64:67], v3 offset:4096
  ds_read_b128 v[68:71], v3 offset:5120
  ds_read_b128 v[72:75], v3 offset:6144
  ds_read_b128 v[76:79], v3 offset:7168
  s_add_u32 s19, s76, 1
  v_mov_b64 v[96:97], 0
  v_mov_b64 v[98:99], 0
  v_mov_b64 v[100:101], 0
  v_mov_b64 v[102:103], 0
  v_mov_b64 v[104:105], 0
  v_mov_b64 v[106:107], 0
  v_mov_b64 v[108:109], 0
  v_mov_b64 v[110:111], 0
  v_mov_b64 v[112:113], 0
  v_mov_b64 v[114:115], 0
  v_mov_b64 v[116:117], 0
  v_mov_b64 v[118:119], 0
  s_and_b32 s60, s19, 1
  s_lshl_b32 s61, s60, 13
  v_add_u32 v8, s61, v0
  s_lshl_b32 s60, s60, 18
  s_add_u32 s21, s60, s78
  s_add_u32 s22, s21, 32768
  s_lshl_b32 s60, s19, 16
  s_add_u32 s27, s60, s83
  s_add_u32 s28, s60, s84
  s_add_u32 s87, s19, 1
  s_min_u32 s87, s87, 63
  v_readfirstlane_b32 s60, v26
  s_cmp_eq_u32 s60, 0
  s_cbranch_scc1 CRS1_101
CRS2_102:
  s_cmp_lg_u32 s56, 0
  s_cbranch_scc1 CRW_104
  s_sleep 4
CND_107:
CRL_105:
  buffer_load_dwordx4 v[32:35], v2, s[32:35], s23 offen offset:0 sc1
  buffer_load_dwordx4 v[36:39], v2, s[32:35], s23 offen offset:1024 sc1
  buffer_load_dwordx4 v[40:43], v2, s[32:35], s23 offen offset:2048 sc1
  buffer_load_dwordx4 v[44:47], v2, s[32:35], s23 offen offset:3072 sc1
  buffer_load_dwordx4 v[80:83], v2, s[32:35], s24 offen offset:0 sc1
  buffer_load_dwordx4 v[84:87], v2, s[32:35], s24 offen offset:1024 sc1
  buffer_load_dwordx4 v[88:91], v2, s[32:35], s24 offen offset:2048 sc1
  buffer_load_dwordx4 v[92:95], v2, s[32:35], s24 offen offset:3072 sc1
  s_waitcnt vmcnt(7)
  v_mfma_f32_16x16x32_bf16 v[120:123], v[12:15], v[32:35], 0
  s_waitcnt vmcnt(6)
  v_mfma_f32_16x16x32_bf16 v[120:123], v[12:15], v[36:39], v[120:123]
  v_max_u32 v28, v35, v39
  s_waitcnt vmcnt(5)
  v_mfma_f32_16x16x32_bf16 v[120:123], v[12:15], v[40:43], v[120:123]
  s_waitcnt vmcnt(4)
  v_mfma_f32_16x16x32_bf16 v[120:123], v[12:15], v[44:47], v[120:123]
  v_max3_u32 v28, v28, v43, v47
  s_waitcnt vmcnt(3)
  v_mfma_f32_16x16x32_bf16 v[120:123], v[12:15], v[80:83], v[120:123]
  s_waitcnt vmcnt(2)
  v_mfma_f32_16x16x32_bf16 v[120:123], v[12:15], v[84:87], v[120:123]
  v_max3_u32 v28, v28, v83, v87
  s_waitcnt vmcnt(1)
  v_mfma_f32_16x16x32_bf16 v[120:123], v[12:15], v[88:91], v[120:123]
  s_waitcnt vmcnt(0)
  v_mfma_f32_16x16x32_bf16 v[120:123], v[12:15], v[92:95], v[120:123]
  v_max3_u32 v28, v28, v91, v95
  v_cmp_eq_u32 vcc, -1, v28
  s_cbranch_vccnz CRD_106
  s_nop 4
  v_cvt_pk_bf16_f32 v28, v120, v121
  v_cvt_pk_bf16_f32 v29, v122, v123
  v_min_u32 v29, -2, v29
  s_mov_b64 exec, s[66:67]
  buffer_store_dwordx2 v[28:29], v10, s[32:35], s25 offen
  buffer_store_dwordx2 v[4:5], v10, s[32:35], s26 offen
  s_mov_b64 exec, -1
CRW_104:
CRS_103:
  s_add_u32 s76, s76, 1
  s_barrier
  s_branch L_CH_TOPF
CHL_97:
  v_mov_b32 v30, v26
  s_mov_b32 s87, s76
  s_lshl_b32 s61, s87, 9
  s_add_u32 s61, s61, s82
CKV_108:
  buffer_load_dword v26, v25, s[32:35], s61 offen sc1
  s_waitcnt vmcnt(0)
  v_readfirstlane_b32 s60, v26
  s_cmp_lg_u32 s60, 0
  s_cbranch_scc1 CKVOK_109
  s_add_u32 s64, s64, 1
  s_cmp_lt_u32 s64, 131072
  s_cbranch_scc1 SPOK_110
  s_mov_b32 s63, 4
  s_branch L_ABORT
SPOK_110:
  s_sleep 1
  s_branch CKV_108
CKVOK_109:
  s_lshl_b32 s60, s87, 18
  s_add_u32 s61, s60, s80
  s_and_b32 s60, s87, 1
  s_lshl_b32 s60, s60, 3
  s_add_u32 s60, s60, s56
  s_lshl_b32 s60, s60, 10
  s_add_u32 m0, s60, 139264
  s_add_u32 s62, s61, 4096
  buffer_load_dwordx4 v2, s[32:35], s61 offen sc1 lds
  s_add_u32 m0, m0, 4096
  s_nop 0
  buffer_load_dwordx4 v2, s[32:35], s62 offen sc1 lds
  v_mov_b32 v26, v30
  s_mov_b32 s64, 0
  s_add_u32 s87, s76, 1
  s_min_u32 s87, s87, 63
  s_branch CHV_96
CG_98:
  buffer_load_dwordx4 v[120:123], v2, s[32:35], s20 offen offset:0 sc1
  buffer_load_dwordx4 v[124:127], v2, s[32:35], s20 offen offset:1024 sc1
  s_add_u32 s64, s64, 1
  s_cmp_lt_u32 s64, 131072
  s_cbranch_scc1 SPOK_111
  s_mov_b32 s63, 5
  s_branch L_ABORT
SPOK_111:
  s_branch CG2_100
CRS1_101:
  s_lshl_b32 s61, s87, 9
  s_add_u32 s61, s61, s82
  buffer_load_dword v26, v25, s[32:35], s61 offen sc1
  s_branch CRS2_102
CRD_106:
  s_add_u32 s64, s64, 1
  s_cmp_lt_u32 s64, 131072
  s_cbranch_scc1 SPOK_112
  s_mov_b32 s63, 6
  s_branch L_ABORT
SPOK_112:
  s_branch CRL_105
L_CH_FINF:
  s_waitcnt vmcnt(0)
  s_mov_b64 exec, 1
  v_mov_b32 v28, 64
  v_mov_b32 v29, 0
  buffer_store_dword v28, v29, s[32:35], s85 offen sc1
  s_mov_b64 exec, -1
  s_branch L_END
L_CH_SLOW:
  v_add_u32 v0, 131072, v2
  s_lshl_b32 s60, s56, 6
  v_add_u32 v27, s60, v18
  s_mov_b32 s30, s88
  s_mov_b32 s31, s88
  s_mov_b32 s16, 0
  v_mov_b32 v26, 0
  s_lshl_b32 s60, s56, 11
  s_add_u32 s20, s79, s60
  s_add_u32 s29, s77, s60
  s_add_u32 s29, s29, 262144
  s_mov_b32 s64, 0
  ds_read_b128 v[48:51], v3 offset:0
  ds_read_b128 v[52:55], v3 offset:1024
  ds_read_b128 v[56:59], v3 offset:2048
  ds_read_b128 v[60:63], v3 offset:3072
  ds_read_b128 v[64:67], v3 offset:4096
  ds_read_b128 v[68:71], v3 offset:5120
  ds_read_b128 v[72:75], v3 offset:6144
  ds_read_b128 v[76:79], v3 offset:7168
  v_mov_b64 v[96:97], 0
  v_mov_b64 v[98:99], 0
  v_mov_b64 v[100:101], 0
  v_mov_b64 v[102:103], 0
  v_mov_b64 v[104:105], 0
  v_mov_b64 v[106:107], 0
  v_mov_b64 v[108:109], 0
  v_mov_b64 v[110:111], 0
  v_mov_b64 v[112:113], 0
  v_mov_b64 v[114:115], 0
  v_mov_b64 v[116:117], 0
  v_mov_b64 v[118:119], 0
  s_and_b32 s60, s76, 1
  s_lshl_b32 s61, s60, 13
  v_add_u32 v8, s61, v0
  s_lshl_b32 s60, s60, 18
  s_add_u32 s21, s60, s78
  s_add_u32 s22, s21, 32768
  s_lshl_b32 s60, s76, 16
  s_add_u32 s27, s60, s83
  s_add_u32 s28, s60, s84
  s_add_u32 s87, s76, 1
  s_min_u32 s87, s87, 63
L_CH_TOPS:
  s_cmp_eq_u32 s16, 0
  s_cbranch_scc1 CHL_114
CHV_113:
  s_sleep 1
  buffer_load_dwordx4 v[120:123], v2, s[32:35], s20 offen offset:0 sc1
  buffer_load_dwordx4 v[124:127], v2, s[32:35], s20 offen offset:1024 sc1
  ds_read_b128 v[80:83], v3 offset:32768
  ds_read_b128 v[84:87], v3 offset:33792
  ds_read_b128 v[88:91], v3 offset:34816
  ds_read_b128 v[92:95], v3 offset:35840
  v_xor_b32 v29, 2048, v24
  v_xor_b32 v30, 4096, v24
  v_xor_b32 v31, 6144, v24
  s_sleep 1
  buffer_load_dwordx4 v[120:123], v2, s[32:35], s20 offen offset:0 sc1
  buffer_load_dwordx4 v[124:127], v2, s[32:35], s20 offen offset:1024 sc1
CG2_117:
  s_waitcnt vmcnt(2)
  v_max_u32 v28, v121, v123
  v_max3_u32 v28, v28, v125, v127
  v_cmp_eq_u32 vcc, -1, v28
  s_cbranch_vccnz CG_115
  ds_write_b128 v24, v[120:123]
  ds_write_b128 v24, v[124:127] offset:1024
  v_smfmac_f32_16x16x64_bf16 v[96:99], v[120:123], a[0:7], v11
  v_smfmac_f32_16x16x64_bf16 v[100:103], v[120:123], a[64:71], v11
  v_smfmac_f32_16x16x64_bf16 v[104:107], v[120:123], a[128:135], v11
  v_smfmac_f32_16x16x64_bf16 v[108:111], v[120:123], a[192:199], v11
  s_waitcnt lgkmcnt(0)
  s_barrier
  ds_read_b128 v[32:35], v29 offset:0
  ds_read_b128 v[36:39], v29 offset:1024
  ds_read_b128 v[40:43], v30 offset:0
  ds_read_b128 v[44:47], v30 offset:1024
  v_readfirstlane_b32 s16, v26
  v_smfmac_f32_16x16x64_bf16 v[96:99], v[124:127], a[8:15], v11
  v_smfmac_f32_16x16x64_bf16 v[100:103], v[124:127], a[72:79], v11
  v_smfmac_f32_16x16x64_bf16 v[104:107], v[124:127], a[136:143], v11
  v_smfmac_f32_16x16x64_bf16 v[108:111], v[124:127], a[200:207], v11
  s_waitcnt lgkmcnt(3)
  v_smfmac_f32_16x16x64_bf16 v[96:99], v[32:35], a[16:23], v11
  v_mov_b32 v28, s76
  buffer_store_dword v28, v25, s[32:35], s85 offen sc1
  v_smfmac_f32_16x16x64_bf16 v[100:103], v[32:35], a[80:87], v11
  s_lshl_b32 s60, s76, 18
  s_add_u32 s60, s60, s81
  v_smfmac_f32_16x16x64_bf16 v[104:107], v[32:35], a[144:151], v11
  buffer_load_dwordx4 v[120:123], v2, s[32:35], s60 offen offset:0 sc1
  buffer_load_dwordx4 v[124:127], v2, s[32:35], s60 offen offset:1024 sc1
  v_smfmac_f32_16x16x64_bf16 v[108:111], v[32:35], a[208:215], v11
  buffer_store_dwordx4 v[4:7], v2, s[32:35], s29 offen offset:0 sc1
  buffer_store_dwordx4 v[4:7], v2, s[32:35], s29 offen offset:1024 sc1
  ds_read_b128 v[32:35], v31 offset:0
  s_waitcnt lgkmcnt(3)
  v_smfmac_f32_16x16x64_bf16 v[96:99], v[36:39], a[24:31], v11
  s_xor_b32 s29, s29, 262144
  s_and_b32 s60, s76, 1
  v_smfmac_f32_16x16x64_bf16 v[100:103], v[36:39], a[88:95], v11
  s_lshl_b32 s60, s60, 18
  s_add_u32 s23, s60, s77
  v_smfmac_f32_16x16x64_bf16 v[104:107], v[36:39], a[152:159], v11
  s_add_u32 s24, s23, 4096
  s_and_b32 s60, s76, 3
  v_smfmac_f32_16x16x64_bf16 v[108:111], v[36:39], a[216:223], v11
  s_lshl_b32 s60, s60, 13
  s_add_u32 s26, s60, s86
  ds_read_b128 v[36:39], v31 offset:1024
  s_waitcnt lgkmcnt(3)
  v_smfmac_f32_16x16x64_bf16 v[96:99], v[40:43], a[32:39], v11
  s_add_u32 s60, s76, 1
  s_and_b32 s60, s60, 3
  v_smfmac_f32_16x16x64_bf16 v[100:103], v[40:43], a[96:103], v11
  s_lshl_b32 s60, s60, 13
  s_add_u32 s25, s60, s86
  v_smfmac_f32_16x16x64_bf16 v[104:107], v[40:43], a[160:167], v11
  s_add_u32 s20, s60, s79
  s_lshl_b32 s60, s56, 11
  v_smfmac_f32_16x16x64_bf16 v[108:111], v[40:43], a[224:231], v11
  s_add_u32 s20, s20, s60
  s_mov_b32 s64, 0
  ds_read_b128 v[40:43], v0 offset:4096
  s_waitcnt lgkmcnt(3)
  v_smfmac_f32_16x16x64_bf16 v[96:99], v[44:47], a[40:47], v11
  s_lshl_b32 s60, s87, 18
  s_add_u32 s61, s60, s80
  v_smfmac_f32_16x16x64_bf16 v[100:103], v[44:47], a[104:111], v11
  s_and_b32 s60, s87, 1
  s_lshl_b32 s60, s60, 3
  v_smfmac_f32_16x16x64_bf16 v[104:107], v[44:47], a[168:175], v11
  s_add_u32 s60, s60, s56
  s_lshl_b32 s60, s60, 10
  v_smfmac_f32_16x16x64_bf16 v[108:111], v[44:47], a[232:239], v11
  s_add_u32 m0, s60, 139264
  s_add_u32 s62, s61, 4096
  ds_read_b128 v[44:47], v0 offset:5120
  s_waitcnt lgkmcnt(3)
  v_smfmac_f32_16x16x64_bf16 v[96:99], v[32:35], a[48:55], v11
  buffer_load_dwordx4 v2, s[32:35], s61 offen sc1 lds
  s_add_u32 m0, m0, 4096
  v_smfmac_f32_16x16x64_bf16 v[100:103], v[32:35], a[112:119], v11
  s_nop 0
  buffer_load_dwordx4 v2, s[32:35], s62 offen sc1 lds
  v_smfmac_f32_16x16x64_bf16 v[104:107], v[32:35], a[176:183], v11
  s_add_u32 s60, s87, 1
  s_min_u32 s60, s60, 63
  v_smfmac_f32_16x16x64_bf16 v[108:111], v[32:35], a[240:247], v11
  s_lshl_b32 s61, s60, 9
  s_add_u32 s61, s61, s82
  ds_read_b128 v[32:35], v0 offset:6144
  s_waitcnt lgkmcnt(3)
  v_smfmac_f32_16x16x64_bf16 v[96:99], v[36:39], a[56:63], v11
  buffer_load_dword v26, v25, s[32:35], s61 offen sc1
  v_smfmac_f32_16x16x64_bf16 v[100:103], v[36:39], a[120:127], v11
  v_smfmac_f32_16x16x64_bf16 v[104:107], v[36:39], a[184:191], v11
  v_smfmac_f32_16x16x64_bf16 v[108:111], v[36:39], a[248:255], v11
  ds_read_b128 v[36:39], v0 offset:7168
  s_waitcnt lgkmcnt(3)
  v_smfmac_f32_16x16x64_bf16 v[112:115], v[40:43], v[48:55], v11
  ds_read_b128 v[48:51], v3 offset:36864
  ds_read_b128 v[52:55], v3 offset:37888
  v_smfmac_f32_16x16x64_bf16 v[116:119], v[40:43], v[56:63], v11
  ds_read_b128 v[56:59], v3 offset:38912
  ds_read_b128 v[60:63], v3 offset:39936
  ds_read_b128 v[40:43], v0 offset:0
  v_pk_add_f32 v[96:97], v[96:97], v[98:99]
  v_pk_add_f32 v[100:101], v[100:101], v[102:103]
  s_waitcnt lgkmcnt(7)
  v_smfmac_f32_16x16x64_bf16 v[112:115], v[44:47], v[64:71], v11
  v_cvt_pk_bf16_f32 v28, v96, v100
  v_cvt_pk_bf16_f32 v29, v97, v101
  v_smfmac_f32_16x16x64_bf16 v[116:119], v[44:47], v[72:79], v11
  ds_read_b128 v[44:47], v0 offset:1024
  ds_write_b32 v16, v28 offset:0
  ds_write_b32 v16, v29 offset:288
  s_waitcnt lgkmcnt(9)
  v_smfmac_f32_16x16x64_bf16 v[112:115], v[32:35], v[80:87], v11
  v_pk_add_f32 v[104:105], v[104:105], v[106:107]
  v_pk_add_f32 v[108:109], v[108:109], v[110:111]
  v_smfmac_f32_16x16x64_bf16 v[116:119], v[32:35], v[88:95], v11
  ds_read_b128 v[32:35], v0 offset:2048
  v_cvt_pk_bf16_f32 v30, v104, v108
  v_cvt_pk_bf16_f32 v31, v105, v109
  s_waitcnt lgkmcnt(7)
  v_smfmac_f32_16x16x64_bf16 v[112:115], v[36:39], v[48:55], v11
  ds_write_b32 v16, v30 offset:2304
  ds_write_b32 v16, v31 offset:2592
  s_waitcnt lgkmcnt(7)
  v_smfmac_f32_16x16x64_bf16 v[116:119], v[36:39], v[56:63], v11
  ds_read_b128 v[36:39], v0 offset:3072
  ds_read_b128 v[48:51], v8 offset:8192
  ds_read_b128 v[52:55], v8 offset:9216
  ds_read_b128 v[56:59], v8 offset:10240
  ds_read_b128 v[60:63], v8 offset:11264
  ds_read_b128 v[64:67], v8 offset:12288
  ds_read_b128 v[68:71], v8 offset:13312
  ds_read_b128 v[72:75], v8 offset:14336
  ds_read_b128 v[76:79], v8 offset:15360
  s_waitcnt lgkmcnt(9)
  s_barrier
  ds_read_b128 v[96:99], v17 offset:0
  v_smfmac_f32_16x16x64_bf16 v[112:115], v[40:43], v[128:135], v11
  ds_read_b128 v[80:83], v18 offset:0
  v_smfmac_f32_16x16x64_bf16 v[116:119], v[40:43], v[136:143], v11
  ds_read_b128 v[100:103], v17 offset:64
  v_smfmac_f32_16x16x64_bf16 v[112:115], v[44:47], v[144:151], v11
  ds_read_b128 v[84:87], v18 offset:64
  v_smfmac_f32_16x16x64_bf16 v[116:119], v[44:47], v[152:159], v11
  ds_read_b128 v[104:107], v17 offset:128
  v_smfmac_f32_16x16x64_bf16 v[112:115], v[32:35], v[160:167], v11
  ds_read_b128 v[88:91], v18 offset:128
  v_smfmac_f32_16x16x64_bf16 v[116:119], v[32:35], v[168:175], v11
  ds_read_b128 v[108:111], v17 offset:192
  s_waitcnt lgkmcnt(15)
  v_smfmac_f32_16x16x64_bf16 v[112:115], v[36:39], v[176:183], v11
  ds_read_b128 v[92:95], v18 offset:192
  v_smfmac_f32_16x16x64_bf16 v[116:119], v[36:39], v[184:191], v11
  ds_read_b128 v[32:35], v27
  s_waitcnt lgkmcnt(7)
  v_mfma_f32_16x16x32_bf16 v[36:39], v[48:51], v[96:99], 0
  v_mfma_f32_16x16x32_bf16 v[40:43], v[64:67], v[96:99], 0
  v_mfma_f32_16x16x32_bf16 v[44:47], v[80:83], v[96:99], 0
  s_nop 0
  v_pk_add_f32 v[112:113], v[112:113], v[114:115]
  s_nop 0
  v_pk_add_f32 v[116:117], v[116:117], v[118:119]
  s_waitcnt lgkmcnt(5)
  v_mfma_f32_16x16x32_bf16 v[36:39], v[52:55], v[100:103], v[36:39]
  v_cvt_pk_bf16_f32 v30, v112, v113
  v_cvt_pk_bf16_f32 v31, v116, v117
  v_mfma_f32_16x16x32_bf16 v[40:43], v[68:71], v[100:103], v[40:43]
  buffer_store_dwordx2 v[30:31], v23, s[32:35], s28 offen sc1
  v_mov_b32 v112, v30
  v_mfma_f32_16x16x32_bf16 v[44:47], v[84:87], v[100:103], v[44:47]
  v_mov_b32 v113, 0
  v_mov_b32 v114, v31
  s_waitcnt lgkmcnt(3)
  v_mfma_f32_16x16x32_bf16 v[36:39], v[56:59], v[104:107], v[36:39]
  v_mov_b32 v115, 0
  v_mfma_f32_16x16x32_bf16 v[40:43], v[72:75], v[104:107], v[40:43]
  v_mfma_f32_16x16x32_bf16 v[44:47], v[88:91], v[104:107], v[44:47]
  s_waitcnt lgkmcnt(1)
  v_mfma_f32_16x16x32_bf16 v[36:39], v[60:63], v[108:111], v[36:39]
  v_mfma_f32_16x16x32_bf16 v[40:43], v[76:79], v[108:111], v[40:43]
  v_mfma_f32_16x16x32_bf16 v[44:47], v[92:95], v[108:111], v[44:47]
  s_waitcnt lgkmcnt(0)
  buffer_store_dwordx4 v[32:35], v22, s[32:35], s27 offen sc1
  s_cmp_eq_u32 s76, 63
  s_cbranch_scc1 L_CH_FINS
  ds_read_b128 v[80:83], v9 offset:0
  ds_read_b128 v[84:87], v9 offset:1024
  ds_read_b128 v[88:91], v9 offset:2048
  ds_read_b128 v[92:95], v9 offset:3072
  ds_read_b128 v[96:99], v9 offset:4096
  ds_read_b128 v[100:103], v9 offset:5120
  ds_read_b128 v[104:107], v9 offset:6144
  ds_read_b128 v[108:111], v9 offset:7168
  v_max3_f32 v28, v36, v37, v38
  v_max3_f32 v29, v39, v40, v41
  v_max3_f32 v28, v28, v42, v43
  v_max3_f32 v29, v29, v44, v45
  v_max_f32 v28, v28, v29
  v_mov_b32 v29, v28
  v_mov_b64 v[78:79], 0
  v_mov_b64 v[76:77], 0
  v_permlane16_swap_b32 v28, v29
  v_max_f32 v28, v28, v29
  v_mov_b32 v29, v28
  v_mov_b64 v[74:75], 0
  v_mov_b64 v[72:73], 0
  v_permlane32_swap_b32 v28, v29
  v_max_f32 v28, v28, v29
  v_mul_f32 v28, s88, v28
  v_pk_fma_f32 v[36:37], v[36:37], s[30:31], v[28:29] op_sel_hi:[1,1,0] neg_lo:[0,0,1] neg_hi:[0,0,1]
  v_pk_fma_f32 v[38:39], v[38:39], s[30:31], v[28:29] op_sel_hi:[1,1,0] neg_lo:[0,0,1] neg_hi:[0,0,1]
  v_pk_fma_f32 v[40:41], v[40:41], s[30:31], v[28:29] op_sel_hi:[1,1,0] neg_lo:[0,0,1] neg_hi:[0,0,1]
  v_pk_fma_f32 v[42:43], v[42:43], s[30:31], v[28:29] op_sel_hi:[1,1,0] neg_lo:[0,0,1] neg_hi:[0,0,1]
  v_pk_fma_f32 v[44:45], v[44:45], s[30:31], v[28:29] op_sel_hi:[1,1,0] neg_lo:[0,0,1] neg_hi:[0,0,1]
  v_exp_f32 v36, v36
  v_exp_f32 v37, v37
  v_exp_f32 v38, v38
  v_exp_f32 v39, v39
  v_exp_f32 v40, v40
  v_exp_f32 v41, v41
  v_exp_f32 v42, v42
  v_exp_f32 v43, v43
  v_exp_f32 v44, v44
  v_exp_f32 v45, v45
  v_mov_b32 v117, 0
  v_cvt_pk_bf16_f32 v32, v36, v37
  v_cvt_pk_bf16_f32 v33, v38, v39
  v_cvt_pk_bf16_f32 v34, v40, v41
  v_cvt_pk_bf16_f32 v35, v42, v43
  v_cvt_pk_bf16_f32 v116, v44, v45
  v_pk_add_f32 v[28:29], v[36:37], v[38:39]
  v_pk_add_f32 v[30:31], v[40:41], v[42:43]
  s_waitcnt vmcnt(5)
  v_mfma_f32_16x16x32_bf16 v[36:39], v[120:123], v[32:35], 0
  v_mfma_f32_16x16x32_bf16 v[40:43], v[124:127], v[32:35], 0
  v_mfma_f32_16x16x16_bf16 v[36:39], v[112:113], v[116:117], v[36:39]
  v_mfma_f32_16x16x16_bf16 v[40:43], v[114:115], v[116:117], v[40:43]
  v_pk_add_f32 v[28:29], v[28:29], v[44:45]
  v_pk_add_f32 v[28:29], v[28:29], v[30:31]
  v_add_f32 v28, v28, v29
  v_mov_b32 v29, v28
  v_mov_b64 v[70:71], 0
  v_mov_b64 v[68:69], 0
  v_permlane16_swap_b32 v28, v29
  v_add_f32 v28, v28, v29
  v_mov_b32 v29, v28
  v_mov_b64 v[66:67], 0
  v_mov_b64 v[64:65], 0
  v_permlane32_swap_b32 v28, v29
  v_add_f32 v28, v28, v29
  v_rcp_f32 v28, v28
  v_mov_b64 v[62:63], 0
  v_pk_mul_f32 v[36:37], v[36:37], v[28:29] op_sel_hi:[1,0]
  v_pk_mul_f32 v[38:39], v[38:39], v[28:29] op_sel_hi:[1,0]
  v_pk_mul_f32 v[40:41], v[40:41], v[28:29] op_sel_hi:[1,0]
  v_pk_mul_f32 v[42:43], v[42:43], v[28:29] op_sel_hi:[1,0]
  v_cvt_pk_bf16_f32 v44, v36, v37
  v_cvt_pk_bf16_f32 v45, v38, v39
  v_cvt_pk_bf16_f32 v46, v40, v41
  v_cvt_pk_bf16_f32 v47, v42, v43
  s_mov_b64 exec, s[90:91]
  ds_write_b128 v19, v[44:47]
  s_mov_b64 exec, -1
  v_mov_b64 v[60:61], 0
  v_mov_b64 v[58:59], 0
  v_mov_b64 v[56:57], 0
  v_mov_b64 v[54:55], 0
  v_mov_b64 v[52:53], 0
  v_mov_b64 v[50:51], 0
  v_mov_b64 v[48:49], 0
  s_waitcnt lgkmcnt(0)
  s_barrier
  ds_read_b128 v[120:123], v20 offset:0
  ds_read_b128 v[124:127], v20 offset:128
  s_waitcnt lgkmcnt(1)
  v_smfmac_f32_16x16x64_bf16 v[64:67], v[120:123], v[80:87], v11
  ds_read_b128 v[80:83], v9 offset:32768
  ds_read_b128 v[84:87], v9 offset:33792
  v_smfmac_f32_16x16x64_bf16 v[68:71], v[120:123], v[88:95], v11
  ds_read_b128 v[88:91], v9 offset:34816
  ds_read_b128 v[92:95], v9 offset:35840
  v_smfmac_f32_16x16x64_bf16 v[72:75], v[120:123], v[96:103], v11
  ds_read_b128 v[96:99], v9 offset:36864
  ds_read_b128 v[100:103], v9 offset:37888
  v_smfmac_f32_16x16x64_bf16 v[76:79], v[120:123], v[104:111], v11
  ds_read_b128 v[104:107], v9 offset:38912
  ds_read_b128 v[108:111], v9 offset:39936
  v_smfmac_f32_16x16x64_bf16 v[48:51], v[120:123], v[192:199], v11
  v_smfmac_f32_16x16x64_bf16 v[52:55], v[120:123], v[208:215], v11
  v_smfmac_f32_16x16x64_bf16 v[56:59], v[120:123], v[224:231], v11
  v_smfmac_f32_16x16x64_bf16 v[60:63], v[120:123], v[240:247], v11
  s_waitcnt lgkmcnt(8)
  v_smfmac_f32_16x16x64_bf16 v[48:51], v[124:127], v[200:207], v11
  v_smfmac_f32_16x16x64_bf16 v[52:55], v[124:127], v[216:223], v11
  v_smfmac_f32_16x16x64_bf16 v[56:59], v[124:127], v[232:239], v11
  v_smfmac_f32_16x16x64_bf16 v[60:63], v[124:127], v[248:255], v11
  s_waitcnt lgkmcnt(0)
  v_smfmac_f32_16x16x64_bf16 v[64:67], v[124:127], v[80:87], v11
  s_nop 2
  v_pk_add_f32 v[48:49], v[48:49], v[50:51]
  v_smfmac_f32_16x16x64_bf16 v[68:71], v[124:127], v[88:95], v11
  v_cvt_pk_bf16_f32 v32, v48, v49
  v_pk_add_f32 v[52:53], v[52:53], v[54:55]
  v_cvt_pk_bf16_f32 v33, v52, v53
  v_smfmac_f32_16x16x64_bf16 v[72:75], v[124:127], v[96:103], v11
  v_pk_add_f32 v[56:57], v[56:57], v[58:59]
  v_cvt_pk_bf16_f32 v34, v56, v57
  v_pk_add_f32 v[60:61], v[60:61], v[62:63]
  v_smfmac_f32_16x16x64_bf16 v[76:79], v[124:127], v[104:111], v11
  v_cvt_pk_bf16_f32 v35, v60, v61
  v_min_u32 v35, -2, v35
  buffer_store_dwordx4 v[32:35], v21, s[32:35], s21 offen sc1
  v_pk_add_f32 v[64:65], v[64:65], v[66:67]
  v_cvt_pk_bf16_f32 v36, v64, v65
  v_pk_add_f32 v[68:69], v[68:69], v[70:71]
  v_cvt_pk_bf16_f32 v37, v68, v69
  v_pk_add_f32 v[72:73], v[72:73], v[74:75]
  v_cvt_pk_bf16_f32 v38, v72, v73
  v_pk_add_f32 v[76:77], v[76:77], v[78:79]
  v_cvt_pk_bf16_f32 v39, v76, v77
  v_min_u32 v39, -2, v39
  buffer_store_dwordx4 v[36:39], v21, s[32:35], s22 offen sc1
  ds_read_b128 v[48:51], v3 offset:0
  ds_read_b128 v[52:55], v3 offset:1024
  ds_read_b128 v[56:59], v3 offset:2048
  ds_read_b128 v[60:63], v3 offset:3072
  ds_read_b128 v[64:67], v3 offset:4096
  ds_read_b128 v[68:71], v3 offset:5120
  ds_read_b128 v[72:75], v3 offset:6144
  ds_read_b128 v[76:79], v3 offset:7168
  s_add_u32 s19, s76, 1
  v_mov_b64 v[96:97], 0
  v_mov_b64 v[98:99], 0
  v_mov_b64 v[100:101], 0
  v_mov_b64 v[102:103], 0
  v_mov_b64 v[104:105], 0
  v_mov_b64 v[106:107], 0
  v_mov_b64 v[108:109], 0
  v_mov_b64 v[110:111], 0
  v_mov_b64 v[112:113], 0
  v_mov_b64 v[114:115], 0
  v_mov_b64 v[116:117], 0
  v_mov_b64 v[118:119], 0
  s_and_b32 s60, s19, 1
  s_lshl_b32 s61, s60, 13
  v_add_u32 v8, s61, v0
  s_lshl_b32 s60, s60, 18
  s_add_u32 s21, s60, s78
  s_add_u32 s22, s21, 32768
  s_lshl_b32 s60, s19, 16
  s_add_u32 s27, s60, s83
  s_add_u32 s28, s60, s84
  s_add_u32 s87, s19, 1
  s_min_u32 s87, s87, 63
  v_readfirstlane_b32 s60, v26
  s_cmp_eq_u32 s60, 0
  s_cbranch_scc1 CRS1_118
CRS2_119:
  s_cmp_lg_u32 s56, 0
  s_cbranch_scc1 CRW_121
  s_sleep 4
CND_124:
CRL_122:
  buffer_load_dwordx4 v[32:35], v2, s[32:35], s23 offen offset:0 sc1
  buffer_load_dwordx4 v[36:39], v2, s[32:35], s23 offen offset:1024 sc1
  buffer_load_dwordx4 v[40:43], v2, s[32:35], s23 offen offset:2048 sc1
  buffer_load_dwordx4 v[44:47], v2, s[32:35], s23 offen offset:3072 sc1
  buffer_load_dwordx4 v[80:83], v2, s[32:35], s24 offen offset:0 sc1
  buffer_load_dwordx4 v[84:87], v2, s[32:35], s24 offen offset:1024 sc1
  buffer_load_dwordx4 v[88:91], v2, s[32:35], s24 offen offset:2048 sc1
  buffer_load_dwordx4 v[92:95], v2, s[32:35], s24 offen offset:3072 sc1
  s_waitcnt vmcnt(7)
  v_mfma_f32_16x16x32_bf16 v[120:123], v[12:15], v[32:35], 0
  s_waitcnt vmcnt(6)
  v_mfma_f32_16x16x32_bf16 v[120:123], v[12:15], v[36:39], v[120:123]
  v_max_u32 v28, v35, v39
  s_waitcnt vmcnt(5)
  v_mfma_f32_16x16x32_bf16 v[120:123], v[12:15], v[40:43], v[120:123]
  s_waitcnt vmcnt(4)
  v_mfma_f32_16x16x32_bf16 v[120:123], v[12:15], v[44:47], v[120:123]
  v_max3_u32 v28, v28, v43, v47
  s_waitcnt vmcnt(3)
  v_mfma_f32_16x16x32_bf16 v[120:123], v[12:15], v[80:83], v[120:123]
  s_waitcnt vmcnt(2)
  v_mfma_f32_16x16x32_bf16 v[120:123], v[12:15], v[84:87], v[120:123]
  v_max3_u32 v28, v28, v83, v87
  s_waitcnt vmcnt(1)
  v_mfma_f32_16x16x32_bf16 v[120:123], v[12:15], v[88:91], v[120:123]
  s_waitcnt vmcnt(0)
  v_mfma_f32_16x16x32_bf16 v[120:123], v[12:15], v[92:95], v[120:123]
  v_max3_u32 v28, v28, v91, v95
  v_cmp_eq_u32 vcc, -1, v28
  s_cbranch_vccnz CRD_123
  s_nop 4
  v_cvt_pk_bf16_f32 v28, v120, v121
  v_cvt_pk_bf16_f32 v29, v122, v123
  v_min_u32 v29, -2, v29
  s_mov_b64 exec, s[66:67]
  buffer_store_dwordx2 v[28:29], v10, s[32:35], s25 offen sc1
  buffer_store_dwordx2 v[4:5], v10, s[32:35], s26 offen sc1
  s_mov_b64 exec, -1
CRW_121:
CRS_120:
  s_add_u32 s76, s76, 1
  s_barrier
  s_branch L_CH_TOPS
CHL_114:
  v_mov_b32 v30, v26
  s_mov_b32 s87, s76
  s_lshl_b32 s61, s87, 9
  s_add_u32 s61, s61, s82
CKV_125:
  buffer_load_dword v26, v25, s[32:35], s61 offen sc1
  s_waitcnt vmcnt(0)
  v_readfirstlane_b32 s60, v26
  s_cmp_lg_u32 s60, 0
  s_cbranch_scc1 CKVOK_126
  s_add_u32 s64, s64, 1
  s_cmp_lt_u32 s64, 131072
  s_cbranch_scc1 SPOK_127
  s_mov_b32 s63, 4
  s_branch L_ABORT
SPOK_127:
  s_sleep 1
  s_branch CKV_125
CKVOK_126:
  s_lshl_b32 s60, s87, 18
  s_add_u32 s61, s60, s80
  s_and_b32 s60, s87, 1
  s_lshl_b32 s60, s60, 3
  s_add_u32 s60, s60, s56
  s_lshl_b32 s60, s60, 10
  s_add_u32 m0, s60, 139264
  s_add_u32 s62, s61, 4096
  buffer_load_dwordx4 v2, s[32:35], s61 offen sc1 lds
  s_add_u32 m0, m0, 4096
  s_nop 0
  buffer_load_dwordx4 v2, s[32:35], s62 offen sc1 lds
  v_mov_b32 v26, v30
  s_mov_b32 s64, 0
  s_add_u32 s87, s76, 1
  s_min_u32 s87, s87, 63
  s_branch CHV_113
CG_115:
  buffer_load_dwordx4 v[120:123], v2, s[32:35], s20 offen offset:0 sc1
  buffer_load_dwordx4 v[124:127], v2, s[32:35], s20 offen offset:1024 sc1
  s_add_u32 s64, s64, 1
  s_cmp_lt_u32 s64, 131072
  s_cbranch_scc1 SPOK_128
  s_mov_b32 s63, 5
  s_branch L_ABORT
SPOK_128:
  s_branch CG2_117
CRS1_118:
  s_lshl_b32 s61, s87, 9
  s_add_u32 s61, s61, s82
  buffer_load_dword v26, v25, s[32:35], s61 offen sc1
  s_branch CRS2_119
CRD_123:
  s_add_u32 s64, s64, 1
  s_cmp_lt_u32 s64, 131072
  s_cbranch_scc1 SPOK_129
  s_mov_b32 s63, 6
  s_branch L_ABORT
SPOK_129:
  s_branch CRL_122
L_CH_FINS:
  s_waitcnt vmcnt(0)
  s_mov_b64 exec, 1
  v_mov_b32 v28, 64
  v_mov_b32 v29, 0
  buffer_store_dword v28, v29, s[32:35], s85 offen sc1
  s_mov_b64 exec, -1
  s_branch L_END
L_AO:
  s_sub_u32 s70, s57, 128
  s_lshr_b32 s71, s70, 4
  s_and_b32 s70, s70, 15
  s_cmp_lg_u32 s56, 0
  s_cbranch_scc1 GR_130
  s_mov_b64 exec, 1
  s_lshl_b32 s60, 1, s58
  v_mov_b32 v3, s60
  s_lshl_b32 s60, s71, 2
  v_mov_b32 v4, 32
  buffer_atomic_or v3, v4, s[36:39], s60 offen
  s_mov_b64 exec, -1
GR_130:
  s_cmp_lg_u32 s56, 0
  s_cbranch_scc1 IA_131
  s_waitcnt vmcnt(0)
  s_mov_b64 exec, 1
  v_mov_b32 v30, 1
  v_mov_b32 v31, 12
  buffer_atomic_add v30, v31, s[36:39], 0 offen
  s_mov_b64 exec, -1
IA_131:
  s_mov_b32 s40, s14
  s_and_b32 s41, s15, 0xffff
  s_mov_b32 s42, 4194304
  s_mov_b32 s43, 0x20000
  s_lshl_b32 s74, s70, 18
  s_lshl_b32 s60, s56, 8
  s_add_u32 s74, s74, s60
  v_lshrrev_b32 v3, 4, v1
  v_bfe_u32 v4, v1, 2, 2
  v_lshl_add_u32 v3, v3, 3, v4
  v_lshlrev_b32 v3, 8, v3
  v_and_b32 v5, 3, v1
  v_lshl_add_u32 v3, v5, 4, v3
  s_lshl_b32 s60, s56, 13
  v_add_u32 v3, s60, v3
  v_xor_b32 v5, 0, v4
  v_lshl_add_u32 v20, v5, 6, v3
  v_add_u32 v21, 0x10000, v20
  v_xor_b32 v5, 1, v4
  v_lshl_add_u32 v22, v5, 6, v3
  v_add_u32 v23, 0x10000, v22
  v_xor_b32 v5, 2, v4
  v_lshl_add_u32 v24, v5, 6, v3
  v_add_u32 v25, 0x10000, v24
  v_xor_b32 v5, 3, v4
  v_lshl_add_u32 v26, v5, 6, v3
  v_add_u32 v27, 0x10000, v26
  s_mov_b32 s73, 1024
  v_lshrrev_b32 v3, 4, v1
  v_mul_lo_u32 v16, v3, s73
  v_lshlrev_b32 v3, 2, v3
  v_and_b32 v4, 15, v1
  v_xor_b32 v3, v3, v4
  v_lshl_add_u32 v16, v3, 4, v16
  s_lshl_b32 s73, s56, 13
  s_add_u32 m0, s73, 32768
  s_add_u32 s73, s74, 0
  buffer_load_dwordx4 v16, s[40:43], s73 offen lds
  s_add_u32 m0, m0, 1024
  s_add_u32 s73, s73, 4096
  buffer_load_dwordx4 v16, s[40:43], s73 offen lds
  s_add_u32 m0, m0, 1024
  s_add_u32 s73, s73, 4096
  buffer_load_dwordx4 v16, s[40:43], s73 offen lds
  s_add_u32 m0, m0, 1024
  s_add_u32 s73, s73, 4096
  buffer_load_dwordx4 v16, s[40:43], s73 offen lds
  s_add_u32 m0, m0, 1024
  s_add_u32 s73, s73, 4096
  buffer_load_dwordx4 v16, s[40:43], s73 offen lds
  s_add_u32 m0, m0, 1024
  s_add_u32 s73, s73, 4096
  buffer_load_dwordx4 v16, s[40:43], s73 offen lds
  s_add_u32 m0, m0, 1024
  s_add_u32 s73, s73, 4096
  buffer_load_dwordx4 v16, s[40:43], s73 offen lds
  s_add_u32 m0, m0, 1024
  s_add_u32 s73, s73, 4096
  buffer_load_dwordx4 v16, s[40:43], s73 offen lds
  s_lshl_b32 s73, s56, 13
  s_add_u32 m0, s73, 65536
  s_add_u32 s73, s74, 32768
  buffer_load_dwordx4 v16, s[40:43], s73 offen lds
  s_add_u32 m0, m0, 1024
  s_add_u32 s73, s73, 4096
  buffer_load_dwordx4 v16, s[40:43], s73 offen lds
  s_add_u32 m0, m0, 1024
  s_add_u32 s73, s73, 4096
  buffer_load_dwordx4 v16, s[40:43], s73 offen lds
  s_add_u32 m0, m0, 1024
  s_add_u32 s73, s73, 4096
  buffer_load_dwordx4 v16, s[40:43], s73 offen lds
  s_add_u32 m0, m0, 1024
  s_add_u32 s73, s73, 4096
  buffer_load_dwordx4 v16, s[40:43], s73 offen lds
  s_add_u32 m0, m0, 1024
  s_add_u32 s73, s73, 4096
  buffer_load_dwordx4 v16, s[40:43], s73 offen lds
  s_add_u32 m0, m0, 1024
  s_add_u32 s73, s73, 4096
  buffer_load_dwordx4 v16, s[40:43], s73 offen lds
  s_add_u32 m0, m0, 1024
  s_add_u32 s73, s73, 4096
  buffer_load_dwordx4 v16, s[40:43], s73 offen lds
  s_lshl_b32 s73, s56, 13
  s_add_u32 m0, s73, 98304
  s_add_u32 s73, s74, 65536
  buffer_load_dwordx4 v16, s[40:43], s73 offen lds
  s_add_u32 m0, m0, 1024
  s_add_u32 s73, s73, 4096
  buffer_load_dwordx4 v16, s[40:43], s73 offen lds
  s_add_u32 m0, m0, 1024
  s_add_u32 s73, s73, 4096
  buffer_load_dwordx4 v16, s[40:43], s73 offen lds
  s_add_u32 m0, m0, 1024
  s_add_u32 s73, s73, 4096
  buffer_load_dwordx4 v16, s[40:43], s73 offen lds
  s_add_u32 m0, m0, 1024
  s_add_u32 s73, s73, 4096
  buffer_load_dwordx4 v16, s[40:43], s73 offen lds
  s_add_u32 m0, m0, 1024
  s_add_u32 s73, s73, 4096
  buffer_load_dwordx4 v16, s[40:43], s73 offen lds
  s_add_u32 m0, m0, 1024
  s_add_u32 s73, s73, 4096
  buffer_load_dwordx4 v16, s[40:43], s73 offen lds
  s_add_u32 m0, m0, 1024
  s_add_u32 s73, s73, 4096
  buffer_load_dwordx4 v16, s[40:43], s73 offen lds
  s_lshl_b32 s73, s56, 13
  s_add_u32 m0, s73, 131072
  s_add_u32 s73, s74, 98304
  buffer_load_dwordx4 v16, s[40:43], s73 offen lds
  s_add_u32 m0, m0, 1024
  s_add_u32 s73, s73, 4096
  buffer_load_dwordx4 v16, s[40:43], s73 offen lds
  s_add_u32 m0, m0, 1024
  s_add_u32 s73, s73, 4096
  buffer_load_dwordx4 v16, s[40:43], s73 offen lds
  s_add_u32 m0, m0, 1024
  s_add_u32 s73, s73, 4096
  buffer_load_dwordx4 v16, s[40:43], s73 offen lds
  s_add_u32 m0, m0, 1024
  s_add_u32 s73, s73, 4096
  buffer_load_dwordx4 v16, s[40:43], s73 offen lds
  s_add_u32 m0, m0, 1024
  s_add_u32 s73, s73, 4096
  buffer_load_dwordx4 v16, s[40:43], s73 offen lds
  s_add_u32 m0, m0, 1024
  s_add_u32 s73, s73, 4096
  buffer_load_dwordx4 v16, s[40:43], s73 offen lds
  s_add_u32 m0, m0, 1024
  s_add_u32 s73, s73, 4096
  buffer_load_dwordx4 v16, s[40:43], s73 offen lds
  s_lshl_b32 s73, s56, 13
  s_add_u32 m0, s73, 0
  s_add_u32 s73, s74, 131072
  buffer_load_dwordx4 v16, s[40:43], s73 offen lds
  s_add_u32 m0, m0, 1024
  s_add_u32 s73, s73, 4096
  buffer_load_dwordx4 v16, s[40:43], s73 offen lds
  s_add_u32 m0, m0, 1024
  s_add_u32 s73, s73, 4096
  buffer_load_dwordx4 v16, s[40:43], s73 offen lds
  s_add_u32 m0, m0, 1024
  s_add_u32 s73, s73, 4096
  buffer_load_dwordx4 v16, s[40:43], s73 offen lds
  s_add_u32 m0, m0, 1024
  s_add_u32 s73, s73, 4096
  buffer_load_dwordx4 v16, s[40:43], s73 offen lds
  s_add_u32 m0, m0, 1024
  s_add_u32 s73, s73, 4096
  buffer_load_dwordx4 v16, s[40:43], s73 offen lds
  s_add_u32 m0, m0, 1024
  s_add_u32 s73, s73, 4096
  buffer_load_dwordx4 v16, s[40:43], s73 offen lds
  s_add_u32 m0, m0, 1024
  s_add_u32 s73, s73, 4096
  buffer_load_dwordx4 v16, s[40:43], s73 offen lds
  s_waitcnt vmcnt(32)
  s_barrier
  ds_read_b64_tr_b16 a[0:1], v20 offset:32768
  ds_read_b64_tr_b16 a[2:3], v20 offset:33792
  ds_read_b64_tr_b16 a[32:33], v20 offset:32776
  ds_read_b64_tr_b16 a[34:35], v20 offset:33800
  ds_read_b64_tr_b16 a[64:65], v22 offset:32768
  ds_read_b64_tr_b16 a[66:67], v22 offset:33792
  ds_read_b64_tr_b16 a[96:97], v22 offset:32776
  ds_read_b64_tr_b16 a[98:99], v22 offset:33800
  ds_read_b64_tr_b16 a[128:129], v24 offset:32768
  ds_read_b64_tr_b16 a[130:131], v24 offset:33792
  ds_read_b64_tr_b16 a[160:161], v24 offset:32776
  ds_read_b64_tr_b16 a[162:163], v24 offset:33800
  ds_read_b64_tr_b16 a[192:193], v26 offset:32768
  ds_read_b64_tr_b16 a[194:195], v26 offset:33792
  ds_read_b64_tr_b16 a[224:225], v26 offset:32776
  ds_read_b64_tr_b16 a[226:227], v26 offset:33800
  s_waitcnt lgkmcnt(0)
  s_waitcnt vmcnt(24)
  s_barrier
  s_lshl_b32 s73, s56, 13
  s_add_u32 m0, s73, 32768
  s_add_u32 s73, s74, 163840
  buffer_load_dwordx4 v16, s[40:43], s73 offen lds
  s_add_u32 m0, m0, 1024
  s_add_u32 s73, s73, 4096
  buffer_load_dwordx4 v16, s[40:43], s73 offen lds
  s_add_u32 m0, m0, 1024
  s_add_u32 s73, s73, 4096
  buffer_load_dwordx4 v16, s[40:43], s73 offen lds
  s_add_u32 m0, m0, 1024
  s_add_u32 s73, s73, 4096
  buffer_load_dwordx4 v16, s[40:43], s73 offen lds
  s_add_u32 m0, m0, 1024
  s_add_u32 s73, s73, 4096
  buffer_load_dwordx4 v16, s[40:43], s73 offen lds
  s_add_u32 m0, m0, 1024
  s_add_u32 s73, s73, 4096
  buffer_load_dwordx4 v16, s[40:43], s73 offen lds
  s_add_u32 m0, m0, 1024
  s_add_u32 s73, s73, 4096
  buffer_load_dwordx4 v16, s[40:43], s73 offen lds
  s_add_u32 m0, m0, 1024
  s_add_u32 s73, s73, 4096
  buffer_load_dwordx4 v16, s[40:43], s73 offen lds
  ds_read_b64_tr_b16 a[4:5], v21 offset:0
  ds_read_b64_tr_b16 a[6:7], v21 offset:1024
  ds_read_b64_tr_b16 a[36:37], v21 offset:8
  ds_read_b64_tr_b16 a[38:39], v21 offset:1032
  ds_read_b64_tr_b16 a[68:69], v23 offset:0
  ds_read_b64_tr_b16 a[70:71], v23 offset:1024
  ds_read_b64_tr_b16 a[100:101], v23 offset:8
  ds_read_b64_tr_b16 a[102:103], v23 offset:1032
  ds_read_b64_tr_b16 a[132:133], v25 offset:0
  ds_read_b64_tr_b16 a[134:135], v25 offset:1024
  ds_read_b64_tr_b16 a[164:165], v25 offset:8
  ds_read_b64_tr_b16 a[166:167], v25 offset:1032
  ds_read_b64_tr_b16 a[196:197], v27 offset:0
  ds_read_b64_tr_b16 a[198:199], v27 offset:1024
  ds_read_b64_tr_b16 a[228:229], v27 offset:8
  ds_read_b64_tr_b16 a[230:231], v27 offset:1032
  s_waitcnt lgkmcnt(0)
  s_waitcnt vmcnt(24)
  s_barrier
  s_lshl_b32 s73, s56, 13
  s_add_u32 m0, s73, 65536
  s_add_u32 s73, s74, 196608
  buffer_load_dwordx4 v16, s[40:43], s73 offen lds
  s_add_u32 m0, m0, 1024
  s_add_u32 s73, s73, 4096
  buffer_load_dwordx4 v16, s[40:43], s73 offen lds
  s_add_u32 m0, m0, 1024
  s_add_u32 s73, s73, 4096
  buffer_load_dwordx4 v16, s[40:43], s73 offen lds
  s_add_u32 m0, m0, 1024
  s_add_u32 s73, s73, 4096
  buffer_load_dwordx4 v16, s[40:43], s73 offen lds
  s_add_u32 m0, m0, 1024
  s_add_u32 s73, s73, 4096
  buffer_load_dwordx4 v16, s[40:43], s73 offen lds
  s_add_u32 m0, m0, 1024
  s_add_u32 s73, s73, 4096
  buffer_load_dwordx4 v16, s[40:43], s73 offen lds
  s_add_u32 m0, m0, 1024
  s_add_u32 s73, s73, 4096
  buffer_load_dwordx4 v16, s[40:43], s73 offen lds
  s_add_u32 m0, m0, 1024
  s_add_u32 s73, s73, 4096
  buffer_load_dwordx4 v16, s[40:43], s73 offen lds
  ds_read_b64_tr_b16 a[8:9], v21 offset:32768
  ds_read_b64_tr_b16 a[10:11], v21 offset:33792
  ds_read_b64_tr_b16 a[40:41], v21 offset:32776
  ds_read_b64_tr_b16 a[42:43], v21 offset:33800
  ds_read_b64_tr_b16 a[72:73], v23 offset:32768
  ds_read_b64_tr_b16 a[74:75], v23 offset:33792
  ds_read_b64_tr_b16 a[104:105], v23 offset:32776
  ds_read_b64_tr_b16 a[106:107], v23 offset:33800
  ds_read_b64_tr_b16 a[136:137], v25 offset:32768
  ds_read_b64_tr_b16 a[138:139], v25 offset:33792
  ds_read_b64_tr_b16 a[168:169], v25 offset:32776
  ds_read_b64_tr_b16 a[170:171], v25 offset:33800
  ds_read_b64_tr_b16 a[200:201], v27 offset:32768
  ds_read_b64_tr_b16 a[202:203], v27 offset:33792
  ds_read_b64_tr_b16 a[232:233], v27 offset:32776
  ds_read_b64_tr_b16 a[234:235], v27 offset:33800
  s_waitcnt lgkmcnt(0)
  s_waitcnt vmcnt(24)
  s_barrier
  s_lshl_b32 s73, s56, 13
  s_add_u32 m0, s73, 98304
  s_add_u32 s73, s74, 229376
  buffer_load_dwordx4 v16, s[40:43], s73 offen lds
  s_add_u32 m0, m0, 1024
  s_add_u32 s73, s73, 4096
  buffer_load_dwordx4 v16, s[40:43], s73 offen lds
  s_add_u32 m0, m0, 1024
  s_add_u32 s73, s73, 4096
  buffer_load_dwordx4 v16, s[40:43], s73 offen lds
  s_add_u32 m0, m0, 1024
  s_add_u32 s73, s73, 4096
  buffer_load_dwordx4 v16, s[40:43], s73 offen lds
  s_add_u32 m0, m0, 1024
  s_add_u32 s73, s73, 4096
  buffer_load_dwordx4 v16, s[40:43], s73 offen lds
  s_add_u32 m0, m0, 1024
  s_add_u32 s73, s73, 4096
  buffer_load_dwordx4 v16, s[40:43], s73 offen lds
  s_add_u32 m0, m0, 1024
  s_add_u32 s73, s73, 4096
  buffer_load_dwordx4 v16, s[40:43], s73 offen lds
  s_add_u32 m0, m0, 1024
  s_add_u32 s73, s73, 4096
  buffer_load_dwordx4 v16, s[40:43], s73 offen lds
  v_add_u32 v5, 0x10000, v21
  ds_read_b64_tr_b16 a[12:13], v5 offset:0
  ds_read_b64_tr_b16 a[14:15], v5 offset:1024
  ds_read_b64_tr_b16 a[44:45], v5 offset:8
  ds_read_b64_tr_b16 a[46:47], v5 offset:1032
  v_add_u32 v5, 0x10000, v23
  ds_read_b64_tr_b16 a[76:77], v5 offset:0
  ds_read_b64_tr_b16 a[78:79], v5 offset:1024
  ds_read_b64_tr_b16 a[108:109], v5 offset:8
  ds_read_b64_tr_b16 a[110:111], v5 offset:1032
  v_add_u32 v5, 0x10000, v25
  ds_read_b64_tr_b16 a[140:141], v5 offset:0
  ds_read_b64_tr_b16 a[142:143], v5 offset:1024
  ds_read_b64_tr_b16 a[172:173], v5 offset:8
  ds_read_b64_tr_b16 a[174:175], v5 offset:1032
  v_add_u32 v5, 0x10000, v27
  ds_read_b64_tr_b16 a[204:205], v5 offset:0
  ds_read_b64_tr_b16 a[206:207], v5 offset:1024
  ds_read_b64_tr_b16 a[236:237], v5 offset:8
  ds_read_b64_tr_b16 a[238:239], v5 offset:1032
  s_waitcnt lgkmcnt(0)
  s_waitcnt vmcnt(24)
  s_barrier
  ds_read_b64_tr_b16 a[16:17], v20 offset:0
  ds_read_b64_tr_b16 a[18:19], v20 offset:1024
  ds_read_b64_tr_b16 a[48:49], v20 offset:8
  ds_read_b64_tr_b16 a[50:51], v20 offset:1032
  ds_read_b64_tr_b16 a[80:81], v22 offset:0
  ds_read_b64_tr_b16 a[82:83], v22 offset:1024
  ds_read_b64_tr_b16 a[112:113], v22 offset:8
  ds_read_b64_tr_b16 a[114:115], v22 offset:1032
  ds_read_b64_tr_b16 a[144:145], v24 offset:0
  ds_read_b64_tr_b16 a[146:147], v24 offset:1024
  ds_read_b64_tr_b16 a[176:177], v24 offset:8
  ds_read_b64_tr_b16 a[178:179], v24 offset:1032
  ds_read_b64_tr_b16 a[208:209], v26 offset:0
  ds_read_b64_tr_b16 a[210:211], v26 offset:1024
  ds_read_b64_tr_b16 a[240:241], v26 offset:8
  ds_read_b64_tr_b16 a[242:243], v26 offset:1032
  s_waitcnt lgkmcnt(0)
  s_waitcnt vmcnt(16)
  s_barrier
  ds_read_b64_tr_b16 a[20:21], v20 offset:32768
  ds_read_b64_tr_b16 a[22:23], v20 offset:33792
  ds_read_b64_tr_b16 a[52:53], v20 offset:32776
  ds_read_b64_tr_b16 a[54:55], v20 offset:33800
  ds_read_b64_tr_b16 a[84:85], v22 offset:32768
  ds_read_b64_tr_b16 a[86:87], v22 offset:33792
  ds_read_b64_tr_b16 a[116:117], v22 offset:32776
  ds_read_b64_tr_b16 a[118:119], v22 offset:33800
  ds_read_b64_tr_b16 a[148:149], v24 offset:32768
  ds_read_b64_tr_b16 a[150:151], v24 offset:33792
  ds_read_b64_tr_b16 a[180:181], v24 offset:32776
  ds_read_b64_tr_b16 a[182:183], v24 offset:33800
  ds_read_b64_tr_b16 a[212:213], v26 offset:32768
  ds_read_b64_tr_b16 a[214:215], v26 offset:33792
  ds_read_b64_tr_b16 a[244:245], v26 offset:32776
  ds_read_b64_tr_b16 a[246:247], v26 offset:33800
  s_waitcnt lgkmcnt(0)
  s_waitcnt vmcnt(8)
  s_barrier
  ds_read_b64_tr_b16 a[24:25], v21 offset:0
  ds_read_b64_tr_b16 a[26:27], v21 offset:1024
  ds_read_b64_tr_b16 a[56:57], v21 offset:8
  ds_read_b64_tr_b16 a[58:59], v21 offset:1032
  ds_read_b64_tr_b16 a[88:89], v23 offset:0
  ds_read_b64_tr_b16 a[90:91], v23 offset:1024
  ds_read_b64_tr_b16 a[120:121], v23 offset:8
  ds_read_b64_tr_b16 a[122:123], v23 offset:1032
  ds_read_b64_tr_b16 a[152:153], v25 offset:0
  ds_read_b64_tr_b16 a[154:155], v25 offset:1024
  ds_read_b64_tr_b16 a[184:185], v25 offset:8
  ds_read_b64_tr_b16 a[186:187], v25 offset:1032
  ds_read_b64_tr_b16 a[216:217], v27 offset:0
  ds_read_b64_tr_b16 a[218:219], v27 offset:1024
  ds_read_b64_tr_b16 a[248:249], v27 offset:8
  ds_read_b64_tr_b16 a[250:251], v27 offset:1032
  s_waitcnt lgkmcnt(0)
  s_waitcnt vmcnt(0)
  s_barrier
  ds_read_b64_tr_b16 a[28:29], v21 offset:32768
  ds_read_b64_tr_b16 a[30:31], v21 offset:33792
  ds_read_b64_tr_b16 a[60:61], v21 offset:32776
  ds_read_b64_tr_b16 a[62:63], v21 offset:33800
  ds_read_b64_tr_b16 a[92:93], v23 offset:32768
  ds_read_b64_tr_b16 a[94:95], v23 offset:33792
  ds_read_b64_tr_b16 a[124:125], v23 offset:32776
  ds_read_b64_tr_b16 a[126:127], v23 offset:33800
  ds_read_b64_tr_b16 a[156:157], v25 offset:32768
  ds_read_b64_tr_b16 a[158:159], v25 offset:33792
  ds_read_b64_tr_b16 a[188:189], v25 offset:32776
  ds_read_b64_tr_b16 a[190:191], v25 offset:33800
  ds_read_b64_tr_b16 a[220:221], v27 offset:32768
  ds_read_b64_tr_b16 a[222:223], v27 offset:33792
  ds_read_b64_tr_b16 a[252:253], v27 offset:32776
  ds_read_b64_tr_b16 a[254:255], v27 offset:33800
  s_waitcnt lgkmcnt(0)
  s_barrier
  v_and_b32 v24, 7, v1
  v_bfe_u32 v25, v1, 3, 2
  s_lshl_b32 s60, s70, 5
  v_lshl_add_u32 v26, v24, 2, s60
  v_mov_b32 v27, 32768
  v_cndmask_b32 v27, 0, v27, s[66:67]
  v_add_u32 v26, v26, v27
  v_add_u32 v8, 81920, v26
  v_lshrrev_b32 v3, 1, v27
  v_lshrrev_b32 v27, 3, v27
  v_lshrrev_b32 v26, 2, v24
  v_lshl_add_u32 v27, v26, 7, v27
  v_and_b32 v26, 3, v24
  v_lshl_add_u32 v27, v26, 2, v27
  s_lshl_b32 s60, s70, 8
  s_add_u32 s60, s60, 147456
  v_add_u32 v27, s60, v27
  v_cmp_eq_u32 vcc, 1, v25
  s_nop 1
  v_cndmask_b32 v8, v8, v27, vcc
  v_mov_b32 v26, 512
  v_cndmask_b32 v9, v26, 0, vcc
  v_cndmask_b32 v11, 0, 1, vcc
  v_mov_b32 v10, 1
  v_and_b32 v26, 15, v1
  v_lshl_add_u32 v26, v26, 2, v3
  v_add_u32 v26, 229376, v26
  v_cmp_le_u32 vcc, 2, v25
  s_nop 1
  v_cndmask_b32 v8, v8, v26, vcc
  v_cndmask_b32 v9, v9, 64, vcc
  s_add_u32 s62, s71, 60
  s_cmp_eq_u32 s71, 0
  s_cselect_b32 s62, 63, s62
  s_lshl_b32 s62, s62, 6
  s_add_u32 s62, s62, 230144
  v_and_b32 v3, 15, v1
  s_mov_b32 s60, 0xffff0000
  s_mov_b32 s61, 0
  v_lshl_add_u32 v3, v3, 2, s62
  v_cndmask_b32 v9, v9, 0, s[60:61]
  v_cndmask_b32 v8, v8, v3, s[60:61]
  v_and_b32 v24, 15, v1
  v_lshrrev_b32 v25, 4, v1
  v_lshrrev_b32 v26, 2, v24
  v_and_b32 v27, 1, v24
  v_lshl_add_u32 v26, v26, 1, v27
  v_lshl_add_u32 v26, v25, 3, v26
  s_lshr_b32 s60, s56, 1
  s_lshl_b32 s61, s60, 11
  v_lshl_add_u32 v18, v26, 4, s61
  v_lshl_add_u32 v19, v1, 3, s61
  v_and_b32 v26, 1, v24
  v_lshlrev_b32 v26, 6, v26
  v_lshrrev_b32 v27, 1, v24
  v_lshl_add_u32 v26, v27, 15, v26
  v_lshl_add_u32 v20, v25, 4, v26
  s_and_b32 s61, s56, 1
  s_lshl_b32 s61, s61, 13
  s_lshl_b32 s60, s60, 12
  s_add_u32 s60, s60, s61
  s_add_u32 s60, s60, 114688
  v_add_u32 v21, s60, v2
  v_add_u32 v23, 114688, v2
  v_mov_b32 v22, 0xff800000
  v_lshl_add_u32 v26, v25, 2, 0
  v_cmp_le_u32 vcc, v26, v24
  s_bitcmp1_b32 s56, 0
  s_cselect_b64 s[4:5], -1, vcc
  s_cselect_b64 s[12:13], vcc, 0
  v_lshl_add_u32 v26, v25, 2, 1
  v_cmp_le_u32 vcc, v26, v24
  s_bitcmp1_b32 s56, 0
  s_cselect_b64 s[6:7], -1, vcc
  s_cselect_b64 s[14:15], vcc, 0
  v_lshl_add_u32 v26, v25, 2, 2
  v_cmp_le_u32 vcc, v26, v24
  s_bitcmp1_b32 s56, 0
  s_cselect_b64 s[8:9], -1, vcc
  s_cselect_b64 s[16:17], vcc, 0
  v_lshl_add_u32 v26, v25, 2, 3
  v_cmp_le_u32 vcc, v26, v24
  s_bitcmp1_b32 s56, 0
  s_cselect_b64 s[10:11], -1, vcc
  s_cselect_b64 s[18:19], vcc, 0
  s_mov_b32 s80, 0x3e0293ee
  s_mov_b32 s20, 0x3e0293ee
  s_mov_b32 s21, 0x3e0293ee
  s_mov_b32 s84, s71
  s_mov_b32 s85, s71
  s_mov_b32 s89, 0
  s_mov_b32 s90, 131072
  s_mov_b32 s75, 0
  v_mov_b32 v129, 0
  v_mov_b32 v131, 0
  v_mov_b32 v133, 0
  v_mov_b32 v135, 0
  v_mov_b32 v137, 0
  v_mov_b32 v139, 0
  v_mov_b32 v141, 0
  v_mov_b32 v143, 0
  v_mov_b32 v25, 12
IW_132:
  buffer_load_dword v24, v25, s[36:39], 0 offen sc1
  s_waitcnt vmcnt(0)
  v_readfirstlane_b32 s60, v24
  s_cmp_ge_u32 s60, 256
  s_cbranch_scc1 IWD_133
  s_add_u32 s64, s64, 1
  s_cmp_lt_u32 s64, 131072
  s_cbranch_scc1 SPOK_134
  s_mov_b32 s63, 1
  s_branch L_ABORT
SPOK_134:
  s_sleep 8
  s_branch IW_132
IWD_133:
  s_mov_b32 s64, 0
  s_barrier
  s_mov_b32 s83, 255
  s_lshl_b32 s60, s71, 2
  v_mov_b32 v4, 32
  buffer_load_dword v3, v4, s[36:39], s60 offen sc1
  s_waitcnt vmcnt(0)
  v_readfirstlane_b32 s60, v3
  s_bcnt1_i32_b32 s60, s60
  s_cmp_eq_u32 s60, 1
  s_cselect_b32 s59, 1, 0
  s_cbranch_scc0 L_AO_SLOW
  s_branch L_AO_FIRSTF
L_AO_IDLEF:
  s_cmp_eq_u32 s89, 0
  s_cbranch_scc1 FS_139
  s_waitcnt vmcnt(0)
  v_mov_b32 v16, 1
  v_mov_b32 v17, 0
  buffer_store_dword v16, v17, s[32:35], s89 offen
  s_mov_b32 s89, 0
FS_139:
  s_waitcnt lgkmcnt(0)
  s_barrier
  v_mov_b32 v13, s90
  ds_read_b32 v12, v13
  s_xor_b32 s90, s90, 4
  s_waitcnt lgkmcnt(0)
  v_readfirstlane_b32 s60, v12
  s_lshr_b32 s86, s60, 6
  s_and_b32 s87, s60, 63
  s_cmp_eq_u32 s86, 0
  s_cselect_b32 s61, 3, 0
  s_add_u32 s84, s84, s61
  s_cmp_eq_u32 s86, 1
  s_cselect_b32 s61, 3, 0
  s_add_u32 s85, s85, s61
  s_cmp_lt_u32 s86, 2
  s_cselect_b32 s88, 1, 0
  s_cselect_b32 s86, s86, 0
  s_cselect_b32 s87, s87, 0
  v_mul_u32_u24 v3, s88, v2
  s_cmp_lg_u32 s88, 0
  s_cbranch_scc1 PKH_138
L_AO_FIRSTF:
  s_min_u32 s60, s84, s85
  s_cmp_ge_u32 s60, 64
  s_cbranch_scc1 L_END
  s_cmp_lg_u32 s56, 0
  s_cbranch_scc1 PKW_137
  s_min_u32 s60, s84, 63
  s_min_u32 s61, s85, 63
  v_mov_b32 v12, s60
  v_mov_b32 v13, s61
  v_cndmask_b32 v12, v12, v13, s[66:67]
  v_mad_u32_u24 v13, v12, v9, v8
  v_mad_u32_u24 v14, v12, v11, v10
  buffer_load_dword v12, v13, s[32:35], 0 offen sc1
PK_135:
  s_waitcnt vmcnt(0)
  v_cmp_ge_u32 vcc, v12, v14
  s_cmp_lt_u32 s85, 52
  s_cselect_b32 s60, 0xffff0000, 0
  s_or_b32 vcc_lo, vcc_lo, s60
  v_readlane_b32 s63, v12, 40
  s_cmp_ge_u32 s63, s84
  s_cselect_b32 s63, 1, 0
  s_add_u32 s61, s85, 64
  s_cmp_lt_u32 s85, 64
  s_cselect_b32 s61, s61, 255
  s_cmp_eq_u32 vcc_lo, -1
  s_cselect_b32 s61, s61, 255
  s_cmp_lt_u32 s84, 64
  s_cselect_b32 s60, s84, 255
  s_cmp_eq_u32 vcc_hi, -1
  s_cselect_b32 s60, s60, 255
  s_cmp_lt_u32 s84, 64
  s_cselect_b32 s63, s63, 0
  s_cmp_lg_u32 s63, 0
  s_cselect_b32 s61, 255, s61
  s_min_u32 s60, s60, s61
  s_cmp_lg_u32 s60, 255
  s_cbranch_scc1 PKG_136
  s_add_u32 s64, s64, 1
  s_cmp_lt_u32 s64, 131072
  s_cbranch_scc1 SPOK_140
  s_mov_b32 s63, 7
  s_branch L_ABORT
SPOK_140:
  s_sleep 2
  buffer_load_dword v12, v13, s[32:35], 0 offen sc1
  s_branch PK_135
PKG_136:
  s_mov_b32 s64, 0
  v_mov_b32 v12, s60
  v_mov_b32 v13, s90
  ds_write_b32 v13, v12
  s_waitcnt lgkmcnt(0)
PKW_137:
  s_barrier
  v_mov_b32 v13, s90
  ds_read_b32 v12, v13
  s_xor_b32 s90, s90, 4
  s_waitcnt lgkmcnt(0)
  v_readfirstlane_b32 s60, v12
  s_lshr_b32 s86, s60, 6
  s_and_b32 s87, s60, 63
  s_cmp_eq_u32 s86, 0
  s_cselect_b32 s61, 3, 0
  s_add_u32 s84, s84, s61
  s_cmp_eq_u32 s86, 1
  s_cselect_b32 s61, 3, 0
  s_add_u32 s85, s85, s61
  s_cmp_lt_u32 s86, 2
  s_cselect_b32 s88, 1, 0
  s_cselect_b32 s86, s86, 0
  s_cselect_b32 s87, s87, 0
  v_mul_u32_u24 v3, s88, v2
PKH_138:
  s_lshl_b32 s60, s87, 5
  s_lshl_b32 s61, s70, 1
  s_add_u32 s60, s60, s61
  s_mov_b32 s61, 0
  s_add_u32 s60, s60, s61
  s_lshl_b32 s76, s60, 13
  s_lshl_b32 s77, s60, 11
  s_add_u32 s61, s76, 37748736
  s_lshl_b32 s60, s56, 12
  s_add_u32 m0, s60, s75
  s_add_u32 s60, s60, s61
  buffer_load_dwordx4 v3, s[32:35], s60 offen offset:0 sc1 lds
  buffer_load_dwordx4 v3, s[32:35], s60 offen offset:1024 sc1 lds
  buffer_load_dwordx4 v3, s[32:35], s60 offen offset:2048 sc1 lds
  buffer_load_dwordx4 v3, s[32:35], s60 offen offset:3072 sc1 lds
  s_add_u32 s61, s76, 71303168
  s_lshl_b32 s60, s56, 12
  s_add_u32 m0, s60, s75
  s_add_u32 m0, m0, 16384
  s_add_u32 s60, s60, s61
  buffer_load_dwordx4 v3, s[32:35], s60 offen offset:0 sc1 lds
  buffer_load_dwordx4 v3, s[32:35], s60 offen offset:1024 sc1 lds
  buffer_load_dwordx4 v3, s[32:35], s60 offen offset:2048 sc1 lds
  buffer_load_dwordx4 v3, s[32:35], s60 offen offset:3072 sc1 lds
  s_add_u32 s61, s77, 20971520
  s_lshl_b32 s60, s56, 10
  s_add_u32 m0, s60, s75
  s_add_u32 m0, m0, 49152
  s_add_u32 s60, s60, s61
  buffer_load_dwordx4 v3, s[32:35], s60 offen offset:0 sc1 lds
  s_add_u32 s61, s76, 104857600
  s_lshl_b32 s60, s56, 12
  s_add_u32 m0, s60, s75
  s_add_u32 m0, m0, 32768
  s_add_u32 s60, s60, s61
  buffer_load_dwordx4 v3, s[32:35], s60 offen offset:0 sc1 lds
  buffer_load_dwordx4 v3, s[32:35], s60 offen offset:1024 sc1 lds
  buffer_load_dwordx4 v3, s[32:35], s60 offen offset:2048 sc1 lds
  buffer_load_dwordx4 v3, s[32:35], s60 offen offset:3072 sc1 lds
  s_add_u32 s61, s77, 29360128
  s_lshl_b32 s60, s56, 10
  s_add_u32 m0, s60, s75
  s_add_u32 m0, m0, 53248
  s_add_u32 s60, s60, s61
  buffer_load_dwordx4 v3, s[32:35], s60 offen offset:0 sc1 lds
  s_cmp_lg_u32 s56, 0
  s_cbranch_scc1 W0_141
  s_min_u32 s60, s84, 63
  s_min_u32 s61, s85, 63
  v_mov_b32 v12, s60
  v_mov_b32 v13, s61
  v_cndmask_b32 v12, v12, v13, s[66:67]
  v_mad_u32_u24 v13, v12, v9, v8
  v_mad_u32_u24 v14, v12, v11, v10
  buffer_load_dword v12, v13, s[32:35], 0 offen sc1
W0_141:
  s_waitcnt vmcnt(0)
  s_cmp_lg_u32 s56, 0
  s_cbranch_scc1 W0_142
  s_waitcnt vmcnt(0)
  v_cmp_ge_u32 vcc, v12, v14
  s_cmp_lt_u32 s85, 52
  s_cselect_b32 s60, 0xffff0000, 0
  s_or_b32 vcc_lo, vcc_lo, s60
  v_readlane_b32 s63, v12, 40
  s_cmp_ge_u32 s63, s84
  s_cselect_b32 s63, 1, 0
  s_add_u32 s61, s85, 64
  s_cmp_lt_u32 s85, 64
  s_cselect_b32 s61, s61, 255
  s_cmp_eq_u32 vcc_lo, -1
  s_cselect_b32 s61, s61, 255
  s_cmp_lt_u32 s84, 64
  s_cselect_b32 s60, s84, 255
  s_cmp_eq_u32 vcc_hi, -1
  s_cselect_b32 s60, s60, 255
  s_cmp_lt_u32 s84, 64
  s_cselect_b32 s63, s63, 0
  s_cmp_lg_u32 s63, 0
  s_cselect_b32 s61, 255, s61
  s_lshl_b32 s62, s88, 1
  s_add_u32 s62, s62, s86
  s_cmp_lt_u32 s84, 64
  s_cselect_b32 s62, s62, 0
  s_cmp_eq_u32 s62, 3
  s_cselect_b32 s61, 255, s61
  s_min_u32 s60, s60, s61
  v_mov_b32 v12, s60
  v_mov_b32 v13, s90
  ds_write_b32 v13, v12
W0_142:
  s_waitcnt lgkmcnt(0)
L_AO_TOPF:
L_AO_BODYF:
  s_mov_b32 s91, s86
  s_mov_b32 s92, s87
  s_lshl_b32 s60, s56, 12
  s_add_u32 s60, s60, s75
  v_add_u32 v4, s60, v2
  s_lshr_b32 s60, s56, 1
  s_lshl_b32 s60, s60, 13
  s_add_u32 s60, s60, s75
  v_add_u32 v5, s60, v2
  v_add_u32 v6, s75, v18
  v_add_u32 v7, s75, v19
  s_sub_u32 s75, 57344, s75
  s_waitcnt vmcnt(6) lgkmcnt(0)
  s_barrier
  v_mov_b32 v13, s90
  ds_read_b32 v12, v13
  s_xor_b32 s90, s90, 4
  ds_read_b128 v[32:35], v4 offset:0
  ds_read_b128 v[48:51], v5 offset:16384
  ds_read_b128 v[64:67], v5 offset:20480
  ds_read_b128 v[80:83], v6 offset:49152
  ds_read_b128 v[36:39], v4 offset:1024
  ds_read_b128 v[52:55], v5 offset:17408
  ds_read_b128 v[68:71], v5 offset:21504
  ds_read_b128 v[84:87], v6 offset:49664
  ds_read_b128 v[40:43], v4 offset:2048
  ds_read_b128 v[56:59], v5 offset:18432
  ds_read_b128 v[72:75], v5 offset:22528
  s_waitcnt lgkmcnt(11)
  v_readfirstlane_b32 s60, v12
  s_lshr_b32 s86, s60, 6
  s_and_b32 s87, s60, 63
  s_cmp_eq_u32 s86, 0
  s_cselect_b32 s61, 3, 0
  s_add_u32 s84, s84, s61
  s_cmp_eq_u32 s86, 1
  s_cselect_b32 s61, 3, 0
  s_add_u32 s85, s85, s61
  s_cmp_lt_u32 s86, 2
  s_cselect_b32 s88, 1, 0
  s_cselect_b32 s86, s86, 0
  s_cselect_b32 s87, s87, 0
  v_mul_u32_u24 v3, s88, v2
  ds_read_b128 v[88:91], v6 offset:50176
  ds_read_b128 v[44:47], v4 offset:3072
  ds_read_b128 v[60:63], v5 offset:19456
  ds_read_b128 v[76:79], v5 offset:23552
  ds_read_b128 v[92:95], v6 offset:50688
  s_mul_i32 s78, s92, 43
  s_bfe_u32 s78, s78, 0x20007
  s_lshl_b32 s60, s71, 2
  s_add_u32 s78, s78, s60
  s_add_u32 s60, s92, 16
  s_cmp_ge_u32 s92, 52
  s_cselect_b32 s60, s78, s60
  s_cmp_eq_u32 s91, 0
  s_cselect_b32 s78, s78, s60
  s_lshl_b32 s78, s78, 19
  s_add_u32 s78, s78, 138412032
  s_lshl_b32 s60, s70, 11
  s_add_u32 s78, s78, s60
  s_lshl_b32 s60, s56, 9
  s_add_u32 s78, s78, s60
  s_lshl_b32 s79, s91, 14
  s_lshl_b32 s60, s92, 8
  s_add_u32 s79, s79, s60
  s_lshl_b32 s60, s70, 4
  s_add_u32 s79, s79, s60
  s_lshl_b32 s60, s56, 2
  s_add_u32 s79, s79, s60
  s_add_u32 s79, s79, 155648
  s_waitcnt lgkmcnt(12)
  v_mfma_f32_16x16x32_bf16 v[144:147], v[48:51], v[32:35], 0
  s_lshl_b32 s60, s87, 5
  s_lshl_b32 s61, s70, 1
  v_mfma_f32_16x16x32_bf16 v[148:151], v[64:67], v[32:35], 0
  s_add_u32 s60, s60, s61
  s_mov_b32 s61, 0
  v_mfma_f32_16x16x32_bf16 v[152:155], v[80:83], v[32:35], 0
  s_add_u32 s60, s60, s61
  s_lshl_b32 s76, s60, 13
  s_waitcnt lgkmcnt(8)
  v_mfma_f32_16x16x32_bf16 v[144:147], v[52:55], v[36:39], v[144:147]
  s_lshl_b32 s77, s60, 11
  s_add_u32 s61, s76, 37748736
  v_mfma_f32_16x16x32_bf16 v[148:151], v[68:71], v[36:39], v[148:151]
  s_lshl_b32 s60, s56, 12
  s_add_u32 m0, s60, s75
  v_mfma_f32_16x16x32_bf16 v[152:155], v[84:87], v[36:39], v[152:155]
  s_add_u32 s60, s60, s61
  buffer_load_dwordx4 v3, s[32:35], s60 offen offset:0 sc1 lds
  s_waitcnt lgkmcnt(4)
  v_mfma_f32_16x16x32_bf16 v[144:147], v[56:59], v[40:43], v[144:147]
  v_mfma_f32_16x16x32_bf16 v[148:151], v[72:75], v[40:43], v[148:151]
  v_mfma_f32_16x16x32_bf16 v[152:155], v[88:91], v[40:43], v[152:155]
  buffer_load_dwordx4 v3, s[32:35], s60 offen offset:1024 sc1 lds
  s_waitcnt lgkmcnt(0)
  v_mfma_f32_16x16x32_bf16 v[144:147], v[60:63], v[44:47], v[144:147]
  v_mfma_f32_16x16x32_bf16 v[148:151], v[76:79], v[44:47], v[148:151]
  v_mfma_f32_16x16x32_bf16 v[152:155], v[92:95], v[44:47], v[152:155]
  buffer_load_dwordx4 v3, s[32:35], s60 offen offset:2048 sc1 lds
  ds_read_b128 v[96:99], v5 offset:32768
  ds_read_b128 v[100:103], v5 offset:33792
  ds_read_b128 v[104:107], v5 offset:34816
  ds_read_b128 v[108:111], v5 offset:35840
  ds_read_b128 v[112:115], v5 offset:36864
  ds_read_b128 v[116:119], v5 offset:37888
  ds_read_b128 v[120:123], v5 offset:38912
  ds_read_b128 v[124:127], v5 offset:39936
  ds_read_b32 v128, v7 offset:53248
  ds_read_b32 v130, v7 offset:53252
  ds_read_b32 v132, v7 offset:53760
  ds_read_b32 v134, v7 offset:53764
  ds_read_b32 v136, v7 offset:54272
  ds_read_b32 v138, v7 offset:54276
  ds_read_b32 v140, v7 offset:54784
  v_mov_b32 v161, 0
  v_cndmask_b32 v144, v22, v144, s[4:5]
  v_cndmask_b32 v145, v22, v145, s[6:7]
  v_cndmask_b32 v146, v22, v146, s[8:9]
  v_cndmask_b32 v147, v22, v147, s[10:11]
  v_cndmask_b32 v148, v22, v148, s[12:13]
  v_cndmask_b32 v149, v22, v149, s[14:15]
  v_cndmask_b32 v150, v22, v150, s[16:17]
  v_cndmask_b32 v151, v22, v151, s[18:19]
  v_max3_f32 v24, v144, v145, v146
  v_max3_f32 v25, v147, v152, v153
  v_max3_f32 v24, v24, v148, v149
  v_max3_f32 v25, v25, v150, v151
  v_max_f32 v24, v24, v25
  ds_read_b32 v142, v7 offset:54788
  v_mov_b32 v25, v24
  buffer_load_dwordx4 v3, s[32:35], s60 offen offset:3072 sc1 lds
  s_add_u32 s61, s76, 71303168
  v_permlane16_swap_b32 v24, v25
  v_max_f32 v24, v24, v25
  v_mov_b32 v25, v24
  s_lshl_b32 s60, s56, 12
  s_add_u32 m0, s60, s75
  v_permlane32_swap_b32 v24, v25
  v_max_f32 v24, v24, v25
  v_mul_f32 v24, s80, v24
  v_pk_fma_f32 v[144:145], v[144:145], s[20:21], v[24:25] op_sel_hi:[1,1,0] neg_lo:[0,0,1] neg_hi:[0,0,1]
  v_pk_fma_f32 v[146:147], v[146:147], s[20:21], v[24:25] op_sel_hi:[1,1,0] neg_lo:[0,0,1] neg_hi:[0,0,1]
  v_pk_fma_f32 v[148:149], v[148:149], s[20:21], v[24:25] op_sel_hi:[1,1,0] neg_lo:[0,0,1] neg_hi:[0,0,1]
  v_pk_fma_f32 v[150:151], v[150:151], s[20:21], v[24:25] op_sel_hi:[1,1,0] neg_lo:[0,0,1] neg_hi:[0,0,1]
  v_pk_fma_f32 v[152:153], v[152:153], s[20:21], v[24:25] op_sel_hi:[1,1,0] neg_lo:[0,0,1] neg_hi:[0,0,1]
  v_exp_f32 v144, v144
  v_exp_f32 v145, v145
  v_exp_f32 v146, v146
  v_exp_f32 v147, v147
  v_exp_f32 v148, v148
  v_exp_f32 v149, v149
  v_exp_f32 v150, v150
  v_exp_f32 v151, v151
  v_exp_f32 v152, v152
  v_exp_f32 v153, v153
  v_pk_add_f32 v[26:27], v[144:145], v[146:147]
  v_pk_add_f32 v[24:25], v[148:149], v[150:151]
  v_pk_add_f32 v[26:27], v[26:27], v[152:153]
  v_pk_add_f32 v[24:25], v[24:25], v[26:27]
  v_add_f32 v24, v24, v25
  v_mov_b32 v25, v24
  s_add_u32 m0, m0, 16384
  s_add_u32 s60, s60, s61
  v_permlane16_swap_b32 v24, v25
  v_add_f32 v24, v24, v25
  v_mov_b32 v25, v24
  buffer_load_dwordx4 v3, s[32:35], s60 offen offset:0 sc1 lds
  buffer_load_dwordx4 v3, s[32:35], s60 offen offset:1024 sc1 lds
  v_permlane32_swap_b32 v24, v25
  v_add_f32 v24, v24, v25
  v_rcp_f32 v24, v24
  s_nop 0
  v_pk_mul_f32 v[144:145], v[144:145], v[24:25] op_sel_hi:[1,0]
  v_pk_mul_f32 v[146:147], v[146:147], v[24:25] op_sel_hi:[1,0]
  v_pk_mul_f32 v[148:149], v[148:149], v[24:25] op_sel_hi:[1,0]
  v_pk_mul_f32 v[150:151], v[150:151], v[24:25] op_sel_hi:[1,0]
  v_pk_mul_f32 v[152:153], v[152:153], v[24:25] op_sel_hi:[1,0]
  v_cvt_pk_bf16_f32 v156, v144, v145
  v_cvt_pk_bf16_f32 v157, v146, v147
  v_cvt_pk_bf16_f32 v158, v148, v149
  v_cvt_pk_bf16_f32 v159, v150, v151
  v_cvt_pk_bf16_f32 v160, v152, v153
  s_cmp_eq_u32 s89, 0
  s_cbranch_scc1 FS_143
  s_waitcnt vmcnt(6)
  v_mov_b32 v16, 1
  v_mov_b32 v17, 0
  buffer_store_dword v16, v17, s[32:35], s89 offen
  s_mov_b32 s89, 0
FS_143:
  s_waitcnt lgkmcnt(0)
  v_mfma_f32_16x16x32_bf16 v[32:35], v[96:99], v[156:159], 0
  v_mfma_f32_16x16x32_bf16 v[36:39], v[100:103], v[156:159], 0
  v_mfma_f32_16x16x32_bf16 v[40:43], v[104:107], v[156:159], 0
  v_mfma_f32_16x16x32_bf16 v[44:47], v[108:111], v[156:159], 0
  buffer_load_dwordx4 v3, s[32:35], s60 offen offset:2048 sc1 lds
  v_mfma_f32_16x16x32_bf16 v[48:51], v[112:115], v[156:159], 0
  v_mfma_f32_16x16x32_bf16 v[52:55], v[116:119], v[156:159], 0
  v_mfma_f32_16x16x32_bf16 v[56:59], v[120:123], v[156:159], 0
  v_mfma_f32_16x16x32_bf16 v[60:63], v[124:127], v[156:159], 0
  buffer_load_dwordx4 v3, s[32:35], s60 offen offset:3072 sc1 lds
  v_mfma_f32_16x16x16_bf16 v[32:35], v[128:129], v[160:161], v[32:35]
  s_add_u32 s61, s77, 20971520
  v_mfma_f32_16x16x16_bf16 v[36:39], v[130:131], v[160:161], v[36:39]
  s_lshl_b32 s60, s56, 10
  v_mfma_f32_16x16x16_bf16 v[40:43], v[132:133], v[160:161], v[40:43]
  s_add_u32 m0, s60, s75
  v_mfma_f32_16x16x16_bf16 v[44:47], v[134:135], v[160:161], v[44:47]
  s_add_u32 m0, m0, 49152
  v_mfma_f32_16x16x16_bf16 v[48:51], v[136:137], v[160:161], v[48:51]
  s_add_u32 s60, s60, s61
  v_mfma_f32_16x16x16_bf16 v[52:55], v[138:139], v[160:161], v[52:55]
  buffer_load_dwordx4 v3, s[32:35], s60 offen offset:0 sc1 lds
  v_mfma_f32_16x16x16_bf16 v[56:59], v[140:141], v[160:161], v[56:59]
  s_add_u32 s61, s76, 104857600
  v_mfma_f32_16x16x16_bf16 v[60:63], v[142:143], v[160:161], v[60:63]
  s_lshl_b32 s60, s56, 12
  v_cvt_pk_bf16_f32 v64, v32, v33
  v_cvt_pk_bf16_f32 v65, v34, v35
  v_cvt_pk_bf16_f32 v66, v36, v37
  v_cvt_pk_bf16_f32 v67, v38, v39
  ds_write_b128 v21, v[64:67] offset:0
  v_cvt_pk_bf16_f32 v68, v40, v41
  v_cvt_pk_bf16_f32 v69, v42, v43
  v_cvt_pk_bf16_f32 v70, v44, v45
  v_cvt_pk_bf16_f32 v71, v46, v47
  ds_write_b128 v21, v[68:71] offset:1024
  v_cvt_pk_bf16_f32 v72, v48, v49
  v_cvt_pk_bf16_f32 v73, v50, v51
  v_cvt_pk_bf16_f32 v74, v52, v53
  v_cvt_pk_bf16_f32 v75, v54, v55
  ds_write_b128 v21, v[72:75] offset:2048
  v_cvt_pk_bf16_f32 v76, v56, v57
  v_cvt_pk_bf16_f32 v77, v58, v59
  v_cvt_pk_bf16_f32 v78, v60, v61
  v_cvt_pk_bf16_f32 v79, v62, v63
  ds_write_b128 v21, v[76:79] offset:3072
  s_waitcnt lgkmcnt(0)
  s_barrier
  ds_read_b128 v[160:163], v23 offset:0
  ds_read_b128 v[192:195], v23 offset:8192
  ds_read_b128 v[164:167], v23 offset:1024
  ds_read_b128 v[196:199], v23 offset:9216
  ds_read_b128 v[168:171], v23 offset:2048
  ds_read_b128 v[200:203], v23 offset:10240
  ds_read_b128 v[172:175], v23 offset:3072
  ds_read_b128 v[204:207], v23 offset:11264
  ds_read_b128 v[176:179], v23 offset:4096
  ds_read_b128 v[208:211], v23 offset:12288
  ds_read_b128 v[180:183], v23 offset:5120
  ds_read_b128 v[212:215], v23 offset:13312
  ds_read_b128 v[184:187], v23 offset:6144
  ds_read_b128 v[216:219], v23 offset:14336
  ds_read_b128 v[188:191], v23 offset:7168
  ds_read_b128 v[220:223], v23 offset:15360
  s_add_u32 s62, s78, 262144
  s_waitcnt lgkmcnt(14)
  v_mfma_f32_16x16x32_bf16 v[32:35], a[0:3], v[160:163], 0
  s_add_u32 m0, s60, s75
  v_mfma_f32_16x16x32_bf16 v[36:39], a[32:35], v[160:163], 0
  s_add_u32 m0, m0, 32768
  v_mfma_f32_16x16x32_bf16 v[40:43], a[0:3], v[192:195], 0
  s_add_u32 s60, s60, s61
  v_mfma_f32_16x16x32_bf16 v[44:47], a[32:35], v[192:195], 0
  s_waitcnt lgkmcnt(12)
  v_mfma_f32_16x16x32_bf16 v[32:35], a[4:7], v[164:167], v[32:35]
  v_mfma_f32_16x16x32_bf16 v[36:39], a[36:39], v[164:167], v[36:39]
  buffer_load_dwordx4 v3, s[32:35], s60 offen offset:0 sc1 lds
  v_mfma_f32_16x16x32_bf16 v[40:43], a[4:7], v[196:199], v[40:43]
  v_mfma_f32_16x16x32_bf16 v[44:47], a[36:39], v[196:199], v[44:47]
  s_waitcnt lgkmcnt(10)
  v_mfma_f32_16x16x32_bf16 v[32:35], a[8:11], v[168:171], v[32:35]
  v_mfma_f32_16x16x32_bf16 v[36:39], a[40:43], v[168:171], v[36:39]
  v_mfma_f32_16x16x32_bf16 v[40:43], a[8:11], v[200:203], v[40:43]
  v_mfma_f32_16x16x32_bf16 v[44:47], a[40:43], v[200:203], v[44:47]
  s_waitcnt lgkmcnt(8)
  v_mfma_f32_16x16x32_bf16 v[32:35], a[12:15], v[172:175], v[32:35]
  v_mfma_f32_16x16x32_bf16 v[36:39], a[44:47], v[172:175], v[36:39]
  buffer_load_dwordx4 v3, s[32:35], s60 offen offset:1024 sc1 lds
  v_mfma_f32_16x16x32_bf16 v[40:43], a[12:15], v[204:207], v[40:43]
  v_mfma_f32_16x16x32_bf16 v[44:47], a[44:47], v[204:207], v[44:47]
  s_waitcnt lgkmcnt(6)
  v_mfma_f32_16x16x32_bf16 v[32:35], a[16:19], v[176:179], v[32:35]
  v_mfma_f32_16x16x32_bf16 v[36:39], a[48:51], v[176:179], v[36:39]
  v_mfma_f32_16x16x32_bf16 v[40:43], a[16:19], v[208:211], v[40:43]
  v_mfma_f32_16x16x32_bf16 v[44:47], a[48:51], v[208:211], v[44:47]
  s_waitcnt lgkmcnt(4)
  v_mfma_f32_16x16x32_bf16 v[32:35], a[20:23], v[180:183], v[32:35]
  v_mfma_f32_16x16x32_bf16 v[36:39], a[52:55], v[180:183], v[36:39]
  buffer_load_dwordx4 v3, s[32:35], s60 offen offset:2048 sc1 lds
  v_mfma_f32_16x16x32_bf16 v[40:43], a[20:23], v[212:215], v[40:43]
  v_mfma_f32_16x16x32_bf16 v[44:47], a[52:55], v[212:215], v[44:47]
  s_waitcnt lgkmcnt(2)
  v_mfma_f32_16x16x32_bf16 v[32:35], a[24:27], v[184:187], v[32:35]
  v_mfma_f32_16x16x32_bf16 v[36:39], a[56:59], v[184:187], v[36:39]
  v_mfma_f32_16x16x32_bf16 v[40:43], a[24:27], v[216:219], v[40:43]
  v_mfma_f32_16x16x32_bf16 v[44:47], a[56:59], v[216:219], v[44:47]
  s_waitcnt lgkmcnt(0)
  v_mfma_f32_16x16x32_bf16 v[32:35], a[28:31], v[188:191], v[32:35]
  v_mfma_f32_16x16x32_bf16 v[36:39], a[60:63], v[188:191], v[36:39]
  buffer_load_dwordx4 v3, s[32:35], s60 offen offset:3072 sc1 lds
  v_mfma_f32_16x16x32_bf16 v[40:43], a[28:31], v[220:223], v[40:43]
  s_add_u32 s61, s77, 29360128
  v_mfma_f32_16x16x32_bf16 v[44:47], a[60:63], v[220:223], v[44:47]
  s_lshl_b32 s60, s56, 10
  v_mfma_f32_16x16x32_bf16 v[48:51], a[64:67], v[160:163], 0
  s_add_u32 m0, s60, s75
  v_mfma_f32_16x16x32_bf16 v[52:55], a[96:99], v[160:163], 0
  s_add_u32 m0, m0, 53248
  v_mfma_f32_16x16x32_bf16 v[56:59], a[64:67], v[192:195], 0
  v_cvt_pk_bf16_f32 v96, v32, v33
  v_mfma_f32_16x16x32_bf16 v[60:63], a[96:99], v[192:195], 0
  v_cvt_pk_bf16_f32 v97, v34, v35
  v_mfma_f32_16x16x32_bf16 v[48:51], a[68:71], v[164:167], v[48:51]
  v_cvt_pk_bf16_f32 v98, v36, v37
  v_mfma_f32_16x16x32_bf16 v[52:55], a[100:103], v[164:167], v[52:55]
  v_cvt_pk_bf16_f32 v99, v38, v39
  v_mfma_f32_16x16x32_bf16 v[56:59], a[68:71], v[196:199], v[56:59]
  buffer_store_dwordx4 v[96:99], v20, s[32:35], s78 offen offset:0
  v_mfma_f32_16x16x32_bf16 v[60:63], a[100:103], v[196:199], v[60:63]
  v_cvt_pk_bf16_f32 v100, v40, v41
  v_mfma_f32_16x16x32_bf16 v[48:51], a[72:75], v[168:171], v[48:51]
  v_cvt_pk_bf16_f32 v101, v42, v43
  v_mfma_f32_16x16x32_bf16 v[52:55], a[104:107], v[168:171], v[52:55]
  v_cvt_pk_bf16_f32 v102, v44, v45
  v_mfma_f32_16x16x32_bf16 v[56:59], a[72:75], v[200:203], v[56:59]
  v_cvt_pk_bf16_f32 v103, v46, v47
  v_mfma_f32_16x16x32_bf16 v[60:63], a[104:107], v[200:203], v[60:63]
  s_add_u32 s60, s60, s61
  v_mfma_f32_16x16x32_bf16 v[48:51], a[76:79], v[172:175], v[48:51]
  buffer_store_dwordx4 v[100:103], v20, s[32:35], s62 offen offset:0
  v_mfma_f32_16x16x32_bf16 v[52:55], a[108:111], v[172:175], v[52:55]
  v_mfma_f32_16x16x32_bf16 v[56:59], a[76:79], v[204:207], v[56:59]
  v_mfma_f32_16x16x32_bf16 v[60:63], a[108:111], v[204:207], v[60:63]
  v_mfma_f32_16x16x32_bf16 v[48:51], a[80:83], v[176:179], v[48:51]
  v_mfma_f32_16x16x32_bf16 v[52:55], a[112:115], v[176:179], v[52:55]
  v_mfma_f32_16x16x32_bf16 v[56:59], a[80:83], v[208:211], v[56:59]
  v_mfma_f32_16x16x32_bf16 v[60:63], a[112:115], v[208:211], v[60:63]
  buffer_load_dwordx4 v3, s[32:35], s60 offen offset:0 sc1 lds
  v_mfma_f32_16x16x32_bf16 v[48:51], a[84:87], v[180:183], v[48:51]
  s_min_u32 s60, s84, 63
  v_mfma_f32_16x16x32_bf16 v[52:55], a[116:119], v[180:183], v[52:55]
  s_min_u32 s61, s85, 63
  v_mfma_f32_16x16x32_bf16 v[56:59], a[84:87], v[212:215], v[56:59]
  v_mov_b32 v12, s60
  v_mfma_f32_16x16x32_bf16 v[60:63], a[116:119], v[212:215], v[60:63]
  v_mov_b32 v13, s61
  v_mfma_f32_16x16x32_bf16 v[48:51], a[88:91], v[184:187], v[48:51]
  v_cndmask_b32 v12, v12, v13, s[66:67]
  v_mfma_f32_16x16x32_bf16 v[52:55], a[120:123], v[184:187], v[52:55]
  v_mad_u32_u24 v13, v12, v9, v8
  v_mfma_f32_16x16x32_bf16 v[56:59], a[88:91], v[216:219], v[56:59]
  v_mad_u32_u24 v14, v12, v11, v10
  v_mfma_f32_16x16x32_bf16 v[60:63], a[120:123], v[216:219], v[60:63]
  buffer_load_dword v12, v13, s[32:35], 0 offen sc1
  v_mfma_f32_16x16x32_bf16 v[48:51], a[92:95], v[188:191], v[48:51]
  v_mfma_f32_16x16x32_bf16 v[52:55], a[124:127], v[188:191], v[52:55]
  v_mfma_f32_16x16x32_bf16 v[56:59], a[92:95], v[220:223], v[56:59]
  v_mfma_f32_16x16x32_bf16 v[60:63], a[124:127], v[220:223], v[60:63]
  v_mfma_f32_16x16x32_bf16 v[32:35], a[128:131], v[160:163], 0
  v_mfma_f32_16x16x32_bf16 v[36:39], a[160:163], v[160:163], 0
  v_mfma_f32_16x16x32_bf16 v[40:43], a[128:131], v[192:195], 0
  s_nop 1
  v_cvt_pk_bf16_f32 v96, v48, v49
  v_mfma_f32_16x16x32_bf16 v[44:47], a[160:163], v[192:195], 0
  v_cvt_pk_bf16_f32 v97, v50, v51
  v_mfma_f32_16x16x32_bf16 v[32:35], a[132:135], v[164:167], v[32:35]
  v_cvt_pk_bf16_f32 v98, v52, v53
  v_mfma_f32_16x16x32_bf16 v[36:39], a[164:167], v[164:167], v[36:39]
  v_cvt_pk_bf16_f32 v99, v54, v55
  v_mfma_f32_16x16x32_bf16 v[40:43], a[132:135], v[196:199], v[40:43]
  buffer_store_dwordx4 v[96:99], v20, s[32:35], s78 offen offset:128
  v_mfma_f32_16x16x32_bf16 v[44:47], a[164:167], v[196:199], v[44:47]
  v_cvt_pk_bf16_f32 v100, v56, v57
  v_mfma_f32_16x16x32_bf16 v[32:35], a[136:139], v[168:171], v[32:35]
  v_cvt_pk_bf16_f32 v101, v58, v59
  v_mfma_f32_16x16x32_bf16 v[36:39], a[168:171], v[168:171], v[36:39]
  v_cvt_pk_bf16_f32 v102, v60, v61
  v_mfma_f32_16x16x32_bf16 v[40:43], a[136:139], v[200:203], v[40:43]
  v_cvt_pk_bf16_f32 v103, v62, v63
  v_mfma_f32_16x16x32_bf16 v[44:47], a[168:171], v[200:203], v[44:47]
  v_mfma_f32_16x16x32_bf16 v[32:35], a[140:143], v[172:175], v[32:35]
  buffer_store_dwordx4 v[100:103], v20, s[32:35], s62 offen offset:128
  v_mfma_f32_16x16x32_bf16 v[36:39], a[172:175], v[172:175], v[36:39]
  v_mfma_f32_16x16x32_bf16 v[40:43], a[140:143], v[204:207], v[40:43]
  v_mfma_f32_16x16x32_bf16 v[44:47], a[172:175], v[204:207], v[44:47]
  v_mfma_f32_16x16x32_bf16 v[32:35], a[144:147], v[176:179], v[32:35]
  v_mfma_f32_16x16x32_bf16 v[36:39], a[176:179], v[176:179], v[36:39]
  v_mfma_f32_16x16x32_bf16 v[40:43], a[144:147], v[208:211], v[40:43]
  v_mfma_f32_16x16x32_bf16 v[44:47], a[176:179], v[208:211], v[44:47]
  v_mfma_f32_16x16x32_bf16 v[32:35], a[148:151], v[180:183], v[32:35]
  v_mfma_f32_16x16x32_bf16 v[36:39], a[180:183], v[180:183], v[36:39]
  v_mfma_f32_16x16x32_bf16 v[40:43], a[148:151], v[212:215], v[40:43]
  v_mfma_f32_16x16x32_bf16 v[44:47], a[180:183], v[212:215], v[44:47]
  v_mfma_f32_16x16x32_bf16 v[32:35], a[152:155], v[184:187], v[32:35]
  v_mfma_f32_16x16x32_bf16 v[36:39], a[184:187], v[184:187], v[36:39]
  v_mfma_f32_16x16x32_bf16 v[40:43], a[152:155], v[216:219], v[40:43]
  v_mfma_f32_16x16x32_bf16 v[44:47], a[184:187], v[216:219], v[44:47]
  v_mfma_f32_16x16x32_bf16 v[32:35], a[156:159], v[188:191], v[32:35]
  v_mfma_f32_16x16x32_bf16 v[36:39], a[188:191], v[188:191], v[36:39]
  v_mfma_f32_16x16x32_bf16 v[40:43], a[156:159], v[220:223], v[40:43]
  v_mfma_f32_16x16x32_bf16 v[44:47], a[188:191], v[220:223], v[44:47]
  v_mfma_f32_16x16x32_bf16 v[48:51], a[192:195], v[160:163], 0
  v_mfma_f32_16x16x32_bf16 v[52:55], a[224:227], v[160:163], 0
  v_mfma_f32_16x16x32_bf16 v[56:59], a[192:195], v[192:195], 0
  s_nop 1
  v_cvt_pk_bf16_f32 v96, v32, v33
  v_mfma_f32_16x16x32_bf16 v[60:63], a[224:227], v[192:195], 0
  v_cvt_pk_bf16_f32 v97, v34, v35
  v_mfma_f32_16x16x32_bf16 v[48:51], a[196:199], v[164:167], v[48:51]
  v_cvt_pk_bf16_f32 v98, v36, v37
  v_mfma_f32_16x16x32_bf16 v[52:55], a[228:231], v[164:167], v[52:55]
  v_cvt_pk_bf16_f32 v99, v38, v39
  v_mfma_f32_16x16x32_bf16 v[56:59], a[196:199], v[196:199], v[56:59]
  buffer_store_dwordx4 v[96:99], v20, s[32:35], s78 offen offset:256
  v_mfma_f32_16x16x32_bf16 v[60:63], a[228:231], v[196:199], v[60:63]
  v_cvt_pk_bf16_f32 v100, v40, v41
  v_mfma_f32_16x16x32_bf16 v[48:51], a[200:203], v[168:171], v[48:51]
  v_cvt_pk_bf16_f32 v101, v42, v43
  v_mfma_f32_16x16x32_bf16 v[52:55], a[232:235], v[168:171], v[52:55]
  v_cvt_pk_bf16_f32 v102, v44, v45
  v_mfma_f32_16x16x32_bf16 v[56:59], a[200:203], v[200:203], v[56:59]
  v_cvt_pk_bf16_f32 v103, v46, v47
  v_mfma_f32_16x16x32_bf16 v[60:63], a[232:235], v[200:203], v[60:63]
  v_mfma_f32_16x16x32_bf16 v[48:51], a[204:207], v[172:175], v[48:51]
  buffer_store_dwordx4 v[100:103], v20, s[32:35], s62 offen offset:256
  v_mfma_f32_16x16x32_bf16 v[52:55], a[236:239], v[172:175], v[52:55]
  v_mfma_f32_16x16x32_bf16 v[56:59], a[204:207], v[204:207], v[56:59]
  v_mfma_f32_16x16x32_bf16 v[60:63], a[236:239], v[204:207], v[60:63]
  v_mfma_f32_16x16x32_bf16 v[48:51], a[208:211], v[176:179], v[48:51]
  v_mfma_f32_16x16x32_bf16 v[52:55], a[240:243], v[176:179], v[52:55]
  v_mfma_f32_16x16x32_bf16 v[56:59], a[208:211], v[208:211], v[56:59]
  v_mfma_f32_16x16x32_bf16 v[60:63], a[240:243], v[208:211], v[60:63]
  v_mfma_f32_16x16x32_bf16 v[48:51], a[212:215], v[180:183], v[48:51]
  v_mfma_f32_16x16x32_bf16 v[52:55], a[244:247], v[180:183], v[52:55]
  v_mfma_f32_16x16x32_bf16 v[56:59], a[212:215], v[212:215], v[56:59]
  v_mfma_f32_16x16x32_bf16 v[60:63], a[244:247], v[212:215], v[60:63]
  v_mfma_f32_16x16x32_bf16 v[48:51], a[216:219], v[184:187], v[48:51]
  v_mfma_f32_16x16x32_bf16 v[52:55], a[248:251], v[184:187], v[52:55]
  v_mfma_f32_16x16x32_bf16 v[56:59], a[216:219], v[216:219], v[56:59]
  v_mfma_f32_16x16x32_bf16 v[60:63], a[248:251], v[216:219], v[60:63]
  v_mfma_f32_16x16x32_bf16 v[48:51], a[220:223], v[188:191], v[48:51]
  v_mfma_f32_16x16x32_bf16 v[52:55], a[252:255], v[188:191], v[52:55]
  v_mfma_f32_16x16x32_bf16 v[56:59], a[220:223], v[220:223], v[56:59]
  v_mfma_f32_16x16x32_bf16 v[60:63], a[252:255], v[220:223], v[60:63]
  s_nop 4
  v_cvt_pk_bf16_f32 v96, v48, v49
  v_cvt_pk_bf16_f32 v97, v50, v51
  v_cvt_pk_bf16_f32 v98, v52, v53
  v_cvt_pk_bf16_f32 v99, v54, v55
  buffer_store_dwordx4 v[96:99], v20, s[32:35], s78 offen offset:384
  v_cvt_pk_bf16_f32 v100, v56, v57
  v_cvt_pk_bf16_f32 v101, v58, v59
  v_cvt_pk_bf16_f32 v102, v60, v61
  v_cvt_pk_bf16_f32 v103, v62, v63
  buffer_store_dwordx4 v[100:103], v20, s[32:35], s62 offen offset:384
  s_mov_b32 s89, s79
  s_cmp_lg_u32 s56, 0
  s_cbranch_scc1 W0_144
  s_waitcnt vmcnt(6)
  v_cmp_ge_u32 vcc, v12, v14
  s_cmp_lt_u32 s85, 52
  s_cselect_b32 s60, 0xffff0000, 0
  s_or_b32 vcc_lo, vcc_lo, s60
  v_readlane_b32 s63, v12, 40
  s_cmp_ge_u32 s63, s84
  s_cselect_b32 s63, 1, 0
  s_add_u32 s61, s85, 64
  s_cmp_lt_u32 s85, 64
  s_cselect_b32 s61, s61, 255
  s_cmp_eq_u32 vcc_lo, -1
  s_cselect_b32 s61, s61, 255
  s_cmp_lt_u32 s84, 64
  s_cselect_b32 s60, s84, 255
  s_cmp_eq_u32 vcc_hi, -1
  s_cselect_b32 s60, s60, 255
  s_cmp_lt_u32 s84, 64
  s_cselect_b32 s63, s63, 0
  s_cmp_lg_u32 s63, 0
  s_cselect_b32 s61, 255, s61
  s_lshl_b32 s62, s88, 1
  s_add_u32 s62, s62, s86
  s_cmp_lt_u32 s84, 64
  s_cselect_b32 s62, s62, 0
  s_cmp_eq_u32 s62, 3
  s_cselect_b32 s61, 255, s61
  s_min_u32 s60, s60, s61
  v_mov_b32 v12, s60
  v_mov_b32 v13, s90
  ds_write_b32 v13, v12
W0_144:
  s_cmp_lg_u32 s88, 0
  s_cbranch_scc1 L_AO_TOPF
  s_branch L_AO_IDLEF
L_AO_SLOW:
  s_branch L_AO_FIRSTS
L_AO_IDLES:
  s_cmp_eq_u32 s89, 0
  s_cbranch_scc1 FS_149
  s_waitcnt vmcnt(0)
  v_mov_b32 v16, 1
  v_mov_b32 v17, 0
  buffer_store_dword v16, v17, s[32:35], s89 offen sc1
  s_mov_b32 s89, 0
FS_149:
  s_waitcnt lgkmcnt(0)
  s_barrier
  v_mov_b32 v13, s90
  ds_read_b32 v12, v13
  s_xor_b32 s90, s90, 4
  s_waitcnt lgkmcnt(0)
  v_readfirstlane_b32 s60, v12
  s_lshr_b32 s86, s60, 6
  s_and_b32 s87, s60, 63
  s_cmp_eq_u32 s86, 0
  s_cselect_b32 s61, 3, 0
  s_add_u32 s84, s84, s61
  s_cmp_eq_u32 s86, 1
  s_cselect_b32 s61, 3, 0
  s_add_u32 s85, s85, s61
  s_cmp_lt_u32 s86, 2
  s_cselect_b32 s88, 1, 0
  s_cselect_b32 s86, s86, 0
  s_cselect_b32 s87, s87, 0
  v_mul_u32_u24 v3, s88, v2
  s_cmp_lg_u32 s88, 0
  s_cbranch_scc1 PKH_148
L_AO_FIRSTS:
  s_min_u32 s60, s84, s85
  s_cmp_ge_u32 s60, 64
  s_cbranch_scc1 L_END
  s_cmp_lg_u32 s56, 0
  s_cbranch_scc1 PKW_147
  s_min_u32 s60, s84, 63
  s_min_u32 s61, s85, 63
  v_mov_b32 v12, s60
  v_mov_b32 v13, s61
  v_cndmask_b32 v12, v12, v13, s[66:67]
  v_mad_u32_u24 v13, v12, v9, v8
  v_mad_u32_u24 v14, v12, v11, v10
  buffer_load_dword v12, v13, s[32:35], 0 offen sc1
PK_145:
  s_waitcnt vmcnt(0)
  v_cmp_ge_u32 vcc, v12, v14
  s_cmp_lt_u32 s85, 52
  s_cselect_b32 s60, 0xffff0000, 0
  s_or_b32 vcc_lo, vcc_lo, s60
  v_readlane_b32 s63, v12, 40
  s_cmp_ge_u32 s63, s84
  s_cselect_b32 s63, 1, 0
  s_add_u32 s61, s85, 64
  s_cmp_lt_u32 s85, 64
  s_cselect_b32 s61, s61, 255
  s_cmp_eq_u32 vcc_lo, -1
  s_cselect_b32 s61, s61, 255
  s_cmp_lt_u32 s84, 64
  s_cselect_b32 s60, s84, 255
  s_cmp_eq_u32 vcc_hi, -1
  s_cselect_b32 s60, s60, 255
  s_cmp_lt_u32 s84, 64
  s_cselect_b32 s63, s63, 0
  s_cmp_lg_u32 s63, 0
  s_cselect_b32 s61, 255, s61
  s_min_u32 s60, s60, s61
  s_cmp_lg_u32 s60, 255
  s_cbranch_scc1 PKG_146
  s_add_u32 s64, s64, 1
  s_cmp_lt_u32 s64, 131072
  s_cbranch_scc1 SPOK_150
  s_mov_b32 s63, 7
  s_branch L_ABORT
SPOK_150:
  s_sleep 2
  buffer_load_dword v12, v13, s[32:35], 0 offen sc1
  s_branch PK_145
PKG_146:
  s_mov_b32 s64, 0
  v_mov_b32 v12, s60
  v_mov_b32 v13, s90
  ds_write_b32 v13, v12
  s_waitcnt lgkmcnt(0)
PKW_147:
  s_barrier
  v_mov_b32 v13, s90
  ds_read_b32 v12, v13
  s_xor_b32 s90, s90, 4
  s_waitcnt lgkmcnt(0)
  v_readfirstlane_b32 s60, v12
  s_lshr_b32 s86, s60, 6
  s_and_b32 s87, s60, 63
  s_cmp_eq_u32 s86, 0
  s_cselect_b32 s61, 3, 0
  s_add_u32 s84, s84, s61
  s_cmp_eq_u32 s86, 1
  s_cselect_b32 s61, 3, 0
  s_add_u32 s85, s85, s61
  s_cmp_lt_u32 s86, 2
  s_cselect_b32 s88, 1, 0
  s_cselect_b32 s86, s86, 0
  s_cselect_b32 s87, s87, 0
  v_mul_u32_u24 v3, s88, v2
PKH_148:
  s_lshl_b32 s60, s87, 5
  s_lshl_b32 s61, s70, 1
  s_add_u32 s60, s60, s61
  s_mov_b32 s61, 0
  s_add_u32 s60, s60, s61
  s_lshl_b32 s76, s60, 13
  s_lshl_b32 s77, s60, 11
  s_add_u32 s61, s76, 37748736
  s_lshl_b32 s60, s56, 12
  s_add_u32 m0, s60, s75
  s_add_u32 s60, s60, s61
  buffer_load_dwordx4 v3, s[32:35], s60 offen offset:0 sc1 lds
  buffer_load_dwordx4 v3, s[32:35], s60 offen offset:1024 sc1 lds
  buffer_load_dwordx4 v3, s[32:35], s60 offen offset:2048 sc1 lds
  buffer_load_dwordx4 v3, s[32:35], s60 offen offset:3072 sc1 lds
  s_add_u32 s61, s76, 71303168
  s_lshl_b32 s60, s56, 12
  s_add_u32 m0, s60, s75
  s_add_u32 m0, m0, 16384
  s_add_u32 s60, s60, s61
  buffer_load_dwordx4 v3, s[32:35], s60 offen offset:0 sc1 lds
  buffer_load_dwordx4 v3, s[32:35], s60 offen offset:1024 sc1 lds
  buffer_load_dwordx4 v3, s[32:35], s60 offen offset:2048 sc1 lds
  buffer_load_dwordx4 v3, s[32:35], s60 offen offset:3072 sc1 lds
  s_add_u32 s61, s77, 20971520
  s_lshl_b32 s60, s56, 10
  s_add_u32 m0, s60, s75
  s_add_u32 m0, m0, 49152
  s_add_u32 s60, s60, s61
  buffer_load_dwordx4 v3, s[32:35], s60 offen offset:0 sc1 lds
  s_add_u32 s61, s76, 104857600
  s_lshl_b32 s60, s56, 12
  s_add_u32 m0, s60, s75
  s_add_u32 m0, m0, 32768
  s_add_u32 s60, s60, s61
  buffer_load_dwordx4 v3, s[32:35], s60 offen offset:0 sc1 lds
  buffer_load_dwordx4 v3, s[32:35], s60 offen offset:1024 sc1 lds
  buffer_load_dwordx4 v3, s[32:35], s60 offen offset:2048 sc1 lds
  buffer_load_dwordx4 v3, s[32:35], s60 offen offset:3072 sc1 lds
  s_add_u32 s61, s77, 29360128
  s_lshl_b32 s60, s56, 10
  s_add_u32 m0, s60, s75
  s_add_u32 m0, m0, 53248
  s_add_u32 s60, s60, s61
  buffer_load_dwordx4 v3, s[32:35], s60 offen offset:0 sc1 lds
  s_cmp_lg_u32 s56, 0
  s_cbranch_scc1 W0_151
  s_min_u32 s60, s84, 63
  s_min_u32 s61, s85, 63
  v_mov_b32 v12, s60
  v_mov_b32 v13, s61
  v_cndmask_b32 v12, v12, v13, s[66:67]
  v_mad_u32_u24 v13, v12, v9, v8
  v_mad_u32_u24 v14, v12, v11, v10
  buffer_load_dword v12, v13, s[32:35], 0 offen sc1
W0_151:
  s_waitcnt vmcnt(0)
  s_cmp_lg_u32 s56, 0
  s_cbranch_scc1 W0_152
  s_waitcnt vmcnt(0)
  v_cmp_ge_u32 vcc, v12, v14
  s_cmp_lt_u32 s85, 52
  s_cselect_b32 s60, 0xffff0000, 0
  s_or_b32 vcc_lo, vcc_lo, s60
  v_readlane_b32 s63, v12, 40
  s_cmp_ge_u32 s63, s84
  s_cselect_b32 s63, 1, 0
  s_add_u32 s61, s85, 64
  s_cmp_lt_u32 s85, 64
  s_cselect_b32 s61, s61, 255
  s_cmp_eq_u32 vcc_lo, -1
  s_cselect_b32 s61, s61, 255
  s_cmp_lt_u32 s84, 64
  s_cselect_b32 s60, s84, 255
  s_cmp_eq_u32 vcc_hi, -1
  s_cselect_b32 s60, s60, 255
  s_cmp_lt_u32 s84, 64
  s_cselect_b32 s63, s63, 0
  s_cmp_lg_u32 s63, 0
  s_cselect_b32 s61, 255, s61
  s_lshl_b32 s62, s88, 1
  s_add_u32 s62, s62, s86
  s_cmp_lt_u32 s84, 64
  s_cselect_b32 s62, s62, 0
  s_cmp_eq_u32 s62, 3
  s_cselect_b32 s61, 255, s61
  s_min_u32 s60, s60, s61
  v_mov_b32 v12, s60
  v_mov_b32 v13, s90
  ds_write_b32 v13, v12
W0_152:
  s_waitcnt lgkmcnt(0)
L_AO_TOPS:
L_AO_BODYS:
  s_mov_b32 s91, s86
  s_mov_b32 s92, s87
  s_lshl_b32 s60, s56, 12
  s_add_u32 s60, s60, s75
  v_add_u32 v4, s60, v2
  s_lshr_b32 s60, s56, 1
  s_lshl_b32 s60, s60, 13
  s_add_u32 s60, s60, s75
  v_add_u32 v5, s60, v2
  v_add_u32 v6, s75, v18
  v_add_u32 v7, s75, v19
  s_sub_u32 s75, 57344, s75
  s_waitcnt vmcnt(6) lgkmcnt(0)
  s_barrier
  v_mov_b32 v13, s90
  ds_read_b32 v12, v13
  s_xor_b32 s90, s90, 4
  ds_read_b128 v[32:35], v4 offset:0
  ds_read_b128 v[48:51], v5 offset:16384
  ds_read_b128 v[64:67], v5 offset:20480
  ds_read_b128 v[80:83], v6 offset:49152
  ds_read_b128 v[36:39], v4 offset:1024
  ds_read_b128 v[52:55], v5 offset:17408
  ds_read_b128 v[68:71], v5 offset:21504
  ds_read_b128 v[84:87], v6 offset:49664
  ds_read_b128 v[40:43], v4 offset:2048
  ds_read_b128 v[56:59], v5 offset:18432
  ds_read_b128 v[72:75], v5 offset:22528
  s_waitcnt lgkmcnt(11)
  v_readfirstlane_b32 s60, v12
  s_lshr_b32 s86, s60, 6
  s_and_b32 s87, s60, 63
  s_cmp_eq_u32 s86, 0
  s_cselect_b32 s61, 3, 0
  s_add_u32 s84, s84, s61
  s_cmp_eq_u32 s86, 1
  s_cselect_b32 s61, 3, 0
  s_add_u32 s85, s85, s61
  s_cmp_lt_u32 s86, 2
  s_cselect_b32 s88, 1, 0
  s_cselect_b32 s86, s86, 0
  s_cselect_b32 s87, s87, 0
  v_mul_u32_u24 v3, s88, v2
  ds_read_b128 v[88:91], v6 offset:50176
  ds_read_b128 v[44:47], v4 offset:3072
  ds_read_b128 v[60:63], v5 offset:19456
  ds_read_b128 v[76:79], v5 offset:23552
  ds_read_b128 v[92:95], v6 offset:50688
  s_mul_i32 s78, s92, 43
  s_bfe_u32 s78, s78, 0x20007
  s_lshl_b32 s60, s71, 2
  s_add_u32 s78, s78, s60
  s_add_u32 s60, s92, 16
  s_cmp_ge_u32 s92, 52
  s_cselect_b32 s60, s78, s60
  s_cmp_eq_u32 s91, 0
  s_cselect_b32 s78, s78, s60
  s_lshl_b32 s78, s78, 19
  s_add_u32 s78, s78, 138412032
  s_lshl_b32 s60, s70, 11
  s_add_u32 s78, s78, s60
  s_lshl_b32 s60, s56, 9
  s_add_u32 s78, s78, s60
  s_lshl_b32 s79, s91, 14
  s_lshl_b32 s60, s92, 8
  s_add_u32 s79, s79, s60
  s_lshl_b32 s60, s70, 4
  s_add_u32 s79, s79, s60
  s_lshl_b32 s60, s56, 2
  s_add_u32 s79, s79, s60
  s_add_u32 s79, s79, 155648
  s_waitcnt lgkmcnt(12)
  v_mfma_f32_16x16x32_bf16 v[144:147], v[48:51], v[32:35], 0
  s_lshl_b32 s60, s87, 5
  s_lshl_b32 s61, s70, 1
  v_mfma_f32_16x16x32_bf16 v[148:151], v[64:67], v[32:35], 0
  s_add_u32 s60, s60, s61
  s_mov_b32 s61, 0
  v_mfma_f32_16x16x32_bf16 v[152:155], v[80:83], v[32:35], 0
  s_add_u32 s60, s60, s61
  s_lshl_b32 s76, s60, 13
  s_waitcnt lgkmcnt(8)
  v_mfma_f32_16x16x32_bf16 v[144:147], v[52:55], v[36:39], v[144:147]
  s_lshl_b32 s77, s60, 11
  s_add_u32 s61, s76, 37748736
  v_mfma_f32_16x16x32_bf16 v[148:151], v[68:71], v[36:39], v[148:151]
  s_lshl_b32 s60, s56, 12
  s_add_u32 m0, s60, s75
  v_mfma_f32_16x16x32_bf16 v[152:155], v[84:87], v[36:39], v[152:155]
  s_add_u32 s60, s60, s61
  buffer_load_dwordx4 v3, s[32:35], s60 offen offset:0 sc1 lds
  s_waitcnt lgkmcnt(4)
  v_mfma_f32_16x16x32_bf16 v[144:147], v[56:59], v[40:43], v[144:147]
  v_mfma_f32_16x16x32_bf16 v[148:151], v[72:75], v[40:43], v[148:151]
  v_mfma_f32_16x16x32_bf16 v[152:155], v[88:91], v[40:43], v[152:155]
  buffer_load_dwordx4 v3, s[32:35], s60 offen offset:1024 sc1 lds
  s_waitcnt lgkmcnt(0)
  v_mfma_f32_16x16x32_bf16 v[144:147], v[60:63], v[44:47], v[144:147]
  v_mfma_f32_16x16x32_bf16 v[148:151], v[76:79], v[44:47], v[148:151]
  v_mfma_f32_16x16x32_bf16 v[152:155], v[92:95], v[44:47], v[152:155]
  buffer_load_dwordx4 v3, s[32:35], s60 offen offset:2048 sc1 lds
  ds_read_b128 v[96:99], v5 offset:32768
  ds_read_b128 v[100:103], v5 offset:33792
  ds_read_b128 v[104:107], v5 offset:34816
  ds_read_b128 v[108:111], v5 offset:35840
  ds_read_b128 v[112:115], v5 offset:36864
  ds_read_b128 v[116:119], v5 offset:37888
  ds_read_b128 v[120:123], v5 offset:38912
  ds_read_b128 v[124:127], v5 offset:39936
  ds_read_b32 v128, v7 offset:53248
  ds_read_b32 v130, v7 offset:53252
  ds_read_b32 v132, v7 offset:53760
  ds_read_b32 v134, v7 offset:53764
  ds_read_b32 v136, v7 offset:54272
  ds_read_b32 v138, v7 offset:54276
  ds_read_b32 v140, v7 offset:54784
  v_mov_b32 v161, 0
  v_cndmask_b32 v144, v22, v144, s[4:5]
  v_cndmask_b32 v145, v22, v145, s[6:7]
  v_cndmask_b32 v146, v22, v146, s[8:9]
  v_cndmask_b32 v147, v22, v147, s[10:11]
  v_cndmask_b32 v148, v22, v148, s[12:13]
  v_cndmask_b32 v149, v22, v149, s[14:15]
  v_cndmask_b32 v150, v22, v150, s[16:17]
  v_cndmask_b32 v151, v22, v151, s[18:19]
  v_max3_f32 v24, v144, v145, v146
  v_max3_f32 v25, v147, v152, v153
  v_max3_f32 v24, v24, v148, v149
  v_max3_f32 v25, v25, v150, v151
  v_max_f32 v24, v24, v25
  ds_read_b32 v142, v7 offset:54788
  v_mov_b32 v25, v24
  buffer_load_dwordx4 v3, s[32:35], s60 offen offset:3072 sc1 lds
  s_add_u32 s61, s76, 71303168
  v_permlane16_swap_b32 v24, v25
  v_max_f32 v24, v24, v25
  v_mov_b32 v25, v24
  s_lshl_b32 s60, s56, 12
  s_add_u32 m0, s60, s75
  v_permlane32_swap_b32 v24, v25
  v_max_f32 v24, v24, v25
  v_mul_f32 v24, s80, v24
  v_pk_fma_f32 v[144:145], v[144:145], s[20:21], v[24:25] op_sel_hi:[1,1,0] neg_lo:[0,0,1] neg_hi:[0,0,1]
  v_pk_fma_f32 v[146:147], v[146:147], s[20:21], v[24:25] op_sel_hi:[1,1,0] neg_lo:[0,0,1] neg_hi:[0,0,1]
  v_pk_fma_f32 v[148:149], v[148:149], s[20:21], v[24:25] op_sel_hi:[1,1,0] neg_lo:[0,0,1] neg_hi:[0,0,1]
  v_pk_fma_f32 v[150:151], v[150:151], s[20:21], v[24:25] op_sel_hi:[1,1,0] neg_lo:[0,0,1] neg_hi:[0,0,1]
  v_pk_fma_f32 v[152:153], v[152:153], s[20:21], v[24:25] op_sel_hi:[1,1,0] neg_lo:[0,0,1] neg_hi:[0,0,1]
  v_exp_f32 v144, v144
  v_exp_f32 v145, v145
  v_exp_f32 v146, v146
  v_exp_f32 v147, v147
  v_exp_f32 v148, v148
  v_exp_f32 v149, v149
  v_exp_f32 v150, v150
  v_exp_f32 v151, v151
  v_exp_f32 v152, v152
  v_exp_f32 v153, v153
  v_pk_add_f32 v[26:27], v[144:145], v[146:147]
  v_pk_add_f32 v[24:25], v[148:149], v[150:151]
  v_pk_add_f32 v[26:27], v[26:27], v[152:153]
  v_pk_add_f32 v[24:25], v[24:25], v[26:27]
  v_add_f32 v24, v24, v25
  v_mov_b32 v25, v24
  s_add_u32 m0, m0, 16384
  s_add_u32 s60, s60, s61
  v_permlane16_swap_b32 v24, v25
  v_add_f32 v24, v24, v25
  v_mov_b32 v25, v24
  buffer_load_dwordx4 v3, s[32:35], s60 offen offset:0 sc1 lds
  buffer_load_dwordx4 v3, s[32:35], s60 offen offset:1024 sc1 lds
  v_permlane32_swap_b32 v24, v25
  v_add_f32 v24, v24, v25
  v_rcp_f32 v24, v24
  s_nop 0
  v_pk_mul_f32 v[144:145], v[144:145], v[24:25] op_sel_hi:[1,0]
  v_pk_mul_f32 v[146:147], v[146:147], v[24:25] op_sel_hi:[1,0]
  v_pk_mul_f32 v[148:149], v[148:149], v[24:25] op_sel_hi:[1,0]
  v_pk_mul_f32 v[150:151], v[150:151], v[24:25] op_sel_hi:[1,0]
  v_pk_mul_f32 v[152:153], v[152:153], v[24:25] op_sel_hi:[1,0]
  v_cvt_pk_bf16_f32 v156, v144, v145
  v_cvt_pk_bf16_f32 v157, v146, v147
  v_cvt_pk_bf16_f32 v158, v148, v149
  v_cvt_pk_bf16_f32 v159, v150, v151
  v_cvt_pk_bf16_f32 v160, v152, v153
  s_cmp_eq_u32 s89, 0
  s_cbranch_scc1 FS_153
  s_waitcnt vmcnt(6)
  v_mov_b32 v16, 1
  v_mov_b32 v17, 0
  buffer_store_dword v16, v17, s[32:35], s89 offen sc1
  s_mov_b32 s89, 0
FS_153:
  s_waitcnt lgkmcnt(0)
  v_mfma_f32_16x16x32_bf16 v[32:35], v[96:99], v[156:159], 0
  v_mfma_f32_16x16x32_bf16 v[36:39], v[100:103], v[156:159], 0
  v_mfma_f32_16x16x32_bf16 v[40:43], v[104:107], v[156:159], 0
  v_mfma_f32_16x16x32_bf16 v[44:47], v[108:111], v[156:159], 0
  buffer_load_dwordx4 v3, s[32:35], s60 offen offset:2048 sc1 lds
  v_mfma_f32_16x16x32_bf16 v[48:51], v[112:115], v[156:159], 0
  v_mfma_f32_16x16x32_bf16 v[52:55], v[116:119], v[156:159], 0
  v_mfma_f32_16x16x32_bf16 v[56:59], v[120:123], v[156:159], 0
  v_mfma_f32_16x16x32_bf16 v[60:63], v[124:127], v[156:159], 0
  buffer_load_dwordx4 v3, s[32:35], s60 offen offset:3072 sc1 lds
  v_mfma_f32_16x16x16_bf16 v[32:35], v[128:129], v[160:161], v[32:35]
  s_add_u32 s61, s77, 20971520
  v_mfma_f32_16x16x16_bf16 v[36:39], v[130:131], v[160:161], v[36:39]
  s_lshl_b32 s60, s56, 10
  v_mfma_f32_16x16x16_bf16 v[40:43], v[132:133], v[160:161], v[40:43]
  s_add_u32 m0, s60, s75
  v_mfma_f32_16x16x16_bf16 v[44:47], v[134:135], v[160:161], v[44:47]
  s_add_u32 m0, m0, 49152
  v_mfma_f32_16x16x16_bf16 v[48:51], v[136:137], v[160:161], v[48:51]
  s_add_u32 s60, s60, s61
  v_mfma_f32_16x16x16_bf16 v[52:55], v[138:139], v[160:161], v[52:55]
  buffer_load_dwordx4 v3, s[32:35], s60 offen offset:0 sc1 lds
  v_mfma_f32_16x16x16_bf16 v[56:59], v[140:141], v[160:161], v[56:59]
  s_add_u32 s61, s76, 104857600
  v_mfma_f32_16x16x16_bf16 v[60:63], v[142:143], v[160:161], v[60:63]
  s_lshl_b32 s60, s56, 12
  v_cvt_pk_bf16_f32 v64, v32, v33
  v_cvt_pk_bf16_f32 v65, v34, v35
  v_cvt_pk_bf16_f32 v66, v36, v37
  v_cvt_pk_bf16_f32 v67, v38, v39
  ds_write_b128 v21, v[64:67] offset:0
  v_cvt_pk_bf16_f32 v68, v40, v41
  v_cvt_pk_bf16_f32 v69, v42, v43
  v_cvt_pk_bf16_f32 v70, v44, v45
  v_cvt_pk_bf16_f32 v71, v46, v47
  ds_write_b128 v21, v[68:71] offset:1024
  v_cvt_pk_bf16_f32 v72, v48, v49
  v_cvt_pk_bf16_f32 v73, v50, v51
  v_cvt_pk_bf16_f32 v74, v52, v53
  v_cvt_pk_bf16_f32 v75, v54, v55
  ds_write_b128 v21, v[72:75] offset:2048
  v_cvt_pk_bf16_f32 v76, v56, v57
  v_cvt_pk_bf16_f32 v77, v58, v59
  v_cvt_pk_bf16_f32 v78, v60, v61
  v_cvt_pk_bf16_f32 v79, v62, v63
  ds_write_b128 v21, v[76:79] offset:3072
  s_waitcnt lgkmcnt(0)
  s_barrier
  ds_read_b128 v[160:163], v23 offset:0
  ds_read_b128 v[192:195], v23 offset:8192
  ds_read_b128 v[164:167], v23 offset:1024
  ds_read_b128 v[196:199], v23 offset:9216
  ds_read_b128 v[168:171], v23 offset:2048
  ds_read_b128 v[200:203], v23 offset:10240
  ds_read_b128 v[172:175], v23 offset:3072
  ds_read_b128 v[204:207], v23 offset:11264
  ds_read_b128 v[176:179], v23 offset:4096
  ds_read_b128 v[208:211], v23 offset:12288
  ds_read_b128 v[180:183], v23 offset:5120
  ds_read_b128 v[212:215], v23 offset:13312
  ds_read_b128 v[184:187], v23 offset:6144
  ds_read_b128 v[216:219], v23 offset:14336
  ds_read_b128 v[188:191], v23 offset:7168
  ds_read_b128 v[220:223], v23 offset:15360
  s_add_u32 s62, s78, 262144
  s_waitcnt lgkmcnt(14)
  v_mfma_f32_16x16x32_bf16 v[32:35], a[0:3], v[160:163], 0
  s_add_u32 m0, s60, s75
  v_mfma_f32_16x16x32_bf16 v[36:39], a[32:35], v[160:163], 0
  s_add_u32 m0, m0, 32768
  v_mfma_f32_16x16x32_bf16 v[40:43], a[0:3], v[192:195], 0
  s_add_u32 s60, s60, s61
  v_mfma_f32_16x16x32_bf16 v[44:47], a[32:35], v[192:195], 0
  s_waitcnt lgkmcnt(12)
  v_mfma_f32_16x16x32_bf16 v[32:35], a[4:7], v[164:167], v[32:35]
  v_mfma_f32_16x16x32_bf16 v[36:39], a[36:39], v[164:167], v[36:39]
  buffer_load_dwordx4 v3, s[32:35], s60 offen offset:0 sc1 lds
  v_mfma_f32_16x16x32_bf16 v[40:43], a[4:7], v[196:199], v[40:43]
  v_mfma_f32_16x16x32_bf16 v[44:47], a[36:39], v[196:199], v[44:47]
  s_waitcnt lgkmcnt(10)
  v_mfma_f32_16x16x32_bf16 v[32:35], a[8:11], v[168:171], v[32:35]
  v_mfma_f32_16x16x32_bf16 v[36:39], a[40:43], v[168:171], v[36:39]
  v_mfma_f32_16x16x32_bf16 v[40:43], a[8:11], v[200:203], v[40:43]
  v_mfma_f32_16x16x32_bf16 v[44:47], a[40:43], v[200:203], v[44:47]
  s_waitcnt lgkmcnt(8)
  v_mfma_f32_16x16x32_bf16 v[32:35], a[12:15], v[172:175], v[32:35]
  v_mfma_f32_16x16x32_bf16 v[36:39], a[44:47], v[172:175], v[36:39]
  buffer_load_dwordx4 v3, s[32:35], s60 offen offset:1024 sc1 lds
  v_mfma_f32_16x16x32_bf16 v[40:43], a[12:15], v[204:207], v[40:43]
  v_mfma_f32_16x16x32_bf16 v[44:47], a[44:47], v[204:207], v[44:47]
  s_waitcnt lgkmcnt(6)
  v_mfma_f32_16x16x32_bf16 v[32:35], a[16:19], v[176:179], v[32:35]
  v_mfma_f32_16x16x32_bf16 v[36:39], a[48:51], v[176:179], v[36:39]
  v_mfma_f32_16x16x32_bf16 v[40:43], a[16:19], v[208:211], v[40:43]
  v_mfma_f32_16x16x32_bf16 v[44:47], a[48:51], v[208:211], v[44:47]
  s_waitcnt lgkmcnt(4)
  v_mfma_f32_16x16x32_bf16 v[32:35], a[20:23], v[180:183], v[32:35]
  v_mfma_f32_16x16x32_bf16 v[36:39], a[52:55], v[180:183], v[36:39]
  buffer_load_dwordx4 v3, s[32:35], s60 offen offset:2048 sc1 lds
  v_mfma_f32_16x16x32_bf16 v[40:43], a[20:23], v[212:215], v[40:43]
  v_mfma_f32_16x16x32_bf16 v[44:47], a[52:55], v[212:215], v[44:47]
  s_waitcnt lgkmcnt(2)
  v_mfma_f32_16x16x32_bf16 v[32:35], a[24:27], v[184:187], v[32:35]
  v_mfma_f32_16x16x32_bf16 v[36:39], a[56:59], v[184:187], v[36:39]
  v_mfma_f32_16x16x32_bf16 v[40:43], a[24:27], v[216:219], v[40:43]
  v_mfma_f32_16x16x32_bf16 v[44:47], a[56:59], v[216:219], v[44:47]
  s_waitcnt lgkmcnt(0)
  v_mfma_f32_16x16x32_bf16 v[32:35], a[28:31], v[188:191], v[32:35]
  v_mfma_f32_16x16x32_bf16 v[36:39], a[60:63], v[188:191], v[36:39]
  buffer_load_dwordx4 v3, s[32:35], s60 offen offset:3072 sc1 lds
  v_mfma_f32_16x16x32_bf16 v[40:43], a[28:31], v[220:223], v[40:43]
  s_add_u32 s61, s77, 29360128
  v_mfma_f32_16x16x32_bf16 v[44:47], a[60:63], v[220:223], v[44:47]
  s_lshl_b32 s60, s56, 10
  v_mfma_f32_16x16x32_bf16 v[48:51], a[64:67], v[160:163], 0
  s_add_u32 m0, s60, s75
  v_mfma_f32_16x16x32_bf16 v[52:55], a[96:99], v[160:163], 0
  s_add_u32 m0, m0, 53248
  v_mfma_f32_16x16x32_bf16 v[56:59], a[64:67], v[192:195], 0
  v_cvt_pk_bf16_f32 v96, v32, v33
  v_mfma_f32_16x16x32_bf16 v[60:63], a[96:99], v[192:195], 0
  v_cvt_pk_bf16_f32 v97, v34, v35
  v_mfma_f32_16x16x32_bf16 v[48:51], a[68:71], v[164:167], v[48:51]
  v_cvt_pk_bf16_f32 v98, v36, v37
  v_mfma_f32_16x16x32_bf16 v[52:55], a[100:103], v[164:167], v[52:55]
  v_cvt_pk_bf16_f32 v99, v38, v39
  v_mfma_f32_16x16x32_bf16 v[56:59], a[68:71], v[196:199], v[56:59]
  buffer_store_dwordx4 v[96:99], v20, s[32:35], s78 offen offset:0 sc1
  v_mfma_f32_16x16x32_bf16 v[60:63], a[100:103], v[196:199], v[60:63]
  v_cvt_pk_bf16_f32 v100, v40, v41
  v_mfma_f32_16x16x32_bf16 v[48:51], a[72:75], v[168:171], v[48:51]
  v_cvt_pk_bf16_f32 v101, v42, v43
  v_mfma_f32_16x16x32_bf16 v[52:55], a[104:107], v[168:171], v[52:55]
  v_cvt_pk_bf16_f32 v102, v44, v45
  v_mfma_f32_16x16x32_bf16 v[56:59], a[72:75], v[200:203], v[56:59]
  v_cvt_pk_bf16_f32 v103, v46, v47
  v_mfma_f32_16x16x32_bf16 v[60:63], a[104:107], v[200:203], v[60:63]
  s_add_u32 s60, s60, s61
  v_mfma_f32_16x16x32_bf16 v[48:51], a[76:79], v[172:175], v[48:51]
  buffer_store_dwordx4 v[100:103], v20, s[32:35], s62 offen offset:0 sc1
  v_mfma_f32_16x16x32_bf16 v[52:55], a[108:111], v[172:175], v[52:55]
  v_mfma_f32_16x16x32_bf16 v[56:59], a[76:79], v[204:207], v[56:59]
  v_mfma_f32_16x16x32_bf16 v[60:63], a[108:111], v[204:207], v[60:63]
  v_mfma_f32_16x16x32_bf16 v[48:51], a[80:83], v[176:179], v[48:51]
  v_mfma_f32_16x16x32_bf16 v[52:55], a[112:115], v[176:179], v[52:55]
  v_mfma_f32_16x16x32_bf16 v[56:59], a[80:83], v[208:211], v[56:59]
  v_mfma_f32_16x16x32_bf16 v[60:63], a[112:115], v[208:211], v[60:63]
  buffer_load_dwordx4 v3, s[32:35], s60 offen offset:0 sc1 lds
  v_mfma_f32_16x16x32_bf16 v[48:51], a[84:87], v[180:183], v[48:51]
  s_min_u32 s60, s84, 63
  v_mfma_f32_16x16x32_bf16 v[52:55], a[116:119], v[180:183], v[52:55]
  s_min_u32 s61, s85, 63
  v_mfma_f32_16x16x32_bf16 v[56:59], a[84:87], v[212:215], v[56:59]
  v_mov_b32 v12, s60
  v_mfma_f32_16x16x32_bf16 v[60:63], a[116:119], v[212:215], v[60:63]
  v_mov_b32 v13, s61
  v_mfma_f32_16x16x32_bf16 v[48:51], a[88:91], v[184:187], v[48:51]
  v_cndmask_b32 v12, v12, v13, s[66:67]
  v_mfma_f32_16x16x32_bf16 v[52:55], a[120:123], v[184:187], v[52:55]
  v_mad_u32_u24 v13, v12, v9, v8
  v_mfma_f32_16x16x32_bf16 v[56:59], a[88:91], v[216:219], v[56:59]
  v_mad_u32_u24 v14, v12, v11, v10
  v_mfma_f32_16x16x32_bf16 v[60:63], a[120:123], v[216:219], v[60:63]
  buffer_load_dword v12, v13, s[32:35], 0 offen sc1
  v_mfma_f32_16x16x32_bf16 v[48:51], a[92:95], v[188:191], v[48:51]
  v_mfma_f32_16x16x32_bf16 v[52:55], a[124:127], v[188:191], v[52:55]
  v_mfma_f32_16x16x32_bf16 v[56:59], a[92:95], v[220:223], v[56:59]
  v_mfma_f32_16x16x32_bf16 v[60:63], a[124:127], v[220:223], v[60:63]
  v_mfma_f32_16x16x32_bf16 v[32:35], a[128:131], v[160:163], 0
  v_mfma_f32_16x16x32_bf16 v[36:39], a[160:163], v[160:163], 0
  v_mfma_f32_16x16x32_bf16 v[40:43], a[128:131], v[192:195], 0
  s_nop 1
  v_cvt_pk_bf16_f32 v96, v48, v49
  v_mfma_f32_16x16x32_bf16 v[44:47], a[160:163], v[192:195], 0
  v_cvt_pk_bf16_f32 v97, v50, v51
  v_mfma_f32_16x16x32_bf16 v[32:35], a[132:135], v[164:167], v[32:35]
  v_cvt_pk_bf16_f32 v98, v52, v53
  v_mfma_f32_16x16x32_bf16 v[36:39], a[164:167], v[164:167], v[36:39]
  v_cvt_pk_bf16_f32 v99, v54, v55
  v_mfma_f32_16x16x32_bf16 v[40:43], a[132:135], v[196:199], v[40:43]
  buffer_store_dwordx4 v[96:99], v20, s[32:35], s78 offen offset:128 sc1
  v_mfma_f32_16x16x32_bf16 v[44:47], a[164:167], v[196:199], v[44:47]
  v_cvt_pk_bf16_f32 v100, v56, v57
  v_mfma_f32_16x16x32_bf16 v[32:35], a[136:139], v[168:171], v[32:35]
  v_cvt_pk_bf16_f32 v101, v58, v59
  v_mfma_f32_16x16x32_bf16 v[36:39], a[168:171], v[168:171], v[36:39]
  v_cvt_pk_bf16_f32 v102, v60, v61
  v_mfma_f32_16x16x32_bf16 v[40:43], a[136:139], v[200:203], v[40:43]
  v_cvt_pk_bf16_f32 v103, v62, v63
  v_mfma_f32_16x16x32_bf16 v[44:47], a[168:171], v[200:203], v[44:47]
  v_mfma_f32_16x16x32_bf16 v[32:35], a[140:143], v[172:175], v[32:35]
  buffer_store_dwordx4 v[100:103], v20, s[32:35], s62 offen offset:128 sc1
  v_mfma_f32_16x16x32_bf16 v[36:39], a[172:175], v[172:175], v[36:39]
  v_mfma_f32_16x16x32_bf16 v[40:43], a[140:143], v[204:207], v[40:43]
  v_mfma_f32_16x16x32_bf16 v[44:47], a[172:175], v[204:207], v[44:47]
  v_mfma_f32_16x16x32_bf16 v[32:35], a[144:147], v[176:179], v[32:35]
  v_mfma_f32_16x16x32_bf16 v[36:39], a[176:179], v[176:179], v[36:39]
  v_mfma_f32_16x16x32_bf16 v[40:43], a[144:147], v[208:211], v[40:43]
  v_mfma_f32_16x16x32_bf16 v[44:47], a[176:179], v[208:211], v[44:47]
  v_mfma_f32_16x16x32_bf16 v[32:35], a[148:151], v[180:183], v[32:35]
  v_mfma_f32_16x16x32_bf16 v[36:39], a[180:183], v[180:183], v[36:39]
  v_mfma_f32_16x16x32_bf16 v[40:43], a[148:151], v[212:215], v[40:43]
  v_mfma_f32_16x16x32_bf16 v[44:47], a[180:183], v[212:215], v[44:47]
  v_mfma_f32_16x16x32_bf16 v[32:35], a[152:155], v[184:187], v[32:35]
  v_mfma_f32_16x16x32_bf16 v[36:39], a[184:187], v[184:187], v[36:39]
  v_mfma_f32_16x16x32_bf16 v[40:43], a[152:155], v[216:219], v[40:43]
  v_mfma_f32_16x16x32_bf16 v[44:47], a[184:187], v[216:219], v[44:47]
  v_mfma_f32_16x16x32_bf16 v[32:35], a[156:159], v[188:191], v[32:35]
  v_mfma_f32_16x16x32_bf16 v[36:39], a[188:191], v[188:191], v[36:39]
  v_mfma_f32_16x16x32_bf16 v[40:43], a[156:159], v[220:223], v[40:43]
  v_mfma_f32_16x16x32_bf16 v[44:47], a[188:191], v[220:223], v[44:47]
  v_mfma_f32_16x16x32_bf16 v[48:51], a[192:195], v[160:163], 0
  v_mfma_f32_16x16x32_bf16 v[52:55], a[224:227], v[160:163], 0
  v_mfma_f32_16x16x32_bf16 v[56:59], a[192:195], v[192:195], 0
  s_nop 1
  v_cvt_pk_bf16_f32 v96, v32, v33
  v_mfma_f32_16x16x32_bf16 v[60:63], a[224:227], v[192:195], 0
  v_cvt_pk_bf16_f32 v97, v34, v35
  v_mfma_f32_16x16x32_bf16 v[48:51], a[196:199], v[164:167], v[48:51]
  v_cvt_pk_bf16_f32 v98, v36, v37
  v_mfma_f32_16x16x32_bf16 v[52:55], a[228:231], v[164:167], v[52:55]
  v_cvt_pk_bf16_f32 v99, v38, v39
  v_mfma_f32_16x16x32_bf16 v[56:59], a[196:199], v[196:199], v[56:59]
  buffer_store_dwordx4 v[96:99], v20, s[32:35], s78 offen offset:256 sc1
  v_mfma_f32_16x16x32_bf16 v[60:63], a[228:231], v[196:199], v[60:63]
  v_cvt_pk_bf16_f32 v100, v40, v41
  v_mfma_f32_16x16x32_bf16 v[48:51], a[200:203], v[168:171], v[48:51]
  v_cvt_pk_bf16_f32 v101, v42, v43
  v_mfma_f32_16x16x32_bf16 v[52:55], a[232:235], v[168:171], v[52:55]
  v_cvt_pk_bf16_f32 v102, v44, v45
  v_mfma_f32_16x16x32_bf16 v[56:59], a[200:203], v[200:203], v[56:59]
  v_cvt_pk_bf16_f32 v103, v46, v47
  v_mfma_f32_16x16x32_bf16 v[60:63], a[232:235], v[200:203], v[60:63]
  v_mfma_f32_16x16x32_bf16 v[48:51], a[204:207], v[172:175], v[48:51]
  buffer_store_dwordx4 v[100:103], v20, s[32:35], s62 offen offset:256 sc1
  v_mfma_f32_16x16x32_bf16 v[52:55], a[236:239], v[172:175], v[52:55]
  v_mfma_f32_16x16x32_bf16 v[56:59], a[204:207], v[204:207], v[56:59]
  v_mfma_f32_16x16x32_bf16 v[60:63], a[236:239], v[204:207], v[60:63]
  v_mfma_f32_16x16x32_bf16 v[48:51], a[208:211], v[176:179], v[48:51]
  v_mfma_f32_16x16x32_bf16 v[52:55], a[240:243], v[176:179], v[52:55]
  v_mfma_f32_16x16x32_bf16 v[56:59], a[208:211], v[208:211], v[56:59]
  v_mfma_f32_16x16x32_bf16 v[60:63], a[240:243], v[208:211], v[60:63]
  v_mfma_f32_16x16x32_bf16 v[48:51], a[212:215], v[180:183], v[48:51]
  v_mfma_f32_16x16x32_bf16 v[52:55], a[244:247], v[180:183], v[52:55]
  v_mfma_f32_16x16x32_bf16 v[56:59], a[212:215], v[212:215], v[56:59]
  v_mfma_f32_16x16x32_bf16 v[60:63], a[244:247], v[212:215], v[60:63]
  v_mfma_f32_16x16x32_bf16 v[48:51], a[216:219], v[184:187], v[48:51]
  v_mfma_f32_16x16x32_bf16 v[52:55], a[248:251], v[184:187], v[52:55]
  v_mfma_f32_16x16x32_bf16 v[56:59], a[216:219], v[216:219], v[56:59]
  v_mfma_f32_16x16x32_bf16 v[60:63], a[248:251], v[216:219], v[60:63]
  v_mfma_f32_16x16x32_bf16 v[48:51], a[220:223], v[188:191], v[48:51]
  v_mfma_f32_16x16x32_bf16 v[52:55], a[252:255], v[188:191], v[52:55]
  v_mfma_f32_16x16x32_bf16 v[56:59], a[220:223], v[220:223], v[56:59]
  v_mfma_f32_16x16x32_bf16 v[60:63], a[252:255], v[220:223], v[60:63]
  s_nop 4
  v_cvt_pk_bf16_f32 v96, v48, v49
  v_cvt_pk_bf16_f32 v97, v50, v51
  v_cvt_pk_bf16_f32 v98, v52, v53
  v_cvt_pk_bf16_f32 v99, v54, v55
  buffer_store_dwordx4 v[96:99], v20, s[32:35], s78 offen offset:384 sc1
  v_cvt_pk_bf16_f32 v100, v56, v57
  v_cvt_pk_bf16_f32 v101, v58, v59
  v_cvt_pk_bf16_f32 v102, v60, v61
  v_cvt_pk_bf16_f32 v103, v62, v63
  buffer_store_dwordx4 v[100:103], v20, s[32:35], s62 offen offset:384 sc1
  s_mov_b32 s89, s79
  s_cmp_lg_u32 s56, 0
  s_cbranch_scc1 W0_154
  s_waitcnt vmcnt(6)
  v_cmp_ge_u32 vcc, v12, v14
  s_cmp_lt_u32 s85, 52
  s_cselect_b32 s60, 0xffff0000, 0
  s_or_b32 vcc_lo, vcc_lo, s60
  v_readlane_b32 s63, v12, 40
  s_cmp_ge_u32 s63, s84
  s_cselect_b32 s63, 1, 0
  s_add_u32 s61, s85, 64
  s_cmp_lt_u32 s85, 64
  s_cselect_b32 s61, s61, 255
  s_cmp_eq_u32 vcc_lo, -1
  s_cselect_b32 s61, s61, 255
  s_cmp_lt_u32 s84, 64
  s_cselect_b32 s60, s84, 255
  s_cmp_eq_u32 vcc_hi, -1
  s_cselect_b32 s60, s60, 255
  s_cmp_lt_u32 s84, 64
  s_cselect_b32 s63, s63, 0
  s_cmp_lg_u32 s63, 0
  s_cselect_b32 s61, 255, s61
  s_lshl_b32 s62, s88, 1
  s_add_u32 s62, s62, s86
  s_cmp_lt_u32 s84, 64
  s_cselect_b32 s62, s62, 0
  s_cmp_eq_u32 s62, 3
  s_cselect_b32 s61, 255, s61
  s_min_u32 s60, s60, s61
  v_mov_b32 v12, s60
  v_mov_b32 v13, s90
  ds_write_b32 v13, v12
W0_154:
  s_cmp_lg_u32 s88, 0
  s_cbranch_scc1 L_AO_TOPS
  s_branch L_AO_IDLES
L_FFN:
  s_sub_u32 s70, s57, 176
  s_mul_i32 s71, s70, 37
  s_lshr_b32 s71, s71, 9
  s_mul_i32 s60, s71, 14
  s_sub_u32 s70, s70, s60
  s_add_u32 s72, s71, 3
  s_cmp_lg_u32 s56, 0
  s_cbranch_scc1 GR_155
  s_mov_b64 exec, 1
  s_lshl_b32 s60, 1, s58
  v_mov_b32 v3, s60
  s_lshl_b32 s60, s72, 2
  v_mov_b32 v4, 32
  buffer_atomic_or v3, v4, s[36:39], s60 offen
  s_mov_b64 exec, -1
GR_155:
  s_cmp_lg_u32 s56, 0
  s_cbranch_scc1 IA_156
  s_waitcnt vmcnt(0)
  s_mov_b64 exec, 1
  v_mov_b32 v30, 1
  v_mov_b32 v31, 12
  buffer_atomic_add v30, v31, s[36:39], 0 offen
  s_mov_b64 exec, -1
IA_156:
  s_mov_b32 s40, s20
  s_and_b32 s41, s21, 0xffff
  s_mov_b32 s42, 1835008
  s_mov_b32 s43, 0x20000
  s_mov_b32 s44, s22
  s_and_b32 s45, s23, 0xffff
  s_mov_b32 s46, 1835008
  s_mov_b32 s47, 0x20000
  s_mov_b32 s48, s24
  s_and_b32 s49, s25, 0xffff
  s_mov_b32 s50, 1835008
  s_mov_b32 s51, 0x20000
  s_lshl_b32 s74, s70, 8
  s_mul_i32 s60, s56, 114688
  s_add_u32 s74, s74, s60
  s_lshl_b32 s75, s70, 17
  s_lshl_b32 s60, s56, 8
  s_add_u32 s75, s75, s60
  v_lshrrev_b32 v3, 4, v1
  v_bfe_u32 v4, v1, 2, 2
  v_lshl_add_u32 v3, v3, 3, v4
  v_lshlrev_b32 v3, 8, v3
  v_and_b32 v5, 3, v1
  v_lshl_add_u32 v3, v5, 4, v3
  v_xor_b32 v4, s56, v4
  v_lshl_add_u32 v8, v4, 6, v3
  v_add_u32 v9, 0x10000, v8
  v_lshrrev_b32 v3, 4, v1
  v_bfe_u32 v4, v1, 2, 2
  v_lshl_add_u32 v3, v3, 3, v4
  v_lshlrev_b32 v3, 8, v3
  v_and_b32 v5, 3, v1
  v_lshl_add_u32 v3, v5, 4, v3
  s_lshl_b32 s60, s56, 13
  v_add_u32 v3, s60, v3
  v_xor_b32 v5, 0, v4
  v_lshl_add_u32 v20, v5, 6, v3
  v_add_u32 v21, 0x10000, v20
  v_xor_b32 v5, 1, v4
  v_lshl_add_u32 v22, v5, 6, v3
  v_add_u32 v23, 0x10000, v22
  v_xor_b32 v5, 2, v4
  v_lshl_add_u32 v24, v5, 6, v3
  v_add_u32 v25, 0x10000, v24
  v_xor_b32 v5, 3, v4
  v_lshl_add_u32 v26, v5, 6, v3
  v_add_u32 v27, 0x10000, v26
  s_mov_b32 s73, 3584
  v_lshrrev_b32 v3, 4, v1
  v_mul_lo_u32 v16, v3, s73
  v_lshlrev_b32 v3, 2, v3
  v_and_b32 v4, 15, v1
  v_xor_b32 v3, v3, v4
  v_lshl_add_u32 v16, v3, 4, v16
  s_mov_b32 s73, 1024
  v_lshrrev_b32 v3, 4, v1
  v_mul_lo_u32 v17, v3, s73
  v_lshlrev_b32 v3, 2, v3
  v_and_b32 v4, 15, v1
  v_xor_b32 v3, v3, v4
  v_lshl_add_u32 v17, v3, 4, v17
  s_lshl_b32 s73, s56, 13
  s_add_u32 m0, s73, 65536
  s_add_u32 s73, s74, 0
  buffer_load_dwordx4 v16, s[40:43], s73 offen lds
  s_add_u32 m0, m0, 1024
  s_add_u32 s73, s73, 14336
  buffer_load_dwordx4 v16, s[40:43], s73 offen lds
  s_add_u32 m0, m0, 1024
  s_add_u32 s73, s73, 14336
  buffer_load_dwordx4 v16, s[40:43], s73 offen lds
  s_add_u32 m0, m0, 1024
  s_add_u32 s73, s73, 14336
  buffer_load_dwordx4 v16, s[40:43], s73 offen lds
  s_add_u32 m0, m0, 1024
  s_add_u32 s73, s73, 14336
  buffer_load_dwordx4 v16, s[40:43], s73 offen lds
  s_add_u32 m0, m0, 1024
  s_add_u32 s73, s73, 14336
  buffer_load_dwordx4 v16, s[40:43], s73 offen lds
  s_add_u32 m0, m0, 1024
  s_add_u32 s73, s73, 14336
  buffer_load_dwordx4 v16, s[40:43], s73 offen lds
  s_add_u32 m0, m0, 1024
  s_add_u32 s73, s73, 14336
  buffer_load_dwordx4 v16, s[40:43], s73 offen lds
  s_lshl_b32 s73, s56, 13
  s_add_u32 m0, s73, 98304
  s_add_u32 s73, s74, 458752
  buffer_load_dwordx4 v16, s[40:43], s73 offen lds
  s_add_u32 m0, m0, 1024
  s_add_u32 s73, s73, 14336
  buffer_load_dwordx4 v16, s[40:43], s73 offen lds
  s_add_u32 m0, m0, 1024
  s_add_u32 s73, s73, 14336
  buffer_load_dwordx4 v16, s[40:43], s73 offen lds
  s_add_u32 m0, m0, 1024
  s_add_u32 s73, s73, 14336
  buffer_load_dwordx4 v16, s[40:43], s73 offen lds
  s_add_u32 m0, m0, 1024
  s_add_u32 s73, s73, 14336
  buffer_load_dwordx4 v16, s[40:43], s73 offen lds
  s_add_u32 m0, m0, 1024
  s_add_u32 s73, s73, 14336
  buffer_load_dwordx4 v16, s[40:43], s73 offen lds
  s_add_u32 m0, m0, 1024
  s_add_u32 s73, s73, 14336
  buffer_load_dwordx4 v16, s[40:43], s73 offen lds
  s_add_u32 m0, m0, 1024
  s_add_u32 s73, s73, 14336
  buffer_load_dwordx4 v16, s[40:43], s73 offen lds
  s_lshl_b32 s73, s56, 13
  s_add_u32 m0, s73, 131072
  s_add_u32 s73, s74, 917504
  buffer_load_dwordx4 v16, s[40:43], s73 offen lds
  s_add_u32 m0, m0, 1024
  s_add_u32 s73, s73, 14336
  buffer_load_dwordx4 v16, s[40:43], s73 offen lds
  s_add_u32 m0, m0, 1024
  s_add_u32 s73, s73, 14336
  buffer_load_dwordx4 v16, s[40:43], s73 offen lds
  s_add_u32 m0, m0, 1024
  s_add_u32 s73, s73, 14336
  buffer_load_dwordx4 v16, s[40:43], s73 offen lds
  s_add_u32 m0, m0, 1024
  s_add_u32 s73, s73, 14336
  buffer_load_dwordx4 v16, s[40:43], s73 offen lds
  s_add_u32 m0, m0, 1024
  s_add_u32 s73, s73, 14336
  buffer_load_dwordx4 v16, s[40:43], s73 offen lds
  s_add_u32 m0, m0, 1024
  s_add_u32 s73, s73, 14336
  buffer_load_dwordx4 v16, s[40:43], s73 offen lds
  s_add_u32 m0, m0, 1024
  s_add_u32 s73, s73, 14336
  buffer_load_dwordx4 v16, s[40:43], s73 offen lds
  s_lshl_b32 s73, s56, 13
  s_add_u32 m0, s73, 0
  s_add_u32 s73, s74, 1376256
  buffer_load_dwordx4 v16, s[40:43], s73 offen lds
  s_add_u32 m0, m0, 1024
  s_add_u32 s73, s73, 14336
  buffer_load_dwordx4 v16, s[40:43], s73 offen lds
  s_add_u32 m0, m0, 1024
  s_add_u32 s73, s73, 14336
  buffer_load_dwordx4 v16, s[40:43], s73 offen lds
  s_add_u32 m0, m0, 1024
  s_add_u32 s73, s73, 14336
  buffer_load_dwordx4 v16, s[40:43], s73 offen lds
  s_add_u32 m0, m0, 1024
  s_add_u32 s73, s73, 14336
  buffer_load_dwordx4 v16, s[40:43], s73 offen lds
  s_add_u32 m0, m0, 1024
  s_add_u32 s73, s73, 14336
  buffer_load_dwordx4 v16, s[40:43], s73 offen lds
  s_add_u32 m0, m0, 1024
  s_add_u32 s73, s73, 14336
  buffer_load_dwordx4 v16, s[40:43], s73 offen lds
  s_add_u32 m0, m0, 1024
  s_add_u32 s73, s73, 14336
  buffer_load_dwordx4 v16, s[40:43], s73 offen lds
  s_lshl_b32 s73, s56, 13
  s_add_u32 m0, s73, 32768
  s_add_u32 s73, s74, 0
  buffer_load_dwordx4 v16, s[44:47], s73 offen lds
  s_add_u32 m0, m0, 1024
  s_add_u32 s73, s73, 14336
  buffer_load_dwordx4 v16, s[44:47], s73 offen lds
  s_add_u32 m0, m0, 1024
  s_add_u32 s73, s73, 14336
  buffer_load_dwordx4 v16, s[44:47], s73 offen lds
  s_add_u32 m0, m0, 1024
  s_add_u32 s73, s73, 14336
  buffer_load_dwordx4 v16, s[44:47], s73 offen lds
  s_add_u32 m0, m0, 1024
  s_add_u32 s73, s73, 14336
  buffer_load_dwordx4 v16, s[44:47], s73 offen lds
  s_add_u32 m0, m0, 1024
  s_add_u32 s73, s73, 14336
  buffer_load_dwordx4 v16, s[44:47], s73 offen lds
  s_add_u32 m0, m0, 1024
  s_add_u32 s73, s73, 14336
  buffer_load_dwordx4 v16, s[44:47], s73 offen lds
  s_add_u32 m0, m0, 1024
  s_add_u32 s73, s73, 14336
  buffer_load_dwordx4 v16, s[44:47], s73 offen lds
  s_waitcnt vmcnt(32)
  s_barrier
  ds_read_b64_tr_b16 a[0:1], v9 offset:0
  ds_read_b64_tr_b16 a[2:3], v9 offset:1024
  ds_read_b64_tr_b16 a[64:65], v9 offset:8
  ds_read_b64_tr_b16 a[66:67], v9 offset:1032
  ds_read_b64_tr_b16 a[4:5], v9 offset:8192
  ds_read_b64_tr_b16 a[6:7], v9 offset:9216
  ds_read_b64_tr_b16 a[68:69], v9 offset:8200
  ds_read_b64_tr_b16 a[70:71], v9 offset:9224
  ds_read_b64_tr_b16 a[8:9], v9 offset:16384
  ds_read_b64_tr_b16 a[10:11], v9 offset:17408
  ds_read_b64_tr_b16 a[72:73], v9 offset:16392
  ds_read_b64_tr_b16 a[74:75], v9 offset:17416
  ds_read_b64_tr_b16 a[12:13], v9 offset:24576
  ds_read_b64_tr_b16 a[14:15], v9 offset:25600
  ds_read_b64_tr_b16 a[76:77], v9 offset:24584
  ds_read_b64_tr_b16 a[78:79], v9 offset:25608
  s_waitcnt lgkmcnt(0)
  s_waitcnt vmcnt(24)
  s_barrier
  s_lshl_b32 s73, s56, 13
  s_add_u32 m0, s73, 65536
  s_add_u32 s73, s74, 458752
  buffer_load_dwordx4 v16, s[44:47], s73 offen lds
  s_add_u32 m0, m0, 1024
  s_add_u32 s73, s73, 14336
  buffer_load_dwordx4 v16, s[44:47], s73 offen lds
  s_add_u32 m0, m0, 1024
  s_add_u32 s73, s73, 14336
  buffer_load_dwordx4 v16, s[44:47], s73 offen lds
  s_add_u32 m0, m0, 1024
  s_add_u32 s73, s73, 14336
  buffer_load_dwordx4 v16, s[44:47], s73 offen lds
  s_add_u32 m0, m0, 1024
  s_add_u32 s73, s73, 14336
  buffer_load_dwordx4 v16, s[44:47], s73 offen lds
  s_add_u32 m0, m0, 1024
  s_add_u32 s73, s73, 14336
  buffer_load_dwordx4 v16, s[44:47], s73 offen lds
  s_add_u32 m0, m0, 1024
  s_add_u32 s73, s73, 14336
  buffer_load_dwordx4 v16, s[44:47], s73 offen lds
  s_add_u32 m0, m0, 1024
  s_add_u32 s73, s73, 14336
  buffer_load_dwordx4 v16, s[44:47], s73 offen lds
  ds_read_b64_tr_b16 a[16:17], v9 offset:32768
  ds_read_b64_tr_b16 a[18:19], v9 offset:33792
  ds_read_b64_tr_b16 a[80:81], v9 offset:32776
  ds_read_b64_tr_b16 a[82:83], v9 offset:33800
  ds_read_b64_tr_b16 a[20:21], v9 offset:40960
  ds_read_b64_tr_b16 a[22:23], v9 offset:41984
  ds_read_b64_tr_b16 a[84:85], v9 offset:40968
  ds_read_b64_tr_b16 a[86:87], v9 offset:41992
  ds_read_b64_tr_b16 a[24:25], v9 offset:49152
  ds_read_b64_tr_b16 a[26:27], v9 offset:50176
  ds_read_b64_tr_b16 a[88:89], v9 offset:49160
  ds_read_b64_tr_b16 a[90:91], v9 offset:50184
  ds_read_b64_tr_b16 a[28:29], v9 offset:57344
  ds_read_b64_tr_b16 a[30:31], v9 offset:58368
  ds_read_b64_tr_b16 a[92:93], v9 offset:57352
  ds_read_b64_tr_b16 a[94:95], v9 offset:58376
  s_waitcnt lgkmcnt(0)
  s_waitcnt vmcnt(24)
  s_barrier
  s_lshl_b32 s73, s56, 13
  s_add_u32 m0, s73, 98304
  s_add_u32 s73, s74, 917504
  buffer_load_dwordx4 v16, s[44:47], s73 offen lds
  s_add_u32 m0, m0, 1024
  s_add_u32 s73, s73, 14336
  buffer_load_dwordx4 v16, s[44:47], s73 offen lds
  s_add_u32 m0, m0, 1024
  s_add_u32 s73, s73, 14336
  buffer_load_dwordx4 v16, s[44:47], s73 offen lds
  s_add_u32 m0, m0, 1024
  s_add_u32 s73, s73, 14336
  buffer_load_dwordx4 v16, s[44:47], s73 offen lds
  s_add_u32 m0, m0, 1024
  s_add_u32 s73, s73, 14336
  buffer_load_dwordx4 v16, s[44:47], s73 offen lds
  s_add_u32 m0, m0, 1024
  s_add_u32 s73, s73, 14336
  buffer_load_dwordx4 v16, s[44:47], s73 offen lds
  s_add_u32 m0, m0, 1024
  s_add_u32 s73, s73, 14336
  buffer_load_dwordx4 v16, s[44:47], s73 offen lds
  s_add_u32 m0, m0, 1024
  s_add_u32 s73, s73, 14336
  buffer_load_dwordx4 v16, s[44:47], s73 offen lds
  v_add_u32 v5, 0x10000, v9
  ds_read_b64_tr_b16 a[32:33], v5 offset:0
  ds_read_b64_tr_b16 a[34:35], v5 offset:1024
  ds_read_b64_tr_b16 a[96:97], v5 offset:8
  ds_read_b64_tr_b16 a[98:99], v5 offset:1032
  ds_read_b64_tr_b16 a[36:37], v5 offset:8192
  ds_read_b64_tr_b16 a[38:39], v5 offset:9216
  ds_read_b64_tr_b16 a[100:101], v5 offset:8200
  ds_read_b64_tr_b16 a[102:103], v5 offset:9224
  ds_read_b64_tr_b16 a[40:41], v5 offset:16384
  ds_read_b64_tr_b16 a[42:43], v5 offset:17408
  ds_read_b64_tr_b16 a[104:105], v5 offset:16392
  ds_read_b64_tr_b16 a[106:107], v5 offset:17416
  ds_read_b64_tr_b16 a[44:45], v5 offset:24576
  ds_read_b64_tr_b16 a[46:47], v5 offset:25600
  ds_read_b64_tr_b16 a[108:109], v5 offset:24584
  ds_read_b64_tr_b16 a[110:111], v5 offset:25608
  s_waitcnt lgkmcnt(0)
  s_waitcnt vmcnt(24)
  s_barrier
  s_lshl_b32 s73, s56, 13
  s_add_u32 m0, s73, 131072
  s_add_u32 s73, s74, 1376256
  buffer_load_dwordx4 v16, s[44:47], s73 offen lds
  s_add_u32 m0, m0, 1024
  s_add_u32 s73, s73, 14336
  buffer_load_dwordx4 v16, s[44:47], s73 offen lds
  s_add_u32 m0, m0, 1024
  s_add_u32 s73, s73, 14336
  buffer_load_dwordx4 v16, s[44:47], s73 offen lds
  s_add_u32 m0, m0, 1024
  s_add_u32 s73, s73, 14336
  buffer_load_dwordx4 v16, s[44:47], s73 offen lds
  s_add_u32 m0, m0, 1024
  s_add_u32 s73, s73, 14336
  buffer_load_dwordx4 v16, s[44:47], s73 offen lds
  s_add_u32 m0, m0, 1024
  s_add_u32 s73, s73, 14336
  buffer_load_dwordx4 v16, s[44:47], s73 offen lds
  s_add_u32 m0, m0, 1024
  s_add_u32 s73, s73, 14336
  buffer_load_dwordx4 v16, s[44:47], s73 offen lds
  s_add_u32 m0, m0, 1024
  s_add_u32 s73, s73, 14336
  buffer_load_dwordx4 v16, s[44:47], s73 offen lds
  ds_read_b64_tr_b16 a[48:49], v8 offset:0
  ds_read_b64_tr_b16 a[50:51], v8 offset:1024
  ds_read_b64_tr_b16 a[112:113], v8 offset:8
  ds_read_b64_tr_b16 a[114:115], v8 offset:1032
  ds_read_b64_tr_b16 a[52:53], v8 offset:8192
  ds_read_b64_tr_b16 a[54:55], v8 offset:9216
  ds_read_b64_tr_b16 a[116:117], v8 offset:8200
  ds_read_b64_tr_b16 a[118:119], v8 offset:9224
  ds_read_b64_tr_b16 a[56:57], v8 offset:16384
  ds_read_b64_tr_b16 a[58:59], v8 offset:17408
  ds_read_b64_tr_b16 a[120:121], v8 offset:16392
  ds_read_b64_tr_b16 a[122:123], v8 offset:17416
  ds_read_b64_tr_b16 a[60:61], v8 offset:24576
  ds_read_b64_tr_b16 a[62:63], v8 offset:25600
  ds_read_b64_tr_b16 a[124:125], v8 offset:24584
  ds_read_b64_tr_b16 a[126:127], v8 offset:25608
  s_waitcnt lgkmcnt(0)
  s_waitcnt vmcnt(24)
  s_barrier
  s_lshl_b32 s73, s56, 13
  s_add_u32 m0, s73, 0
  s_add_u32 s73, s75, 0
  buffer_load_dwordx4 v17, s[48:51], s73 offen lds
  s_add_u32 m0, m0, 1024
  s_add_u32 s73, s73, 4096
  buffer_load_dwordx4 v17, s[48:51], s73 offen lds
  s_add_u32 m0, m0, 1024
  s_add_u32 s73, s73, 4096
  buffer_load_dwordx4 v17, s[48:51], s73 offen lds
  s_add_u32 m0, m0, 1024
  s_add_u32 s73, s73, 4096
  buffer_load_dwordx4 v17, s[48:51], s73 offen lds
  s_add_u32 m0, m0, 1024
  s_add_u32 s73, s73, 4096
  buffer_load_dwordx4 v17, s[48:51], s73 offen lds
  s_add_u32 m0, m0, 1024
  s_add_u32 s73, s73, 4096
  buffer_load_dwordx4 v17, s[48:51], s73 offen lds
  s_add_u32 m0, m0, 1024
  s_add_u32 s73, s73, 4096
  buffer_load_dwordx4 v17, s[48:51], s73 offen lds
  s_add_u32 m0, m0, 1024
  s_add_u32 s73, s73, 4096
  buffer_load_dwordx4 v17, s[48:51], s73 offen lds
  ds_read_b64_tr_b16 a[128:129], v8 offset:32768
  ds_read_b64_tr_b16 a[130:131], v8 offset:33792
  ds_read_b64_tr_b16 a[192:193], v8 offset:32776
  ds_read_b64_tr_b16 a[194:195], v8 offset:33800
  ds_read_b64_tr_b16 a[132:133], v8 offset:40960
  ds_read_b64_tr_b16 a[134:135], v8 offset:41984
  ds_read_b64_tr_b16 a[196:197], v8 offset:40968
  ds_read_b64_tr_b16 a[198:199], v8 offset:41992
  ds_read_b64_tr_b16 a[136:137], v8 offset:49152
  ds_read_b64_tr_b16 a[138:139], v8 offset:50176
  ds_read_b64_tr_b16 a[200:201], v8 offset:49160
  ds_read_b64_tr_b16 a[202:203], v8 offset:50184
  ds_read_b64_tr_b16 a[140:141], v8 offset:57344
  ds_read_b64_tr_b16 a[142:143], v8 offset:58368
  ds_read_b64_tr_b16 a[204:205], v8 offset:57352
  ds_read_b64_tr_b16 a[206:207], v8 offset:58376
  s_waitcnt lgkmcnt(0)
  s_waitcnt vmcnt(24)
  s_barrier
  s_lshl_b32 s73, s56, 13
  s_add_u32 m0, s73, 32768
  s_add_u32 s73, s75, 32768
  buffer_load_dwordx4 v17, s[48:51], s73 offen lds
  s_add_u32 m0, m0, 1024
  s_add_u32 s73, s73, 4096
  buffer_load_dwordx4 v17, s[48:51], s73 offen lds
  s_add_u32 m0, m0, 1024
  s_add_u32 s73, s73, 4096
  buffer_load_dwordx4 v17, s[48:51], s73 offen lds
  s_add_u32 m0, m0, 1024
  s_add_u32 s73, s73, 4096
  buffer_load_dwordx4 v17, s[48:51], s73 offen lds
  s_add_u32 m0, m0, 1024
  s_add_u32 s73, s73, 4096
  buffer_load_dwordx4 v17, s[48:51], s73 offen lds
  s_add_u32 m0, m0, 1024
  s_add_u32 s73, s73, 4096
  buffer_load_dwordx4 v17, s[48:51], s73 offen lds
  s_add_u32 m0, m0, 1024
  s_add_u32 s73, s73, 4096
  buffer_load_dwordx4 v17, s[48:51], s73 offen lds
  s_add_u32 m0, m0, 1024
  s_add_u32 s73, s73, 4096
  buffer_load_dwordx4 v17, s[48:51], s73 offen lds
  ds_read_b64_tr_b16 a[144:145], v9 offset:0
  ds_read_b64_tr_b16 a[146:147], v9 offset:1024
  ds_read_b64_tr_b16 a[208:209], v9 offset:8
  ds_read_b64_tr_b16 a[210:211], v9 offset:1032
  ds_read_b64_tr_b16 a[148:149], v9 offset:8192
  ds_read_b64_tr_b16 a[150:151], v9 offset:9216
  ds_read_b64_tr_b16 a[212:213], v9 offset:8200
  ds_read_b64_tr_b16 a[214:215], v9 offset:9224
  ds_read_b64_tr_b16 a[152:153], v9 offset:16384
  ds_read_b64_tr_b16 a[154:155], v9 offset:17408
  ds_read_b64_tr_b16 a[216:217], v9 offset:16392
  ds_read_b64_tr_b16 a[218:219], v9 offset:17416
  ds_read_b64_tr_b16 a[156:157], v9 offset:24576
  ds_read_b64_tr_b16 a[158:159], v9 offset:25600
  ds_read_b64_tr_b16 a[220:221], v9 offset:24584
  ds_read_b64_tr_b16 a[222:223], v9 offset:25608
  s_waitcnt lgkmcnt(0)
  s_waitcnt vmcnt(24)
  s_barrier
  s_lshl_b32 s73, s56, 13
  s_add_u32 m0, s73, 65536
  s_add_u32 s73, s75, 65536
  buffer_load_dwordx4 v17, s[48:51], s73 offen lds
  s_add_u32 m0, m0, 1024
  s_add_u32 s73, s73, 4096
  buffer_load_dwordx4 v17, s[48:51], s73 offen lds
  s_add_u32 m0, m0, 1024
  s_add_u32 s73, s73, 4096
  buffer_load_dwordx4 v17, s[48:51], s73 offen lds
  s_add_u32 m0, m0, 1024
  s_add_u32 s73, s73, 4096
  buffer_load_dwordx4 v17, s[48:51], s73 offen lds
  s_add_u32 m0, m0, 1024
  s_add_u32 s73, s73, 4096
  buffer_load_dwordx4 v17, s[48:51], s73 offen lds
  s_add_u32 m0, m0, 1024
  s_add_u32 s73, s73, 4096
  buffer_load_dwordx4 v17, s[48:51], s73 offen lds
  s_add_u32 m0, m0, 1024
  s_add_u32 s73, s73, 4096
  buffer_load_dwordx4 v17, s[48:51], s73 offen lds
  s_add_u32 m0, m0, 1024
  s_add_u32 s73, s73, 4096
  buffer_load_dwordx4 v17, s[48:51], s73 offen lds
  ds_read_b64_tr_b16 a[160:161], v9 offset:32768
  ds_read_b64_tr_b16 a[162:163], v9 offset:33792
  ds_read_b64_tr_b16 a[224:225], v9 offset:32776
  ds_read_b64_tr_b16 a[226:227], v9 offset:33800
  ds_read_b64_tr_b16 a[164:165], v9 offset:40960
  ds_read_b64_tr_b16 a[166:167], v9 offset:41984
  ds_read_b64_tr_b16 a[228:229], v9 offset:40968
  ds_read_b64_tr_b16 a[230:231], v9 offset:41992
  ds_read_b64_tr_b16 a[168:169], v9 offset:49152
  ds_read_b64_tr_b16 a[170:171], v9 offset:50176
  ds_read_b64_tr_b16 a[232:233], v9 offset:49160
  ds_read_b64_tr_b16 a[234:235], v9 offset:50184
  ds_read_b64_tr_b16 a[172:173], v9 offset:57344
  ds_read_b64_tr_b16 a[174:175], v9 offset:58368
  ds_read_b64_tr_b16 a[236:237], v9 offset:57352
  ds_read_b64_tr_b16 a[238:239], v9 offset:58376
  s_waitcnt lgkmcnt(0)
  s_waitcnt vmcnt(24)
  s_barrier
  s_lshl_b32 s73, s56, 13
  s_add_u32 m0, s73, 98304
  s_add_u32 s73, s75, 98304
  buffer_load_dwordx4 v17, s[48:51], s73 offen lds
  s_add_u32 m0, m0, 1024
  s_add_u32 s73, s73, 4096
  buffer_load_dwordx4 v17, s[48:51], s73 offen lds
  s_add_u32 m0, m0, 1024
  s_add_u32 s73, s73, 4096
  buffer_load_dwordx4 v17, s[48:51], s73 offen lds
  s_add_u32 m0, m0, 1024
  s_add_u32 s73, s73, 4096
  buffer_load_dwordx4 v17, s[48:51], s73 offen lds
  s_add_u32 m0, m0, 1024
  s_add_u32 s73, s73, 4096
  buffer_load_dwordx4 v17, s[48:51], s73 offen lds
  s_add_u32 m0, m0, 1024
  s_add_u32 s73, s73, 4096
  buffer_load_dwordx4 v17, s[48:51], s73 offen lds
  s_add_u32 m0, m0, 1024
  s_add_u32 s73, s73, 4096
  buffer_load_dwordx4 v17, s[48:51], s73 offen lds
  s_add_u32 m0, m0, 1024
  s_add_u32 s73, s73, 4096
  buffer_load_dwordx4 v17, s[48:51], s73 offen lds
  v_add_u32 v5, 0x10000, v9
  ds_read_b64_tr_b16 a[176:177], v5 offset:0
  ds_read_b64_tr_b16 a[178:179], v5 offset:1024
  ds_read_b64_tr_b16 a[240:241], v5 offset:8
  ds_read_b64_tr_b16 a[242:243], v5 offset:1032
  ds_read_b64_tr_b16 a[180:181], v5 offset:8192
  ds_read_b64_tr_b16 a[182:183], v5 offset:9216
  ds_read_b64_tr_b16 a[244:245], v5 offset:8200
  ds_read_b64_tr_b16 a[246:247], v5 offset:9224
  ds_read_b64_tr_b16 a[184:185], v5 offset:16384
  ds_read_b64_tr_b16 a[186:187], v5 offset:17408
  ds_read_b64_tr_b16 a[248:249], v5 offset:16392
  ds_read_b64_tr_b16 a[250:251], v5 offset:17416
  ds_read_b64_tr_b16 a[188:189], v5 offset:24576
  ds_read_b64_tr_b16 a[190:191], v5 offset:25600
  ds_read_b64_tr_b16 a[252:253], v5 offset:24584
  ds_read_b64_tr_b16 a[254:255], v5 offset:25608
  s_waitcnt lgkmcnt(0)
  s_waitcnt vmcnt(24)
  s_barrier
  ds_read_b64_tr_b16 v[128:129], v20 offset:0
  ds_read_b64_tr_b16 v[130:131], v20 offset:1024
  ds_read_b64_tr_b16 v[144:145], v20 offset:8
  ds_read_b64_tr_b16 v[146:147], v20 offset:1032
  ds_read_b64_tr_b16 v[160:161], v22 offset:0
  ds_read_b64_tr_b16 v[162:163], v22 offset:1024
  ds_read_b64_tr_b16 v[176:177], v22 offset:8
  ds_read_b64_tr_b16 v[178:179], v22 offset:1032
  ds_read_b64_tr_b16 v[192:193], v24 offset:0
  ds_read_b64_tr_b16 v[194:195], v24 offset:1024
  ds_read_b64_tr_b16 v[208:209], v24 offset:8
  ds_read_b64_tr_b16 v[210:211], v24 offset:1032
  ds_read_b64_tr_b16 v[224:225], v26 offset:0
  ds_read_b64_tr_b16 v[226:227], v26 offset:1024
  ds_read_b64_tr_b16 v[240:241], v26 offset:8
  ds_read_b64_tr_b16 v[242:243], v26 offset:1032
  s_waitcnt lgkmcnt(0)
  s_waitcnt vmcnt(16)
  s_barrier
  ds_read_b64_tr_b16 v[132:133], v20 offset:32768
  ds_read_b64_tr_b16 v[134:135], v20 offset:33792
  ds_read_b64_tr_b16 v[148:149], v20 offset:32776
  ds_read_b64_tr_b16 v[150:151], v20 offset:33800
  ds_read_b64_tr_b16 v[164:165], v22 offset:32768
  ds_read_b64_tr_b16 v[166:167], v22 offset:33792
  ds_read_b64_tr_b16 v[180:181], v22 offset:32776
  ds_read_b64_tr_b16 v[182:183], v22 offset:33800
  ds_read_b64_tr_b16 v[196:197], v24 offset:32768
  ds_read_b64_tr_b16 v[198:199], v24 offset:33792
  ds_read_b64_tr_b16 v[212:213], v24 offset:32776
  ds_read_b64_tr_b16 v[214:215], v24 offset:33800
  ds_read_b64_tr_b16 v[228:229], v26 offset:32768
  ds_read_b64_tr_b16 v[230:231], v26 offset:33792
  ds_read_b64_tr_b16 v[244:245], v26 offset:32776
  ds_read_b64_tr_b16 v[246:247], v26 offset:33800
  s_waitcnt lgkmcnt(0)
  s_waitcnt vmcnt(8)
  s_barrier
  ds_read_b64_tr_b16 v[136:137], v21 offset:0
  ds_read_b64_tr_b16 v[138:139], v21 offset:1024
  ds_read_b64_tr_b16 v[152:153], v21 offset:8
  ds_read_b64_tr_b16 v[154:155], v21 offset:1032
  ds_read_b64_tr_b16 v[168:169], v23 offset:0
  ds_read_b64_tr_b16 v[170:171], v23 offset:1024
  ds_read_b64_tr_b16 v[184:185], v23 offset:8
  ds_read_b64_tr_b16 v[186:187], v23 offset:1032
  ds_read_b64_tr_b16 v[200:201], v25 offset:0
  ds_read_b64_tr_b16 v[202:203], v25 offset:1024
  ds_read_b64_tr_b16 v[216:217], v25 offset:8
  ds_read_b64_tr_b16 v[218:219], v25 offset:1032
  ds_read_b64_tr_b16 v[232:233], v27 offset:0
  ds_read_b64_tr_b16 v[234:235], v27 offset:1024
  ds_read_b64_tr_b16 v[248:249], v27 offset:8
  ds_read_b64_tr_b16 v[250:251], v27 offset:1032
  s_waitcnt lgkmcnt(0)
  s_waitcnt vmcnt(0)
  s_barrier
  ds_read_b64_tr_b16 v[140:141], v21 offset:32768
  ds_read_b64_tr_b16 v[142:143], v21 offset:33792
  ds_read_b64_tr_b16 v[156:157], v21 offset:32776
  ds_read_b64_tr_b16 v[158:159], v21 offset:33800
  ds_read_b64_tr_b16 v[172:173], v23 offset:32768
  ds_read_b64_tr_b16 v[174:175], v23 offset:33792
  ds_read_b64_tr_b16 v[188:189], v23 offset:32776
  ds_read_b64_tr_b16 v[190:191], v23 offset:33800
  ds_read_b64_tr_b16 v[204:205], v25 offset:32768
  ds_read_b64_tr_b16 v[206:207], v25 offset:33792
  ds_read_b64_tr_b16 v[220:221], v25 offset:32776
  ds_read_b64_tr_b16 v[222:223], v25 offset:33800
  ds_read_b64_tr_b16 v[236:237], v27 offset:32768
  ds_read_b64_tr_b16 v[238:239], v27 offset:33792
  ds_read_b64_tr_b16 v[252:253], v27 offset:32776
  ds_read_b64_tr_b16 v[254:255], v27 offset:33800
  s_waitcnt lgkmcnt(0)
  s_barrier
  v_and_b32 v3, 15, v1
  v_lshrrev_b32 v4, 4, v1
  v_add_u32 v5, 0, v4
  v_xor_b32 v5, v5, v3
  v_lshlrev_b32 v5, 4, v5
  v_lshl_add_u32 v120, v3, 10, v5
  v_add_u32 v5, 4, v4
  v_xor_b32 v5, v5, v3
  v_lshlrev_b32 v5, 4, v5
  v_lshl_add_u32 v121, v3, 10, v5
  v_add_u32 v5, 8, v4
  v_xor_b32 v5, v5, v3
  v_lshlrev_b32 v5, 4, v5
  v_lshl_add_u32 v122, v3, 10, v5
  v_add_u32 v5, 12, v4
  v_xor_b32 v5, v5, v3
  v_lshlrev_b32 v5, 4, v5
  v_lshl_add_u32 v123, v3, 10, v5
  v_and_b32 v3, 15, v1
  v_lshlrev_b32 v3, 2, v3
  v_mov_b32 v4, 230144
  v_mov_b32 v5, 246528
  v_cndmask_b32 v4, v4, v5, s[66:67]
  v_add_u32 v8, v3, v4
  v_bfe_u32 v3, v1, 4, 1
  v_mul_u32_u24 v3, 7424, v3
  v_add_u32 v8, v3, v8
  v_mov_b32 v9, 64
  s_add_u32 s62, s71, 60
  s_cmp_eq_u32 s71, 0
  s_cselect_b32 s62, 63, s62
  s_lshl_b32 s62, s62, 6
  s_add_u32 s62, s62, 238336
  v_and_b32 v3, 15, v1
  s_mov_b32 s60, 0xffff0000
  s_mov_b32 s61, 0
  v_lshl_add_u32 v124, v3, 2, s62
  v_add_u32 v3, 384, v8
  v_cndmask_b32 v8, v8, v3, s[60:61]
  v_mov_b32 v10, 1
  v_mov_b32 v11, 0
  v_and_b32 v3, 15, v1
  v_lshrrev_b32 v4, 4, v1
  v_lshrrev_b32 v5, 1, v3
  v_and_b32 v3, 1, v3
  v_lshlrev_b32 v3, 6, v3
  v_lshl_add_u32 v3, v5, 15, v3
  v_lshl_add_u32 v18, v4, 4, v3
  v_add_u32 v6, 65536, v2
  s_lshl_b32 s60, s56, 10
  v_add_u32 v19, s60, v6
  s_mov_b32 s84, s71
  s_mov_b32 s85, s71
  s_mov_b32 s89, 0
  s_mov_b32 s90, 81920
  s_mov_b32 s76, 0
  v_mov_b32 v13, 12
IW_157:
  buffer_load_dword v12, v13, s[36:39], 0 offen sc1
  s_waitcnt vmcnt(0)
  v_readfirstlane_b32 s60, v12
  s_cmp_ge_u32 s60, 256
  s_cbranch_scc1 IWD_158
  s_add_u32 s64, s64, 1
  s_cmp_lt_u32 s64, 131072
  s_cbranch_scc1 SPOK_159
  s_mov_b32 s63, 1
  s_branch L_ABORT
SPOK_159:
  s_sleep 8
  s_branch IW_157
IWD_158:
  s_mov_b32 s64, 0
  s_barrier
  s_add_u32 s72, s71, 3
  s_lshl_b32 s60, s72, 2
  v_mov_b32 v4, 32
  buffer_load_dword v3, v4, s[36:39], s60 offen sc1
  s_waitcnt vmcnt(0)
  v_readfirstlane_b32 s60, v3
  s_bcnt1_i32_b32 s60, s60
  s_cmp_eq_u32 s60, 1
  s_cselect_b32 s59, 1, 0
  s_cbranch_scc0 L_FFN_SLOW
  s_branch L_FFN_FIRSTF
L_FFN_IDLEF:
  s_cmp_eq_u32 s89, 0
  s_cbranch_scc1 FS_164
  s_waitcnt vmcnt(0)
  v_mov_b32 v16, 1
  v_mov_b32 v17, 0
  buffer_store_dword v16, v17, s[32:35], s89 offen
  s_mov_b32 s89, 0
FS_164:
  s_waitcnt lgkmcnt(0)
  s_barrier
  v_mov_b32 v13, s90
  ds_read_b32 v12, v13
  s_xor_b32 s90, s90, 4
  s_waitcnt lgkmcnt(0)
  v_readfirstlane_b32 s60, v12
  s_lshr_b32 s86, s60, 6
  s_and_b32 s87, s60, 63
  s_cmp_eq_u32 s86, 0
  s_cselect_b32 s61, 3, 0
  s_add_u32 s84, s84, s61
  s_cmp_eq_u32 s86, 1
  s_cselect_b32 s61, 3, 0
  s_add_u32 s85, s85, s61
  s_cmp_lt_u32 s86, 2
  s_cselect_b32 s88, 1, 0
  s_cselect_b32 s86, s86, 0
  s_cselect_b32 s87, s87, 0
  v_mul_u32_u24 v3, s88, v2
  s_cmp_lg_u32 s88, 0
  s_cbranch_scc1 PKH_163
L_FFN_FIRSTF:
  s_min_u32 s60, s84, s85
  s_cmp_ge_u32 s60, 64
  s_cbranch_scc1 L_END
  s_cmp_lg_u32 s56, 0
  s_cbranch_scc1 PKW_162
  s_min_u32 s60, s84, 63
  s_min_u32 s61, s85, 63
  v_mov_b32 v12, s60
  v_mov_b32 v13, s61
  v_cndmask_b32 v12, v12, v13, s[66:67]
  v_mad_u32_u24 v13, v12, v9, v8
  v_mad_u32_u24 v14, v12, v11, v10
  s_cmp_ge_u32 s85, 52
  s_cselect_b32 s60, 0xffff0000, 0
  s_mov_b32 s61, 0
  v_cndmask_b32 v13, v13, v124, s[60:61]
  buffer_load_dword v12, v13, s[32:35], 0 offen sc1
PK_160:
  s_waitcnt vmcnt(0)
  v_cmp_ge_u32 vcc, v12, v14
  s_and_b32 s63, vcc_hi, 0xffff
  s_add_u32 s61, s85, 64
  s_cmp_lt_u32 s85, 64
  s_cselect_b32 s61, s61, 255
  s_cmp_eq_u32 vcc_lo, -1
  s_cselect_b32 s61, s61, 255
  s_cmp_lt_u32 s84, 64
  s_cselect_b32 s60, s84, 255
  s_cmp_eq_u32 vcc_hi, -1
  s_cselect_b32 s60, s60, 255
  s_cmp_lt_u32 s84, 64
  s_cselect_b32 s63, s63, 0
  s_cmp_lg_u32 s63, 0
  s_cselect_b32 s61, 255, s61
  s_min_u32 s60, s60, s61
  s_cmp_lg_u32 s60, 255
  s_cbranch_scc1 PKG_161
  s_add_u32 s64, s64, 1
  s_cmp_lt_u32 s64, 131072
  s_cbranch_scc1 SPOK_165
  s_mov_b32 s63, 8
  s_branch L_ABORT
SPOK_165:
  s_sleep 2
  buffer_load_dword v12, v13, s[32:35], 0 offen sc1
  s_branch PK_160
PKG_161:
  s_mov_b32 s64, 0
  v_mov_b32 v12, s60
  v_mov_b32 v13, s90
  ds_write_b32 v13, v12
  s_waitcnt lgkmcnt(0)
PKW_162:
  s_barrier
  v_mov_b32 v13, s90
  ds_read_b32 v12, v13
  s_xor_b32 s90, s90, 4
  s_waitcnt lgkmcnt(0)
  v_readfirstlane_b32 s60, v12
  s_lshr_b32 s86, s60, 6
  s_and_b32 s87, s60, 63
  s_cmp_eq_u32 s86, 0
  s_cselect_b32 s61, 3, 0
  s_add_u32 s84, s84, s61
  s_cmp_eq_u32 s86, 1
  s_cselect_b32 s61, 3, 0
  s_add_u32 s85, s85, s61
  s_cmp_lt_u32 s86, 2
  s_cselect_b32 s88, 1, 0
  s_cselect_b32 s86, s86, 0
  s_cselect_b32 s87, s87, 0
  v_mul_u32_u24 v3, s88, v2
PKH_163:
  s_mov_b32 s77, 0
  s_lshl_b32 s60, s87, 15
  s_add_u32 s77, s77, s60
  s_add_u32 s77, s77, 6291456
  s_lshl_b32 s60, s56, 13
  s_add_u32 m0, s60, s76
  s_add_u32 s60, s60, s77
  buffer_load_dwordx4 v3, s[32:35], s60 offen offset:0 sc1 lds
  buffer_load_dwordx4 v3, s[32:35], s60 offen offset:1024 sc1 lds
  buffer_load_dwordx4 v3, s[32:35], s60 offen offset:2048 sc1 lds
  buffer_load_dwordx4 v3, s[32:35], s60 offen offset:3072 sc1 lds
  s_add_u32 m0, m0, 4096
  s_add_u32 s60, s60, 4096
  buffer_load_dwordx4 v3, s[32:35], s60 offen offset:0 sc1 lds
  buffer_load_dwordx4 v3, s[32:35], s60 offen offset:1024 sc1 lds
  buffer_load_dwordx4 v3, s[32:35], s60 offen offset:2048 sc1 lds
  buffer_load_dwordx4 v3, s[32:35], s60 offen offset:3072 sc1 lds
  s_cmp_lg_u32 s56, 0
  s_cbranch_scc1 W0_166
  s_min_u32 s60, s84, 63
  s_min_u32 s61, s85, 63
  v_mov_b32 v12, s60
  v_mov_b32 v13, s61
  v_cndmask_b32 v12, v12, v13, s[66:67]
  v_mad_u32_u24 v13, v12, v9, v8
  v_mad_u32_u24 v14, v12, v11, v10
  s_cmp_ge_u32 s85, 52
  s_cselect_b32 s60, 0xffff0000, 0
  s_mov_b32 s61, 0
  v_cndmask_b32 v13, v13, v124, s[60:61]
  buffer_load_dword v12, v13, s[32:35], 0 offen sc1
W0_166:
  s_waitcnt vmcnt(0)
  s_cmp_lg_u32 s56, 0
  s_cbranch_scc1 W0_167
  s_waitcnt vmcnt(0)
  v_cmp_ge_u32 vcc, v12, v14
  s_and_b32 s63, vcc_hi, 0xffff
  s_add_u32 s61, s85, 64
  s_cmp_lt_u32 s85, 64
  s_cselect_b32 s61, s61, 255
  s_cmp_eq_u32 vcc_lo, -1
  s_cselect_b32 s61, s61, 255
  s_cmp_lt_u32 s84, 64
  s_cselect_b32 s60, s84, 255
  s_cmp_eq_u32 vcc_hi, -1
  s_cselect_b32 s60, s60, 255
  s_cmp_lt_u32 s84, 64
  s_cselect_b32 s63, s63, 0
  s_cmp_lg_u32 s63, 0
  s_cselect_b32 s61, 255, s61
  s_lshl_b32 s62, s88, 1
  s_add_u32 s62, s62, s86
  s_cmp_lt_u32 s84, 64
  s_cselect_b32 s62, s62, 0
  s_cmp_eq_u32 s62, 3
  s_cselect_b32 s61, 255, s61
  s_min_u32 s60, s60, s61
  v_mov_b32 v12, s60
  v_mov_b32 v13, s90
  ds_write_b32 v13, v12
W0_167:
  s_waitcnt lgkmcnt(0)
L_FFN_TOPF:
L_FFN_BODYF:
  s_mov_b32 s91, s86
  s_mov_b32 s92, s87
  v_add_u32 v20, s76, v120
  v_add_u32 v21, s76, v121
  v_add_u32 v22, s76, v122
  v_add_u32 v23, s76, v123
  s_xor_b32 s76, s76, 0x8000
  s_waitcnt vmcnt(8) lgkmcnt(0)
  s_barrier
  v_mov_b32 v13, s90
  ds_read_b32 v12, v13
  s_xor_b32 s90, s90, 4
  ds_read_b128 v[24:27], v20 offset:0
  ds_read_b128 v[28:31], v20 offset:16384
  ds_read_b128 v[32:35], v21 offset:0
  ds_read_b128 v[36:39], v21 offset:16384
  s_waitcnt lgkmcnt(4)
  v_readfirstlane_b32 s60, v12
  s_lshr_b32 s86, s60, 6
  s_and_b32 s87, s60, 63
  s_cmp_eq_u32 s86, 0
  s_cselect_b32 s61, 3, 0
  s_add_u32 s84, s84, s61
  s_cmp_eq_u32 s86, 1
  s_cselect_b32 s61, 3, 0
  s_add_u32 s85, s85, s61
  s_cmp_lt_u32 s86, 2
  s_cselect_b32 s88, 1, 0
  s_cselect_b32 s86, s86, 0
  s_cselect_b32 s87, s87, 0
  v_mul_u32_u24 v3, s88, v2
  ds_read_b128 v[40:43], v22 offset:0
  ds_read_b128 v[44:47], v22 offset:16384
  s_waitcnt lgkmcnt(4)
  v_mfma_f32_16x16x32_bf16 v[48:51], a[0:3], v[24:27], 0
  s_mov_b32 s77, 0
  v_mfma_f32_16x16x32_bf16 v[52:55], a[64:67], v[24:27], 0
  s_lshl_b32 s60, s87, 15
  v_mfma_f32_16x16x32_bf16 v[56:59], a[128:131], v[24:27], 0
  s_add_u32 s77, s77, s60
  v_mfma_f32_16x16x32_bf16 v[60:63], a[192:195], v[24:27], 0
  s_add_u32 s77, s77, 6291456
  v_mfma_f32_16x16x32_bf16 v[64:67], a[0:3], v[28:31], 0
  s_lshl_b32 s60, s56, 13
  v_mfma_f32_16x16x32_bf16 v[68:71], a[64:67], v[28:31], 0
  s_add_u32 m0, s60, s76
  v_mfma_f32_16x16x32_bf16 v[72:75], a[128:131], v[28:31], 0
  s_add_u32 s60, s60, s77
  v_mfma_f32_16x16x32_bf16 v[76:79], a[192:195], v[28:31], 0
  buffer_load_dwordx4 v3, s[32:35], s60 offen offset:0 sc1 lds
  ds_read_b128 v[24:27], v23 offset:0
  ds_read_b128 v[28:31], v23 offset:16384
  s_waitcnt lgkmcnt(4)
  v_mfma_f32_16x16x32_bf16 v[48:51], a[4:7], v[32:35], v[48:51]
  v_mfma_f32_16x16x32_bf16 v[52:55], a[68:71], v[32:35], v[52:55]
  v_mfma_f32_16x16x32_bf16 v[56:59], a[132:135], v[32:35], v[56:59]
  v_mfma_f32_16x16x32_bf16 v[60:63], a[196:199], v[32:35], v[60:63]
  v_mfma_f32_16x16x32_bf16 v[64:67], a[4:7], v[36:39], v[64:67]
  v_mfma_f32_16x16x32_bf16 v[68:71], a[68:71], v[36:39], v[68:71]
  v_mfma_f32_16x16x32_bf16 v[72:75], a[132:135], v[36:39], v[72:75]
  v_mfma_f32_16x16x32_bf16 v[76:79], a[196:199], v[36:39], v[76:79]
  ds_read_b128 v[32:35], v20 offset:256
  ds_read_b128 v[36:39], v20 offset:16640
  s_waitcnt lgkmcnt(4)
  v_mfma_f32_16x16x32_bf16 v[48:51], a[8:11], v[40:43], v[48:51]
  v_mfma_f32_16x16x32_bf16 v[52:55], a[72:75], v[40:43], v[52:55]
  buffer_load_dwordx4 v3, s[32:35], s60 offen offset:1024 sc1 lds
  v_mfma_f32_16x16x32_bf16 v[56:59], a[136:139], v[40:43], v[56:59]
  v_mfma_f32_16x16x32_bf16 v[60:63], a[200:203], v[40:43], v[60:63]
  v_mfma_f32_16x16x32_bf16 v[64:67], a[8:11], v[44:47], v[64:67]
  v_mfma_f32_16x16x32_bf16 v[68:71], a[72:75], v[44:47], v[68:71]
  v_mfma_f32_16x16x32_bf16 v[72:75], a[136:139], v[44:47], v[72:75]
  v_mfma_f32_16x16x32_bf16 v[76:79], a[200:203], v[44:47], v[76:79]
  ds_read_b128 v[40:43], v21 offset:256
  ds_read_b128 v[44:47], v21 offset:16640
  s_waitcnt lgkmcnt(4)
  v_mfma_f32_16x16x32_bf16 v[48:51], a[12:15], v[24:27], v[48:51]
  v_mfma_f32_16x16x32_bf16 v[52:55], a[76:79], v[24:27], v[52:55]
  v_mfma_f32_16x16x32_bf16 v[56:59], a[140:143], v[24:27], v[56:59]
  v_mfma_f32_16x16x32_bf16 v[60:63], a[204:207], v[24:27], v[60:63]
  buffer_load_dwordx4 v3, s[32:35], s60 offen offset:2048 sc1 lds
  v_mfma_f32_16x16x32_bf16 v[64:67], a[12:15], v[28:31], v[64:67]
  v_mfma_f32_16x16x32_bf16 v[68:71], a[76:79], v[28:31], v[68:71]
  v_mfma_f32_16x16x32_bf16 v[72:75], a[140:143], v[28:31], v[72:75]
  v_mfma_f32_16x16x32_bf16 v[76:79], a[204:207], v[28:31], v[76:79]
  ds_read_b128 v[24:27], v22 offset:256
  ds_read_b128 v[28:31], v22 offset:16640
  s_waitcnt lgkmcnt(4)
  v_mfma_f32_16x16x32_bf16 v[48:51], a[16:19], v[32:35], v[48:51]
  v_mfma_f32_16x16x32_bf16 v[52:55], a[80:83], v[32:35], v[52:55]
  v_mfma_f32_16x16x32_bf16 v[56:59], a[144:147], v[32:35], v[56:59]
  v_mfma_f32_16x16x32_bf16 v[60:63], a[208:211], v[32:35], v[60:63]
  v_mfma_f32_16x16x32_bf16 v[64:67], a[16:19], v[36:39], v[64:67]
  v_mfma_f32_16x16x32_bf16 v[68:71], a[80:83], v[36:39], v[68:71]
  buffer_load_dwordx4 v3, s[32:35], s60 offen offset:3072 sc1 lds
  v_mfma_f32_16x16x32_bf16 v[72:75], a[144:147], v[36:39], v[72:75]
  s_add_u32 m0, m0, 4096
  v_mfma_f32_16x16x32_bf16 v[76:79], a[208:211], v[36:39], v[76:79]
  s_add_u32 s60, s60, 4096
  ds_read_b128 v[32:35], v23 offset:256
  ds_read_b128 v[36:39], v23 offset:16640
  s_waitcnt lgkmcnt(4)
  v_mfma_f32_16x16x32_bf16 v[48:51], a[20:23], v[40:43], v[48:51]
  v_mfma_f32_16x16x32_bf16 v[52:55], a[84:87], v[40:43], v[52:55]
  v_mfma_f32_16x16x32_bf16 v[56:59], a[148:151], v[40:43], v[56:59]
  v_mfma_f32_16x16x32_bf16 v[60:63], a[212:215], v[40:43], v[60:63]
  v_mfma_f32_16x16x32_bf16 v[64:67], a[20:23], v[44:47], v[64:67]
  v_mfma_f32_16x16x32_bf16 v[68:71], a[84:87], v[44:47], v[68:71]
  v_mfma_f32_16x16x32_bf16 v[72:75], a[148:151], v[44:47], v[72:75]
  v_mfma_f32_16x16x32_bf16 v[76:79], a[212:215], v[44:47], v[76:79]
  buffer_load_dwordx4 v3, s[32:35], s60 offen offset:0 sc1 lds
  s_cmp_eq_u32 s89, 0
  s_cbranch_scc1 FS_168
  s_waitcnt vmcnt(5)
  v_mov_b32 v16, 1
  v_mov_b32 v17, 0
  buffer_store_dword v16, v17, s[32:35], s89 offen
  s_mov_b32 s89, 0
FS_168:
  ds_read_b128 v[40:43], v20 offset:512
  ds_read_b128 v[44:47], v20 offset:16896
  s_waitcnt lgkmcnt(4)
  v_mfma_f32_16x16x32_bf16 v[48:51], a[24:27], v[24:27], v[48:51]
  v_mfma_f32_16x16x32_bf16 v[52:55], a[88:91], v[24:27], v[52:55]
  v_mfma_f32_16x16x32_bf16 v[56:59], a[152:155], v[24:27], v[56:59]
  v_mfma_f32_16x16x32_bf16 v[60:63], a[216:219], v[24:27], v[60:63]
  v_mfma_f32_16x16x32_bf16 v[64:67], a[24:27], v[28:31], v[64:67]
  v_mfma_f32_16x16x32_bf16 v[68:71], a[88:91], v[28:31], v[68:71]
  v_mfma_f32_16x16x32_bf16 v[72:75], a[152:155], v[28:31], v[72:75]
  v_mfma_f32_16x16x32_bf16 v[76:79], a[216:219], v[28:31], v[76:79]
  ds_read_b128 v[24:27], v21 offset:512
  ds_read_b128 v[28:31], v21 offset:16896
  s_waitcnt lgkmcnt(4)
  v_mfma_f32_16x16x32_bf16 v[48:51], a[28:31], v[32:35], v[48:51]
  v_mfma_f32_16x16x32_bf16 v[52:55], a[92:95], v[32:35], v[52:55]
  buffer_load_dwordx4 v3, s[32:35], s60 offen offset:1024 sc1 lds
  v_mfma_f32_16x16x32_bf16 v[56:59], a[156:159], v[32:35], v[56:59]
  v_mfma_f32_16x16x32_bf16 v[60:63], a[220:223], v[32:35], v[60:63]
  v_mfma_f32_16x16x32_bf16 v[64:67], a[28:31], v[36:39], v[64:67]
  v_mfma_f32_16x16x32_bf16 v[68:71], a[92:95], v[36:39], v[68:71]
  v_mfma_f32_16x16x32_bf16 v[72:75], a[156:159], v[36:39], v[72:75]
  v_mfma_f32_16x16x32_bf16 v[76:79], a[220:223], v[36:39], v[76:79]
  ds_read_b128 v[32:35], v22 offset:512
  ds_read_b128 v[36:39], v22 offset:16896
  s_waitcnt lgkmcnt(4)
  v_mfma_f32_16x16x32_bf16 v[48:51], a[32:35], v[40:43], v[48:51]
  v_mfma_f32_16x16x32_bf16 v[52:55], a[96:99], v[40:43], v[52:55]
  v_mfma_f32_16x16x32_bf16 v[56:59], a[160:163], v[40:43], v[56:59]
  v_mfma_f32_16x16x32_bf16 v[60:63], a[224:227], v[40:43], v[60:63]
  buffer_load_dwordx4 v3, s[32:35], s60 offen offset:2048 sc1 lds
  v_mfma_f32_16x16x32_bf16 v[64:67], a[32:35], v[44:47], v[64:67]
  v_mfma_f32_16x16x32_bf16 v[68:71], a[96:99], v[44:47], v[68:71]
  v_mfma_f32_16x16x32_bf16 v[72:75], a[160:163], v[44:47], v[72:75]
  v_mfma_f32_16x16x32_bf16 v[76:79], a[224:227], v[44:47], v[76:79]
  ds_read_b128 v[40:43], v23 offset:512
  ds_read_b128 v[44:47], v23 offset:16896
  s_waitcnt lgkmcnt(4)
  v_mfma_f32_16x16x32_bf16 v[48:51], a[36:39], v[24:27], v[48:51]
  v_mfma_f32_16x16x32_bf16 v[52:55], a[100:103], v[24:27], v[52:55]
  v_mfma_f32_16x16x32_bf16 v[56:59], a[164:167], v[24:27], v[56:59]
  v_mfma_f32_16x16x32_bf16 v[60:63], a[228:231], v[24:27], v[60:63]
  v_mfma_f32_16x16x32_bf16 v[64:67], a[36:39], v[28:31], v[64:67]
  v_mfma_f32_16x16x32_bf16 v[68:71], a[100:103], v[28:31], v[68:71]
  buffer_load_dwordx4 v3, s[32:35], s60 offen offset:3072 sc1 lds
  v_mfma_f32_16x16x32_bf16 v[72:75], a[164:167], v[28:31], v[72:75]
  s_mul_i32 s78, s92, 43
  v_mfma_f32_16x16x32_bf16 v[76:79], a[228:231], v[28:31], v[76:79]
  s_bfe_u32 s78, s78, 0x20007
  ds_read_b128 v[24:27], v20 offset:768
  ds_read_b128 v[28:31], v20 offset:17152
  s_waitcnt lgkmcnt(4)
  v_mfma_f32_16x16x32_bf16 v[48:51], a[40:43], v[32:35], v[48:51]
  s_lshl_b32 s60, s71, 2
  v_mfma_f32_16x16x32_bf16 v[52:55], a[104:107], v[32:35], v[52:55]
  s_add_u32 s78, s78, s60
  v_mfma_f32_16x16x32_bf16 v[56:59], a[168:171], v[32:35], v[56:59]
  s_lshl_b32 s60, s71, 1
  v_mfma_f32_16x16x32_bf16 v[60:63], a[232:235], v[32:35], v[60:63]
  s_add_u32 s60, s60, 12
  v_mfma_f32_16x16x32_bf16 v[64:67], a[40:43], v[36:39], v[64:67]
  s_bitcmp1_b32 s78, 0
  v_mfma_f32_16x16x32_bf16 v[68:71], a[104:107], v[36:39], v[68:71]
  s_addc_u32 s60, s60, 0
  v_mfma_f32_16x16x32_bf16 v[72:75], a[168:171], v[36:39], v[72:75]
  s_cmp_ge_u32 s92, 52
  v_mfma_f32_16x16x32_bf16 v[76:79], a[232:235], v[36:39], v[76:79]
  s_cselect_b32 s60, s78, s60
  ds_read_b128 v[32:35], v21 offset:768
  ds_read_b128 v[36:39], v21 offset:17152
  s_waitcnt lgkmcnt(4)
  v_mfma_f32_16x16x32_bf16 v[48:51], a[44:47], v[40:43], v[48:51]
  s_cmp_eq_u32 s91, 0
  v_mfma_f32_16x16x32_bf16 v[52:55], a[108:111], v[40:43], v[52:55]
  s_cselect_b32 s78, s78, s60
  v_mfma_f32_16x16x32_bf16 v[56:59], a[172:175], v[40:43], v[56:59]
  s_lshl_b32 s78, s78, 19
  v_mfma_f32_16x16x32_bf16 v[60:63], a[236:239], v[40:43], v[60:63]
  s_add_u32 s78, s78, 184549376
  v_mfma_f32_16x16x32_bf16 v[64:67], a[44:47], v[44:47], v[64:67]
  s_lshl_b32 s60, s70, 11
  v_mfma_f32_16x16x32_bf16 v[68:71], a[108:111], v[44:47], v[68:71]
  s_add_u32 s78, s78, s60
  v_mfma_f32_16x16x32_bf16 v[72:75], a[172:175], v[44:47], v[72:75]
  s_lshl_b32 s60, s56, 9
  v_mfma_f32_16x16x32_bf16 v[76:79], a[236:239], v[44:47], v[76:79]
  s_add_u32 s78, s78, s60
  ds_read_b128 v[40:43], v22 offset:768
  ds_read_b128 v[44:47], v22 offset:17152
  s_waitcnt lgkmcnt(4)
  v_mfma_f32_16x16x32_bf16 v[48:51], a[48:51], v[24:27], v[48:51]
  s_lshl_b32 s79, s91, 14
  v_mfma_f32_16x16x32_bf16 v[52:55], a[112:115], v[24:27], v[52:55]
  s_lshl_b32 s60, s92, 8
  v_mfma_f32_16x16x32_bf16 v[56:59], a[176:179], v[24:27], v[56:59]
  s_add_u32 s79, s79, s60
  v_mfma_f32_16x16x32_bf16 v[60:63], a[240:243], v[24:27], v[60:63]
  s_lshl_b32 s60, s70, 4
  v_mfma_f32_16x16x32_bf16 v[64:67], a[48:51], v[28:31], v[64:67]
  s_add_u32 s79, s79, s60
  v_mfma_f32_16x16x32_bf16 v[68:71], a[112:115], v[28:31], v[68:71]
  s_lshl_b32 s60, s56, 2
  v_mfma_f32_16x16x32_bf16 v[72:75], a[176:179], v[28:31], v[72:75]
  s_add_u32 s79, s79, s60
  v_mfma_f32_16x16x32_bf16 v[76:79], a[240:243], v[28:31], v[76:79]
  s_add_u32 s79, s79, 188416
  ds_read_b128 v[24:27], v23 offset:768
  ds_read_b128 v[28:31], v23 offset:17152
  s_waitcnt lgkmcnt(4)
  v_mfma_f32_16x16x32_bf16 v[48:51], a[52:55], v[32:35], v[48:51]
  v_mfma_f32_16x16x32_bf16 v[52:55], a[116:119], v[32:35], v[52:55]
  v_mfma_f32_16x16x32_bf16 v[56:59], a[180:183], v[32:35], v[56:59]
  v_mfma_f32_16x16x32_bf16 v[60:63], a[244:247], v[32:35], v[60:63]
  v_mfma_f32_16x16x32_bf16 v[64:67], a[52:55], v[36:39], v[64:67]
  v_mfma_f32_16x16x32_bf16 v[68:71], a[116:119], v[36:39], v[68:71]
  v_mfma_f32_16x16x32_bf16 v[72:75], a[180:183], v[36:39], v[72:75]
  v_mfma_f32_16x16x32_bf16 v[76:79], a[244:247], v[36:39], v[76:79]
  s_waitcnt lgkmcnt(2)
  v_mfma_f32_16x16x32_bf16 v[48:51], a[56:59], v[40:43], v[48:51]
  v_mfma_f32_16x16x32_bf16 v[52:55], a[120:123], v[40:43], v[52:55]
  v_mfma_f32_16x16x32_bf16 v[56:59], a[184:187], v[40:43], v[56:59]
  v_mfma_f32_16x16x32_bf16 v[60:63], a[248:251], v[40:43], v[60:63]
  v_mfma_f32_16x16x32_bf16 v[64:67], a[56:59], v[44:47], v[64:67]
  v_mfma_f32_16x16x32_bf16 v[68:71], a[120:123], v[44:47], v[68:71]
  v_mfma_f32_16x16x32_bf16 v[72:75], a[184:187], v[44:47], v[72:75]
  v_mfma_f32_16x16x32_bf16 v[76:79], a[248:251], v[44:47], v[76:79]
  s_waitcnt lgkmcnt(0)
  v_mfma_f32_16x16x32_bf16 v[48:51], a[60:63], v[24:27], v[48:51]
  v_mfma_f32_16x16x32_bf16 v[52:55], a[124:127], v[24:27], v[52:55]
  v_mfma_f32_16x16x32_bf16 v[56:59], a[188:191], v[24:27], v[56:59]
  v_mfma_f32_16x16x32_bf16 v[60:63], a[252:255], v[24:27], v[60:63]
  v_mfma_f32_16x16x32_bf16 v[64:67], a[60:63], v[28:31], v[64:67]
  v_mfma_f32_16x16x32_bf16 v[68:71], a[124:127], v[28:31], v[68:71]
  v_mfma_f32_16x16x32_bf16 v[72:75], a[188:191], v[28:31], v[72:75]
  v_mfma_f32_16x16x32_bf16 v[76:79], a[252:255], v[28:31], v[76:79]
  s_nop 0
  v_max_f32 v48, 0, v48
  v_max_f32 v49, 0, v49
  v_max_f32 v50, 0, v50
  v_max_f32 v51, 0, v51
  v_max_f32 v52, 0, v52
  v_max_f32 v53, 0, v53
  v_max_f32 v54, 0, v54
  v_max_f32 v55, 0, v55
  v_pk_mul_f32 v[48:49], v[48:49], v[56:57]
  v_pk_mul_f32 v[50:51], v[50:51], v[58:59]
  v_pk_mul_f32 v[52:53], v[52:53], v[60:61]
  v_pk_mul_f32 v[54:55], v[54:55], v[62:63]
  v_cvt_pk_bf16_f32 v112, v48, v49
  v_cvt_pk_bf16_f32 v113, v50, v51
  v_cvt_pk_bf16_f32 v114, v52, v53
  v_cvt_pk_bf16_f32 v115, v54, v55
  ds_write_b128 v19, v[112:115] offset:0
  v_max_f32 v64, 0, v64
  v_max_f32 v65, 0, v65
  v_max_f32 v66, 0, v66
  v_max_f32 v67, 0, v67
  v_max_f32 v68, 0, v68
  v_max_f32 v69, 0, v69
  v_max_f32 v70, 0, v70
  v_max_f32 v71, 0, v71
  v_pk_mul_f32 v[64:65], v[64:65], v[72:73]
  v_pk_mul_f32 v[66:67], v[66:67], v[74:75]
  v_pk_mul_f32 v[68:69], v[68:69], v[76:77]
  v_pk_mul_f32 v[70:71], v[70:71], v[78:79]
  v_cvt_pk_bf16_f32 v116, v64, v65
  v_cvt_pk_bf16_f32 v117, v66, v67
  v_cvt_pk_bf16_f32 v118, v68, v69
  v_cvt_pk_bf16_f32 v119, v70, v71
  ds_write_b128 v19, v[116:119] offset:4096
  s_cmp_lg_u32 s56, 0
  s_cbranch_scc1 W0_169
  s_min_u32 s60, s84, 63
  s_min_u32 s61, s85, 63
  v_mov_b32 v12, s60
  v_mov_b32 v13, s61
  v_cndmask_b32 v12, v12, v13, s[66:67]
  v_mad_u32_u24 v13, v12, v9, v8
  v_mad_u32_u24 v14, v12, v11, v10
  s_cmp_ge_u32 s85, 52
  s_cselect_b32 s60, 0xffff0000, 0
  s_mov_b32 s61, 0
  v_cndmask_b32 v13, v13, v124, s[60:61]
  buffer_load_dword v12, v13, s[32:35], 0 offen sc1
W0_169:
  s_waitcnt lgkmcnt(0)
  s_barrier
  ds_read_b128 v[80:83], v6 offset:0
  ds_read_b128 v[96:99], v6 offset:4096
  ds_read_b128 v[84:87], v6 offset:1024
  ds_read_b128 v[100:103], v6 offset:5120
  ds_read_b128 v[88:91], v6 offset:2048
  ds_read_b128 v[104:107], v6 offset:6144
  ds_read_b128 v[92:95], v6 offset:3072
  ds_read_b128 v[108:111], v6 offset:7168
  s_add_u32 s62, s78, 262144
  s_waitcnt lgkmcnt(6)
  v_mfma_f32_16x16x32_bf16 v[48:51], v[128:131], v[80:83], 0
  v_mfma_f32_16x16x32_bf16 v[52:55], v[144:147], v[80:83], 0
  v_mfma_f32_16x16x32_bf16 v[56:59], v[128:131], v[96:99], 0
  v_mfma_f32_16x16x32_bf16 v[60:63], v[144:147], v[96:99], 0
  s_waitcnt lgkmcnt(4)
  v_mfma_f32_16x16x32_bf16 v[48:51], v[132:135], v[84:87], v[48:51]
  v_mfma_f32_16x16x32_bf16 v[52:55], v[148:151], v[84:87], v[52:55]
  v_mfma_f32_16x16x32_bf16 v[56:59], v[132:135], v[100:103], v[56:59]
  v_mfma_f32_16x16x32_bf16 v[60:63], v[148:151], v[100:103], v[60:63]
  s_waitcnt lgkmcnt(2)
  v_mfma_f32_16x16x32_bf16 v[48:51], v[136:139], v[88:91], v[48:51]
  v_mfma_f32_16x16x32_bf16 v[52:55], v[152:155], v[88:91], v[52:55]
  v_mfma_f32_16x16x32_bf16 v[56:59], v[136:139], v[104:107], v[56:59]
  v_mfma_f32_16x16x32_bf16 v[60:63], v[152:155], v[104:107], v[60:63]
  s_waitcnt lgkmcnt(0)
  v_mfma_f32_16x16x32_bf16 v[48:51], v[140:143], v[92:95], v[48:51]
  v_mfma_f32_16x16x32_bf16 v[52:55], v[156:159], v[92:95], v[52:55]
  v_mfma_f32_16x16x32_bf16 v[56:59], v[140:143], v[108:111], v[56:59]
  v_mfma_f32_16x16x32_bf16 v[60:63], v[156:159], v[108:111], v[60:63]
  v_mfma_f32_16x16x32_bf16 v[64:67], v[160:163], v[80:83], 0
  v_mfma_f32_16x16x32_bf16 v[68:71], v[176:179], v[80:83], 0
  v_mfma_f32_16x16x32_bf16 v[72:75], v[160:163], v[96:99], 0
  s_nop 1
  v_cvt_pk_bf16_f32 v112, v48, v49
  v_mfma_f32_16x16x32_bf16 v[76:79], v[176:179], v[96:99], 0
  v_cvt_pk_bf16_f32 v113, v50, v51
  v_mfma_f32_16x16x32_bf16 v[64:67], v[164:167], v[84:87], v[64:67]
  v_cvt_pk_bf16_f32 v114, v52, v53
  v_mfma_f32_16x16x32_bf16 v[68:71], v[180:183], v[84:87], v[68:71]
  v_cvt_pk_bf16_f32 v115, v54, v55
  v_mfma_f32_16x16x32_bf16 v[72:75], v[164:167], v[100:103], v[72:75]
  buffer_store_dwordx4 v[112:115], v18, s[32:35], s78 offen offset:0
  v_mfma_f32_16x16x32_bf16 v[76:79], v[180:183], v[100:103], v[76:79]
  v_cvt_pk_bf16_f32 v116, v56, v57
  v_mfma_f32_16x16x32_bf16 v[64:67], v[168:171], v[88:91], v[64:67]
  v_cvt_pk_bf16_f32 v117, v58, v59
  v_mfma_f32_16x16x32_bf16 v[68:71], v[184:187], v[88:91], v[68:71]
  v_cvt_pk_bf16_f32 v118, v60, v61
  v_mfma_f32_16x16x32_bf16 v[72:75], v[168:171], v[104:107], v[72:75]
  v_cvt_pk_bf16_f32 v119, v62, v63
  v_mfma_f32_16x16x32_bf16 v[76:79], v[184:187], v[104:107], v[76:79]
  v_mfma_f32_16x16x32_bf16 v[64:67], v[172:175], v[92:95], v[64:67]
  buffer_store_dwordx4 v[116:119], v18, s[32:35], s62 offen offset:0
  v_mfma_f32_16x16x32_bf16 v[68:71], v[188:191], v[92:95], v[68:71]
  v_mfma_f32_16x16x32_bf16 v[72:75], v[172:175], v[108:111], v[72:75]
  v_mfma_f32_16x16x32_bf16 v[76:79], v[188:191], v[108:111], v[76:79]
  v_mfma_f32_16x16x32_bf16 v[48:51], v[192:195], v[80:83], 0
  v_mfma_f32_16x16x32_bf16 v[52:55], v[208:211], v[80:83], 0
  v_mfma_f32_16x16x32_bf16 v[56:59], v[192:195], v[96:99], 0
  s_nop 0
  v_cvt_pk_bf16_f32 v112, v64, v65
  v_mfma_f32_16x16x32_bf16 v[60:63], v[208:211], v[96:99], 0
  v_cvt_pk_bf16_f32 v113, v66, v67
  v_mfma_f32_16x16x32_bf16 v[48:51], v[196:199], v[84:87], v[48:51]
  v_cvt_pk_bf16_f32 v114, v68, v69
  v_mfma_f32_16x16x32_bf16 v[52:55], v[212:215], v[84:87], v[52:55]
  v_cvt_pk_bf16_f32 v115, v70, v71
  v_mfma_f32_16x16x32_bf16 v[56:59], v[196:199], v[100:103], v[56:59]
  buffer_store_dwordx4 v[112:115], v18, s[32:35], s78 offen offset:128
  v_mfma_f32_16x16x32_bf16 v[60:63], v[212:215], v[100:103], v[60:63]
  v_cvt_pk_bf16_f32 v116, v72, v73
  v_mfma_f32_16x16x32_bf16 v[48:51], v[200:203], v[88:91], v[48:51]
  v_cvt_pk_bf16_f32 v117, v74, v75
  v_mfma_f32_16x16x32_bf16 v[52:55], v[216:219], v[88:91], v[52:55]
  v_cvt_pk_bf16_f32 v118, v76, v77
  v_mfma_f32_16x16x32_bf16 v[56:59], v[200:203], v[104:107], v[56:59]
  v_cvt_pk_bf16_f32 v119, v78, v79
  v_mfma_f32_16x16x32_bf16 v[60:63], v[216:219], v[104:107], v[60:63]
  v_mfma_f32_16x16x32_bf16 v[48:51], v[204:207], v[92:95], v[48:51]
  buffer_store_dwordx4 v[116:119], v18, s[32:35], s62 offen offset:128
  v_mfma_f32_16x16x32_bf16 v[52:55], v[220:223], v[92:95], v[52:55]
  v_mfma_f32_16x16x32_bf16 v[56:59], v[204:207], v[108:111], v[56:59]
  v_mfma_f32_16x16x32_bf16 v[60:63], v[220:223], v[108:111], v[60:63]
  v_mfma_f32_16x16x32_bf16 v[64:67], v[224:227], v[80:83], 0
  v_mfma_f32_16x16x32_bf16 v[68:71], v[240:243], v[80:83], 0
  v_mfma_f32_16x16x32_bf16 v[72:75], v[224:227], v[96:99], 0
  s_nop 0
  v_cvt_pk_bf16_f32 v112, v48, v49
  v_mfma_f32_16x16x32_bf16 v[76:79], v[240:243], v[96:99], 0
  v_cvt_pk_bf16_f32 v113, v50, v51
  v_mfma_f32_16x16x32_bf16 v[64:67], v[228:231], v[84:87], v[64:67]
  v_cvt_pk_bf16_f32 v114, v52, v53
  v_mfma_f32_16x16x32_bf16 v[68:71], v[244:247], v[84:87], v[68:71]
  v_cvt_pk_bf16_f32 v115, v54, v55
  v_mfma_f32_16x16x32_bf16 v[72:75], v[228:231], v[100:103], v[72:75]
  buffer_store_dwordx4 v[112:115], v18, s[32:35], s78 offen offset:256
  v_mfma_f32_16x16x32_bf16 v[76:79], v[244:247], v[100:103], v[76:79]
  v_cvt_pk_bf16_f32 v116, v56, v57
  v_mfma_f32_16x16x32_bf16 v[64:67], v[232:235], v[88:91], v[64:67]
  v_cvt_pk_bf16_f32 v117, v58, v59
  v_mfma_f32_16x16x32_bf16 v[68:71], v[248:251], v[88:91], v[68:71]
  v_cvt_pk_bf16_f32 v118, v60, v61
  v_mfma_f32_16x16x32_bf16 v[72:75], v[232:235], v[104:107], v[72:75]
  v_cvt_pk_bf16_f32 v119, v62, v63
  v_mfma_f32_16x16x32_bf16 v[76:79], v[248:251], v[104:107], v[76:79]
  v_mfma_f32_16x16x32_bf16 v[64:67], v[236:239], v[92:95], v[64:67]
  buffer_store_dwordx4 v[116:119], v18, s[32:35], s62 offen offset:256
  v_mfma_f32_16x16x32_bf16 v[68:71], v[252:255], v[92:95], v[68:71]
  v_mfma_f32_16x16x32_bf16 v[72:75], v[236:239], v[108:111], v[72:75]
  v_mfma_f32_16x16x32_bf16 v[76:79], v[252:255], v[108:111], v[76:79]
  s_nop 3
  v_cvt_pk_bf16_f32 v112, v64, v65
  v_cvt_pk_bf16_f32 v113, v66, v67
  v_cvt_pk_bf16_f32 v114, v68, v69
  v_cvt_pk_bf16_f32 v115, v70, v71
  buffer_store_dwordx4 v[112:115], v18, s[32:35], s78 offen offset:384
  v_cvt_pk_bf16_f32 v116, v72, v73
  v_cvt_pk_bf16_f32 v117, v74, v75
  v_cvt_pk_bf16_f32 v118, v76, v77
  v_cvt_pk_bf16_f32 v119, v78, v79
  buffer_store_dwordx4 v[116:119], v18, s[32:35], s62 offen offset:384
  s_cmp_lg_u32 s56, 0
  s_cbranch_scc1 W0_170
  s_waitcnt vmcnt(8)
  v_cmp_ge_u32 vcc, v12, v14
  s_and_b32 s63, vcc_hi, 0xffff
  s_add_u32 s61, s85, 64
  s_cmp_lt_u32 s85, 64
  s_cselect_b32 s61, s61, 255
  s_cmp_eq_u32 vcc_lo, -1
  s_cselect_b32 s61, s61, 255
  s_cmp_lt_u32 s84, 64
  s_cselect_b32 s60, s84, 255
  s_cmp_eq_u32 vcc_hi, -1
  s_cselect_b32 s60, s60, 255
  s_cmp_lt_u32 s84, 64
  s_cselect_b32 s63, s63, 0
  s_cmp_lg_u32 s63, 0
  s_cselect_b32 s61, 255, s61
  s_lshl_b32 s62, s88, 1
  s_add_u32 s62, s62, s86
  s_cmp_lt_u32 s84, 64
  s_cselect_b32 s62, s62, 0
  s_cmp_eq_u32 s62, 3
  s_cselect_b32 s61, 255, s61
  s_min_u32 s60, s60, s61
  v_mov_b32 v12, s60
  v_mov_b32 v13, s90
  ds_write_b32 v13, v12
W0_170:
  s_mov_b32 s89, s79
  s_cmp_lg_u32 s88, 0
  s_cbranch_scc1 L_FFN_TOPF
  s_branch L_FFN_IDLEF
L_FFN_SLOW:
  s_branch L_FFN_FIRSTS
L_FFN_IDLES:
  s_cmp_eq_u32 s89, 0
  s_cbranch_scc1 FS_175
  s_waitcnt vmcnt(0)
  v_mov_b32 v16, 1
  v_mov_b32 v17, 0
  buffer_store_dword v16, v17, s[32:35], s89 offen sc1
  s_mov_b32 s89, 0
FS_175:
  s_waitcnt lgkmcnt(0)
  s_barrier
  v_mov_b32 v13, s90
  ds_read_b32 v12, v13
  s_xor_b32 s90, s90, 4
  s_waitcnt lgkmcnt(0)
  v_readfirstlane_b32 s60, v12
  s_lshr_b32 s86, s60, 6
  s_and_b32 s87, s60, 63
  s_cmp_eq_u32 s86, 0
  s_cselect_b32 s61, 3, 0
  s_add_u32 s84, s84, s61
  s_cmp_eq_u32 s86, 1
  s_cselect_b32 s61, 3, 0
  s_add_u32 s85, s85, s61
  s_cmp_lt_u32 s86, 2
  s_cselect_b32 s88, 1, 0
  s_cselect_b32 s86, s86, 0
  s_cselect_b32 s87, s87, 0
  v_mul_u32_u24 v3, s88, v2
  s_cmp_lg_u32 s88, 0
  s_cbranch_scc1 PKH_174
L_FFN_FIRSTS:
  s_min_u32 s60, s84, s85
  s_cmp_ge_u32 s60, 64
  s_cbranch_scc1 L_END
  s_cmp_lg_u32 s56, 0
  s_cbranch_scc1 PKW_173
  s_min_u32 s60, s84, 63
  s_min_u32 s61, s85, 63
  v_mov_b32 v12, s60
  v_mov_b32 v13, s61
  v_cndmask_b32 v12, v12, v13, s[66:67]
  v_mad_u32_u24 v13, v12, v9, v8
  v_mad_u32_u24 v14, v12, v11, v10
  s_cmp_ge_u32 s85, 52
  s_cselect_b32 s60, 0xffff0000, 0
  s_mov_b32 s61, 0
  v_cndmask_b32 v13, v13, v124, s[60:61]
  buffer_load_dword v12, v13, s[32:35], 0 offen sc1
PK_171:
  s_waitcnt vmcnt(0)
  v_cmp_ge_u32 vcc, v12, v14
  s_and_b32 s63, vcc_hi, 0xffff
  s_add_u32 s61, s85, 64
  s_cmp_lt_u32 s85, 64
  s_cselect_b32 s61, s61, 255
  s_cmp_eq_u32 vcc_lo, -1
  s_cselect_b32 s61, s61, 255
  s_cmp_lt_u32 s84, 64
  s_cselect_b32 s60, s84, 255
  s_cmp_eq_u32 vcc_hi, -1
  s_cselect_b32 s60, s60, 255
  s_cmp_lt_u32 s84, 64
  s_cselect_b32 s63, s63, 0
  s_cmp_lg_u32 s63, 0
  s_cselect_b32 s61, 255, s61
  s_min_u32 s60, s60, s61
  s_cmp_lg_u32 s60, 255
  s_cbranch_scc1 PKG_172
  s_add_u32 s64, s64, 1
  s_cmp_lt_u32 s64, 131072
  s_cbranch_scc1 SPOK_176
  s_mov_b32 s63, 8
  s_branch L_ABORT
SPOK_176:
  s_sleep 2
  buffer_load_dword v12, v13, s[32:35], 0 offen sc1
  s_branch PK_171
PKG_172:
  s_mov_b32 s64, 0
  v_mov_b32 v12, s60
  v_mov_b32 v13, s90
  ds_write_b32 v13, v12
  s_waitcnt lgkmcnt(0)
PKW_173:
  s_barrier
  v_mov_b32 v13, s90
  ds_read_b32 v12, v13
  s_xor_b32 s90, s90, 4
  s_waitcnt lgkmcnt(0)
  v_readfirstlane_b32 s60, v12
  s_lshr_b32 s86, s60, 6
  s_and_b32 s87, s60, 63
  s_cmp_eq_u32 s86, 0
  s_cselect_b32 s61, 3, 0
  s_add_u32 s84, s84, s61
  s_cmp_eq_u32 s86, 1
  s_cselect_b32 s61, 3, 0
  s_add_u32 s85, s85, s61
  s_cmp_lt_u32 s86, 2
  s_cselect_b32 s88, 1, 0
  s_cselect_b32 s86, s86, 0
  s_cselect_b32 s87, s87, 0
  v_mul_u32_u24 v3, s88, v2
PKH_174:
  s_mov_b32 s77, 0
  s_lshl_b32 s60, s87, 15
  s_add_u32 s77, s77, s60
  s_add_u32 s77, s77, 6291456
  s_lshl_b32 s60, s56, 13
  s_add_u32 m0, s60, s76
  s_add_u32 s60, s60, s77
  buffer_load_dwordx4 v3, s[32:35], s60 offen offset:0 sc1 lds
  buffer_load_dwordx4 v3, s[32:35], s60 offen offset:1024 sc1 lds
  buffer_load_dwordx4 v3, s[32:35], s60 offen offset:2048 sc1 lds
  buffer_load_dwordx4 v3, s[32:35], s60 offen offset:3072 sc1 lds
  s_add_u32 m0, m0, 4096
  s_add_u32 s60, s60, 4096
  buffer_load_dwordx4 v3, s[32:35], s60 offen offset:0 sc1 lds
  buffer_load_dwordx4 v3, s[32:35], s60 offen offset:1024 sc1 lds
  buffer_load_dwordx4 v3, s[32:35], s60 offen offset:2048 sc1 lds
  buffer_load_dwordx4 v3, s[32:35], s60 offen offset:3072 sc1 lds
  s_cmp_lg_u32 s56, 0
  s_cbranch_scc1 W0_177
  s_min_u32 s60, s84, 63
  s_min_u32 s61, s85, 63
  v_mov_b32 v12, s60
  v_mov_b32 v13, s61
  v_cndmask_b32 v12, v12, v13, s[66:67]
  v_mad_u32_u24 v13, v12, v9, v8
  v_mad_u32_u24 v14, v12, v11, v10
  s_cmp_ge_u32 s85, 52
  s_cselect_b32 s60, 0xffff0000, 0
  s_mov_b32 s61, 0
  v_cndmask_b32 v13, v13, v124, s[60:61]
  buffer_load_dword v12, v13, s[32:35], 0 offen sc1
W0_177:
  s_waitcnt vmcnt(0)
  s_cmp_lg_u32 s56, 0
  s_cbranch_scc1 W0_178
  s_waitcnt vmcnt(0)
  v_cmp_ge_u32 vcc, v12, v14
  s_and_b32 s63, vcc_hi, 0xffff
  s_add_u32 s61, s85, 64
  s_cmp_lt_u32 s85, 64
  s_cselect_b32 s61, s61, 255
  s_cmp_eq_u32 vcc_lo, -1
  s_cselect_b32 s61, s61, 255
  s_cmp_lt_u32 s84, 64
  s_cselect_b32 s60, s84, 255
  s_cmp_eq_u32 vcc_hi, -1
  s_cselect_b32 s60, s60, 255
  s_cmp_lt_u32 s84, 64
  s_cselect_b32 s63, s63, 0
  s_cmp_lg_u32 s63, 0
  s_cselect_b32 s61, 255, s61
  s_lshl_b32 s62, s88, 1
  s_add_u32 s62, s62, s86
  s_cmp_lt_u32 s84, 64
  s_cselect_b32 s62, s62, 0
  s_cmp_eq_u32 s62, 3
  s_cselect_b32 s61, 255, s61
  s_min_u32 s60, s60, s61
  v_mov_b32 v12, s60
  v_mov_b32 v13, s90
  ds_write_b32 v13, v12
W0_178:
  s_waitcnt lgkmcnt(0)
L_FFN_TOPS:
L_FFN_BODYS:
  s_mov_b32 s91, s86
  s_mov_b32 s92, s87
  v_add_u32 v20, s76, v120
  v_add_u32 v21, s76, v121
  v_add_u32 v22, s76, v122
  v_add_u32 v23, s76, v123
  s_xor_b32 s76, s76, 0x8000
  s_waitcnt vmcnt(8) lgkmcnt(0)
  s_barrier
  v_mov_b32 v13, s90
  ds_read_b32 v12, v13
  s_xor_b32 s90, s90, 4
  ds_read_b128 v[24:27], v20 offset:0
  ds_read_b128 v[28:31], v20 offset:16384
  ds_read_b128 v[32:35], v21 offset:0
  ds_read_b128 v[36:39], v21 offset:16384
  s_waitcnt lgkmcnt(4)
  v_readfirstlane_b32 s60, v12
  s_lshr_b32 s86, s60, 6
  s_and_b32 s87, s60, 63
  s_cmp_eq_u32 s86, 0
  s_cselect_b32 s61, 3, 0
  s_add_u32 s84, s84, s61
  s_cmp_eq_u32 s86, 1
  s_cselect_b32 s61, 3, 0
  s_add_u32 s85, s85, s61
  s_cmp_lt_u32 s86, 2
  s_cselect_b32 s88, 1, 0
  s_cselect_b32 s86, s86, 0
  s_cselect_b32 s87, s87, 0
  v_mul_u32_u24 v3, s88, v2
  ds_read_b128 v[40:43], v22 offset:0
  ds_read_b128 v[44:47], v22 offset:16384
  s_waitcnt lgkmcnt(4)
  v_mfma_f32_16x16x32_bf16 v[48:51], a[0:3], v[24:27], 0
  s_mov_b32 s77, 0
  v_mfma_f32_16x16x32_bf16 v[52:55], a[64:67], v[24:27], 0
  s_lshl_b32 s60, s87, 15
  v_mfma_f32_16x16x32_bf16 v[56:59], a[128:131], v[24:27], 0
  s_add_u32 s77, s77, s60
  v_mfma_f32_16x16x32_bf16 v[60:63], a[192:195], v[24:27], 0
  s_add_u32 s77, s77, 6291456
  v_mfma_f32_16x16x32_bf16 v[64:67], a[0:3], v[28:31], 0
  s_lshl_b32 s60, s56, 13
  v_mfma_f32_16x16x32_bf16 v[68:71], a[64:67], v[28:31], 0
  s_add_u32 m0, s60, s76
  v_mfma_f32_16x16x32_bf16 v[72:75], a[128:131], v[28:31], 0
  s_add_u32 s60, s60, s77
  v_mfma_f32_16x16x32_bf16 v[76:79], a[192:195], v[28:31], 0
  buffer_load_dwordx4 v3, s[32:35], s60 offen offset:0 sc1 lds
  ds_read_b128 v[24:27], v23 offset:0
  ds_read_b128 v[28:31], v23 offset:16384
  s_waitcnt lgkmcnt(4)
  v_mfma_f32_16x16x32_bf16 v[48:51], a[4:7], v[32:35], v[48:51]
  v_mfma_f32_16x16x32_bf16 v[52:55], a[68:71], v[32:35], v[52:55]
  v_mfma_f32_16x16x32_bf16 v[56:59], a[132:135], v[32:35], v[56:59]
  v_mfma_f32_16x16x32_bf16 v[60:63], a[196:199], v[32:35], v[60:63]
  v_mfma_f32_16x16x32_bf16 v[64:67], a[4:7], v[36:39], v[64:67]
  v_mfma_f32_16x16x32_bf16 v[68:71], a[68:71], v[36:39], v[68:71]
  v_mfma_f32_16x16x32_bf16 v[72:75], a[132:135], v[36:39], v[72:75]
  v_mfma_f32_16x16x32_bf16 v[76:79], a[196:199], v[36:39], v[76:79]
  ds_read_b128 v[32:35], v20 offset:256
  ds_read_b128 v[36:39], v20 offset:16640
  s_waitcnt lgkmcnt(4)
  v_mfma_f32_16x16x32_bf16 v[48:51], a[8:11], v[40:43], v[48:51]
  v_mfma_f32_16x16x32_bf16 v[52:55], a[72:75], v[40:43], v[52:55]
  buffer_load_dwordx4 v3, s[32:35], s60 offen offset:1024 sc1 lds
  v_mfma_f32_16x16x32_bf16 v[56:59], a[136:139], v[40:43], v[56:59]
  v_mfma_f32_16x16x32_bf16 v[60:63], a[200:203], v[40:43], v[60:63]
  v_mfma_f32_16x16x32_bf16 v[64:67], a[8:11], v[44:47], v[64:67]
  v_mfma_f32_16x16x32_bf16 v[68:71], a[72:75], v[44:47], v[68:71]
  v_mfma_f32_16x16x32_bf16 v[72:75], a[136:139], v[44:47], v[72:75]
  v_mfma_f32_16x16x32_bf16 v[76:79], a[200:203], v[44:47], v[76:79]
  ds_read_b128 v[40:43], v21 offset:256
  ds_read_b128 v[44:47], v21 offset:16640
  s_waitcnt lgkmcnt(4)
  v_mfma_f32_16x16x32_bf16 v[48:51], a[12:15], v[24:27], v[48:51]
  v_mfma_f32_16x16x32_bf16 v[52:55], a[76:79], v[24:27], v[52:55]
  v_mfma_f32_16x16x32_bf16 v[56:59], a[140:143], v[24:27], v[56:59]
  v_mfma_f32_16x16x32_bf16 v[60:63], a[204:207], v[24:27], v[60:63]
  buffer_load_dwordx4 v3, s[32:35], s60 offen offset:2048 sc1 lds
  v_mfma_f32_16x16x32_bf16 v[64:67], a[12:15], v[28:31], v[64:67]
  v_mfma_f32_16x16x32_bf16 v[68:71], a[76:79], v[28:31], v[68:71]
  v_mfma_f32_16x16x32_bf16 v[72:75], a[140:143], v[28:31], v[72:75]
  v_mfma_f32_16x16x32_bf16 v[76:79], a[204:207], v[28:31], v[76:79]
  ds_read_b128 v[24:27], v22 offset:256
  ds_read_b128 v[28:31], v22 offset:16640
  s_waitcnt lgkmcnt(4)
  v_mfma_f32_16x16x32_bf16 v[48:51], a[16:19], v[32:35], v[48:51]
  v_mfma_f32_16x16x32_bf16 v[52:55], a[80:83], v[32:35], v[52:55]
  v_mfma_f32_16x16x32_bf16 v[56:59], a[144:147], v[32:35], v[56:59]
  v_mfma_f32_16x16x32_bf16 v[60:63], a[208:211], v[32:35], v[60:63]
  v_mfma_f32_16x16x32_bf16 v[64:67], a[16:19], v[36:39], v[64:67]
  v_mfma_f32_16x16x32_bf16 v[68:71], a[80:83], v[36:39], v[68:71]
  buffer_load_dwordx4 v3, s[32:35], s60 offen offset:3072 sc1 lds
  v_mfma_f32_16x16x32_bf16 v[72:75], a[144:147], v[36:39], v[72:75]
  s_add_u32 m0, m0, 4096
  v_mfma_f32_16x16x32_bf16 v[76:79], a[208:211], v[36:39], v[76:79]
  s_add_u32 s60, s60, 4096
  ds_read_b128 v[32:35], v23 offset:256
  ds_read_b128 v[36:39], v23 offset:16640
  s_waitcnt lgkmcnt(4)
  v_mfma_f32_16x16x32_bf16 v[48:51], a[20:23], v[40:43], v[48:51]
  v_mfma_f32_16x16x32_bf16 v[52:55], a[84:87], v[40:43], v[52:55]
  v_mfma_f32_16x16x32_bf16 v[56:59], a[148:151], v[40:43], v[56:59]
  v_mfma_f32_16x16x32_bf16 v[60:63], a[212:215], v[40:43], v[60:63]
  v_mfma_f32_16x16x32_bf16 v[64:67], a[20:23], v[44:47], v[64:67]
  v_mfma_f32_16x16x32_bf16 v[68:71], a[84:87], v[44:47], v[68:71]
  v_mfma_f32_16x16x32_bf16 v[72:75], a[148:151], v[44:47], v[72:75]
  v_mfma_f32_16x16x32_bf16 v[76:79], a[212:215], v[44:47], v[76:79]
  buffer_load_dwordx4 v3, s[32:35], s60 offen offset:0 sc1 lds
  s_cmp_eq_u32 s89, 0
  s_cbranch_scc1 FS_179
  s_waitcnt vmcnt(5)
  v_mov_b32 v16, 1
  v_mov_b32 v17, 0
  buffer_store_dword v16, v17, s[32:35], s89 offen sc1
  s_mov_b32 s89, 0
FS_179:
  ds_read_b128 v[40:43], v20 offset:512
  ds_read_b128 v[44:47], v20 offset:16896
  s_waitcnt lgkmcnt(4)
  v_mfma_f32_16x16x32_bf16 v[48:51], a[24:27], v[24:27], v[48:51]
  v_mfma_f32_16x16x32_bf16 v[52:55], a[88:91], v[24:27], v[52:55]
  v_mfma_f32_16x16x32_bf16 v[56:59], a[152:155], v[24:27], v[56:59]
  v_mfma_f32_16x16x32_bf16 v[60:63], a[216:219], v[24:27], v[60:63]
  v_mfma_f32_16x16x32_bf16 v[64:67], a[24:27], v[28:31], v[64:67]
  v_mfma_f32_16x16x32_bf16 v[68:71], a[88:91], v[28:31], v[68:71]
  v_mfma_f32_16x16x32_bf16 v[72:75], a[152:155], v[28:31], v[72:75]
  v_mfma_f32_16x16x32_bf16 v[76:79], a[216:219], v[28:31], v[76:79]
  ds_read_b128 v[24:27], v21 offset:512
  ds_read_b128 v[28:31], v21 offset:16896
  s_waitcnt lgkmcnt(4)
  v_mfma_f32_16x16x32_bf16 v[48:51], a[28:31], v[32:35], v[48:51]
  v_mfma_f32_16x16x32_bf16 v[52:55], a[92:95], v[32:35], v[52:55]
  buffer_load_dwordx4 v3, s[32:35], s60 offen offset:1024 sc1 lds
  v_mfma_f32_16x16x32_bf16 v[56:59], a[156:159], v[32:35], v[56:59]
  v_mfma_f32_16x16x32_bf16 v[60:63], a[220:223], v[32:35], v[60:63]
  v_mfma_f32_16x16x32_bf16 v[64:67], a[28:31], v[36:39], v[64:67]
  v_mfma_f32_16x16x32_bf16 v[68:71], a[92:95], v[36:39], v[68:71]
  v_mfma_f32_16x16x32_bf16 v[72:75], a[156:159], v[36:39], v[72:75]
  v_mfma_f32_16x16x32_bf16 v[76:79], a[220:223], v[36:39], v[76:79]
  ds_read_b128 v[32:35], v22 offset:512
  ds_read_b128 v[36:39], v22 offset:16896
  s_waitcnt lgkmcnt(4)
  v_mfma_f32_16x16x32_bf16 v[48:51], a[32:35], v[40:43], v[48:51]
  v_mfma_f32_16x16x32_bf16 v[52:55], a[96:99], v[40:43], v[52:55]
  v_mfma_f32_16x16x32_bf16 v[56:59], a[160:163], v[40:43], v[56:59]
  v_mfma_f32_16x16x32_bf16 v[60:63], a[224:227], v[40:43], v[60:63]
  buffer_load_dwordx4 v3, s[32:35], s60 offen offset:2048 sc1 lds
  v_mfma_f32_16x16x32_bf16 v[64:67], a[32:35], v[44:47], v[64:67]
  v_mfma_f32_16x16x32_bf16 v[68:71], a[96:99], v[44:47], v[68:71]
  v_mfma_f32_16x16x32_bf16 v[72:75], a[160:163], v[44:47], v[72:75]
  v_mfma_f32_16x16x32_bf16 v[76:79], a[224:227], v[44:47], v[76:79]
  ds_read_b128 v[40:43], v23 offset:512
  ds_read_b128 v[44:47], v23 offset:16896
  s_waitcnt lgkmcnt(4)
  v_mfma_f32_16x16x32_bf16 v[48:51], a[36:39], v[24:27], v[48:51]
  v_mfma_f32_16x16x32_bf16 v[52:55], a[100:103], v[24:27], v[52:55]
  v_mfma_f32_16x16x32_bf16 v[56:59], a[164:167], v[24:27], v[56:59]
  v_mfma_f32_16x16x32_bf16 v[60:63], a[228:231], v[24:27], v[60:63]
  v_mfma_f32_16x16x32_bf16 v[64:67], a[36:39], v[28:31], v[64:67]
  v_mfma_f32_16x16x32_bf16 v[68:71], a[100:103], v[28:31], v[68:71]
  buffer_load_dwordx4 v3, s[32:35], s60 offen offset:3072 sc1 lds
  v_mfma_f32_16x16x32_bf16 v[72:75], a[164:167], v[28:31], v[72:75]
  s_mul_i32 s78, s92, 43
  v_mfma_f32_16x16x32_bf16 v[76:79], a[228:231], v[28:31], v[76:79]
  s_bfe_u32 s78, s78, 0x20007
  ds_read_b128 v[24:27], v20 offset:768
  ds_read_b128 v[28:31], v20 offset:17152
  s_waitcnt lgkmcnt(4)
  v_mfma_f32_16x16x32_bf16 v[48:51], a[40:43], v[32:35], v[48:51]
  s_lshl_b32 s60, s71, 2
  v_mfma_f32_16x16x32_bf16 v[52:55], a[104:107], v[32:35], v[52:55]
  s_add_u32 s78, s78, s60
  v_mfma_f32_16x16x32_bf16 v[56:59], a[168:171], v[32:35], v[56:59]
  s_lshl_b32 s60, s71, 1
  v_mfma_f32_16x16x32_bf16 v[60:63], a[232:235], v[32:35], v[60:63]
  s_add_u32 s60, s60, 12
  v_mfma_f32_16x16x32_bf16 v[64:67], a[40:43], v[36:39], v[64:67]
  s_bitcmp1_b32 s78, 0
  v_mfma_f32_16x16x32_bf16 v[68:71], a[104:107], v[36:39], v[68:71]
  s_addc_u32 s60, s60, 0
  v_mfma_f32_16x16x32_bf16 v[72:75], a[168:171], v[36:39], v[72:75]
  s_cmp_ge_u32 s92, 52
  v_mfma_f32_16x16x32_bf16 v[76:79], a[232:235], v[36:39], v[76:79]
  s_cselect_b32 s60, s78, s60
  ds_read_b128 v[32:35], v21 offset:768
  ds_read_b128 v[36:39], v21 offset:17152
  s_waitcnt lgkmcnt(4)
  v_mfma_f32_16x16x32_bf16 v[48:51], a[44:47], v[40:43], v[48:51]
  s_cmp_eq_u32 s91, 0
  v_mfma_f32_16x16x32_bf16 v[52:55], a[108:111], v[40:43], v[52:55]
  s_cselect_b32 s78, s78, s60
  v_mfma_f32_16x16x32_bf16 v[56:59], a[172:175], v[40:43], v[56:59]
  s_lshl_b32 s78, s78, 19
  v_mfma_f32_16x16x32_bf16 v[60:63], a[236:239], v[40:43], v[60:63]
  s_add_u32 s78, s78, 184549376
  v_mfma_f32_16x16x32_bf16 v[64:67], a[44:47], v[44:47], v[64:67]
  s_lshl_b32 s60, s70, 11
  v_mfma_f32_16x16x32_bf16 v[68:71], a[108:111], v[44:47], v[68:71]
  s_add_u32 s78, s78, s60
  v_mfma_f32_16x16x32_bf16 v[72:75], a[172:175], v[44:47], v[72:75]
  s_lshl_b32 s60, s56, 9
  v_mfma_f32_16x16x32_bf16 v[76:79], a[236:239], v[44:47], v[76:79]
  s_add_u32 s78, s78, s60
  ds_read_b128 v[40:43], v22 offset:768
  ds_read_b128 v[44:47], v22 offset:17152
  s_waitcnt lgkmcnt(4)
  v_mfma_f32_16x16x32_bf16 v[48:51], a[48:51], v[24:27], v[48:51]
  s_lshl_b32 s79, s91, 14
  v_mfma_f32_16x16x32_bf16 v[52:55], a[112:115], v[24:27], v[52:55]
  s_lshl_b32 s60, s92, 8
  v_mfma_f32_16x16x32_bf16 v[56:59], a[176:179], v[24:27], v[56:59]
  s_add_u32 s79, s79, s60
  v_mfma_f32_16x16x32_bf16 v[60:63], a[240:243], v[24:27], v[60:63]
  s_lshl_b32 s60, s70, 4
  v_mfma_f32_16x16x32_bf16 v[64:67], a[48:51], v[28:31], v[64:67]
  s_add_u32 s79, s79, s60
  v_mfma_f32_16x16x32_bf16 v[68:71], a[112:115], v[28:31], v[68:71]
  s_lshl_b32 s60, s56, 2
  v_mfma_f32_16x16x32_bf16 v[72:75], a[176:179], v[28:31], v[72:75]
  s_add_u32 s79, s79, s60
  v_mfma_f32_16x16x32_bf16 v[76:79], a[240:243], v[28:31], v[76:79]
  s_add_u32 s79, s79, 188416
  ds_read_b128 v[24:27], v23 offset:768
  ds_read_b128 v[28:31], v23 offset:17152
  s_waitcnt lgkmcnt(4)
  v_mfma_f32_16x16x32_bf16 v[48:51], a[52:55], v[32:35], v[48:51]
  v_mfma_f32_16x16x32_bf16 v[52:55], a[116:119], v[32:35], v[52:55]
  v_mfma_f32_16x16x32_bf16 v[56:59], a[180:183], v[32:35], v[56:59]
  v_mfma_f32_16x16x32_bf16 v[60:63], a[244:247], v[32:35], v[60:63]
  v_mfma_f32_16x16x32_bf16 v[64:67], a[52:55], v[36:39], v[64:67]
  v_mfma_f32_16x16x32_bf16 v[68:71], a[116:119], v[36:39], v[68:71]
  v_mfma_f32_16x16x32_bf16 v[72:75], a[180:183], v[36:39], v[72:75]
  v_mfma_f32_16x16x32_bf16 v[76:79], a[244:247], v[36:39], v[76:79]
  s_waitcnt lgkmcnt(2)
  v_mfma_f32_16x16x32_bf16 v[48:51], a[56:59], v[40:43], v[48:51]
  v_mfma_f32_16x16x32_bf16 v[52:55], a[120:123], v[40:43], v[52:55]
  v_mfma_f32_16x16x32_bf16 v[56:59], a[184:187], v[40:43], v[56:59]
  v_mfma_f32_16x16x32_bf16 v[60:63], a[248:251], v[40:43], v[60:63]
  v_mfma_f32_16x16x32_bf16 v[64:67], a[56:59], v[44:47], v[64:67]
  v_mfma_f32_16x16x32_bf16 v[68:71], a[120:123], v[44:47], v[68:71]
  v_mfma_f32_16x16x32_bf16 v[72:75], a[184:187], v[44:47], v[72:75]
  v_mfma_f32_16x16x32_bf16 v[76:79], a[248:251], v[44:47], v[76:79]
  s_waitcnt lgkmcnt(0)
  v_mfma_f32_16x16x32_bf16 v[48:51], a[60:63], v[24:27], v[48:51]
  v_mfma_f32_16x16x32_bf16 v[52:55], a[124:127], v[24:27], v[52:55]
  v_mfma_f32_16x16x32_bf16 v[56:59], a[188:191], v[24:27], v[56:59]
  v_mfma_f32_16x16x32_bf16 v[60:63], a[252:255], v[24:27], v[60:63]
  v_mfma_f32_16x16x32_bf16 v[64:67], a[60:63], v[28:31], v[64:67]
  v_mfma_f32_16x16x32_bf16 v[68:71], a[124:127], v[28:31], v[68:71]
  v_mfma_f32_16x16x32_bf16 v[72:75], a[188:191], v[28:31], v[72:75]
  v_mfma_f32_16x16x32_bf16 v[76:79], a[252:255], v[28:31], v[76:79]
  s_nop 0
  v_max_f32 v48, 0, v48
  v_max_f32 v49, 0, v49
  v_max_f32 v50, 0, v50
  v_max_f32 v51, 0, v51
  v_max_f32 v52, 0, v52
  v_max_f32 v53, 0, v53
  v_max_f32 v54, 0, v54
  v_max_f32 v55, 0, v55
  v_pk_mul_f32 v[48:49], v[48:49], v[56:57]
  v_pk_mul_f32 v[50:51], v[50:51], v[58:59]
  v_pk_mul_f32 v[52:53], v[52:53], v[60:61]
  v_pk_mul_f32 v[54:55], v[54:55], v[62:63]
  v_cvt_pk_bf16_f32 v112, v48, v49
  v_cvt_pk_bf16_f32 v113, v50, v51
  v_cvt_pk_bf16_f32 v114, v52, v53
  v_cvt_pk_bf16_f32 v115, v54, v55
  ds_write_b128 v19, v[112:115] offset:0
  v_max_f32 v64, 0, v64
  v_max_f32 v65, 0, v65
  v_max_f32 v66, 0, v66
  v_max_f32 v67, 0, v67
  v_max_f32 v68, 0, v68
  v_max_f32 v69, 0, v69
  v_max_f32 v70, 0, v70
  v_max_f32 v71, 0, v71
  v_pk_mul_f32 v[64:65], v[64:65], v[72:73]
  v_pk_mul_f32 v[66:67], v[66:67], v[74:75]
  v_pk_mul_f32 v[68:69], v[68:69], v[76:77]
  v_pk_mul_f32 v[70:71], v[70:71], v[78:79]
  v_cvt_pk_bf16_f32 v116, v64, v65
  v_cvt_pk_bf16_f32 v117, v66, v67
  v_cvt_pk_bf16_f32 v118, v68, v69
  v_cvt_pk_bf16_f32 v119, v70, v71
  ds_write_b128 v19, v[116:119] offset:4096
  s_cmp_lg_u32 s56, 0
  s_cbranch_scc1 W0_180
  s_min_u32 s60, s84, 63
  s_min_u32 s61, s85, 63
  v_mov_b32 v12, s60
  v_mov_b32 v13, s61
  v_cndmask_b32 v12, v12, v13, s[66:67]
  v_mad_u32_u24 v13, v12, v9, v8
  v_mad_u32_u24 v14, v12, v11, v10
  s_cmp_ge_u32 s85, 52
  s_cselect_b32 s60, 0xffff0000, 0
  s_mov_b32 s61, 0
  v_cndmask_b32 v13, v13, v124, s[60:61]
  buffer_load_dword v12, v13, s[32:35], 0 offen sc1
W0_180:
  s_waitcnt lgkmcnt(0)
  s_barrier
  ds_read_b128 v[80:83], v6 offset:0
  ds_read_b128 v[96:99], v6 offset:4096
  ds_read_b128 v[84:87], v6 offset:1024
  ds_read_b128 v[100:103], v6 offset:5120
  ds_read_b128 v[88:91], v6 offset:2048
  ds_read_b128 v[104:107], v6 offset:6144
  ds_read_b128 v[92:95], v6 offset:3072
  ds_read_b128 v[108:111], v6 offset:7168
  s_add_u32 s62, s78, 262144
  s_waitcnt lgkmcnt(6)
  v_mfma_f32_16x16x32_bf16 v[48:51], v[128:131], v[80:83], 0
  v_mfma_f32_16x16x32_bf16 v[52:55], v[144:147], v[80:83], 0
  v_mfma_f32_16x16x32_bf16 v[56:59], v[128:131], v[96:99], 0
  v_mfma_f32_16x16x32_bf16 v[60:63], v[144:147], v[96:99], 0
  s_waitcnt lgkmcnt(4)
  v_mfma_f32_16x16x32_bf16 v[48:51], v[132:135], v[84:87], v[48:51]
  v_mfma_f32_16x16x32_bf16 v[52:55], v[148:151], v[84:87], v[52:55]
  v_mfma_f32_16x16x32_bf16 v[56:59], v[132:135], v[100:103], v[56:59]
  v_mfma_f32_16x16x32_bf16 v[60:63], v[148:151], v[100:103], v[60:63]
  s_waitcnt lgkmcnt(2)
  v_mfma_f32_16x16x32_bf16 v[48:51], v[136:139], v[88:91], v[48:51]
  v_mfma_f32_16x16x32_bf16 v[52:55], v[152:155], v[88:91], v[52:55]
  v_mfma_f32_16x16x32_bf16 v[56:59], v[136:139], v[104:107], v[56:59]
  v_mfma_f32_16x16x32_bf16 v[60:63], v[152:155], v[104:107], v[60:63]
  s_waitcnt lgkmcnt(0)
  v_mfma_f32_16x16x32_bf16 v[48:51], v[140:143], v[92:95], v[48:51]
  v_mfma_f32_16x16x32_bf16 v[52:55], v[156:159], v[92:95], v[52:55]
  v_mfma_f32_16x16x32_bf16 v[56:59], v[140:143], v[108:111], v[56:59]
  v_mfma_f32_16x16x32_bf16 v[60:63], v[156:159], v[108:111], v[60:63]
  v_mfma_f32_16x16x32_bf16 v[64:67], v[160:163], v[80:83], 0
  v_mfma_f32_16x16x32_bf16 v[68:71], v[176:179], v[80:83], 0
  v_mfma_f32_16x16x32_bf16 v[72:75], v[160:163], v[96:99], 0
  s_nop 1
  v_cvt_pk_bf16_f32 v112, v48, v49
  v_mfma_f32_16x16x32_bf16 v[76:79], v[176:179], v[96:99], 0
  v_cvt_pk_bf16_f32 v113, v50, v51
  v_mfma_f32_16x16x32_bf16 v[64:67], v[164:167], v[84:87], v[64:67]
  v_cvt_pk_bf16_f32 v114, v52, v53
  v_mfma_f32_16x16x32_bf16 v[68:71], v[180:183], v[84:87], v[68:71]
  v_cvt_pk_bf16_f32 v115, v54, v55
  v_mfma_f32_16x16x32_bf16 v[72:75], v[164:167], v[100:103], v[72:75]
  buffer_store_dwordx4 v[112:115], v18, s[32:35], s78 offen offset:0 sc1
  v_mfma_f32_16x16x32_bf16 v[76:79], v[180:183], v[100:103], v[76:79]
  v_cvt_pk_bf16_f32 v116, v56, v57
  v_mfma_f32_16x16x32_bf16 v[64:67], v[168:171], v[88:91], v[64:67]
  v_cvt_pk_bf16_f32 v117, v58, v59
  v_mfma_f32_16x16x32_bf16 v[68:71], v[184:187], v[88:91], v[68:71]
  v_cvt_pk_bf16_f32 v118, v60, v61
  v_mfma_f32_16x16x32_bf16 v[72:75], v[168:171], v[104:107], v[72:75]
  v_cvt_pk_bf16_f32 v119, v62, v63
  v_mfma_f32_16x16x32_bf16 v[76:79], v[184:187], v[104:107], v[76:79]
  v_mfma_f32_16x16x32_bf16 v[64:67], v[172:175], v[92:95], v[64:67]
  buffer_store_dwordx4 v[116:119], v18, s[32:35], s62 offen offset:0 sc1
  v_mfma_f32_16x16x32_bf16 v[68:71], v[188:191], v[92:95], v[68:71]
  v_mfma_f32_16x16x32_bf16 v[72:75], v[172:175], v[108:111], v[72:75]
  v_mfma_f32_16x16x32_bf16 v[76:79], v[188:191], v[108:111], v[76:79]
  v_mfma_f32_16x16x32_bf16 v[48:51], v[192:195], v[80:83], 0
  v_mfma_f32_16x16x32_bf16 v[52:55], v[208:211], v[80:83], 0
  v_mfma_f32_16x16x32_bf16 v[56:59], v[192:195], v[96:99], 0
  s_nop 0
  v_cvt_pk_bf16_f32 v112, v64, v65
  v_mfma_f32_16x16x32_bf16 v[60:63], v[208:211], v[96:99], 0
  v_cvt_pk_bf16_f32 v113, v66, v67
  v_mfma_f32_16x16x32_bf16 v[48:51], v[196:199], v[84:87], v[48:51]
  v_cvt_pk_bf16_f32 v114, v68, v69
  v_mfma_f32_16x16x32_bf16 v[52:55], v[212:215], v[84:87], v[52:55]
  v_cvt_pk_bf16_f32 v115, v70, v71
  v_mfma_f32_16x16x32_bf16 v[56:59], v[196:199], v[100:103], v[56:59]
  buffer_store_dwordx4 v[112:115], v18, s[32:35], s78 offen offset:128 sc1
  v_mfma_f32_16x16x32_bf16 v[60:63], v[212:215], v[100:103], v[60:63]
  v_cvt_pk_bf16_f32 v116, v72, v73
  v_mfma_f32_16x16x32_bf16 v[48:51], v[200:203], v[88:91], v[48:51]
  v_cvt_pk_bf16_f32 v117, v74, v75
  v_mfma_f32_16x16x32_bf16 v[52:55], v[216:219], v[88:91], v[52:55]
  v_cvt_pk_bf16_f32 v118, v76, v77
  v_mfma_f32_16x16x32_bf16 v[56:59], v[200:203], v[104:107], v[56:59]
  v_cvt_pk_bf16_f32 v119, v78, v79
  v_mfma_f32_16x16x32_bf16 v[60:63], v[216:219], v[104:107], v[60:63]
  v_mfma_f32_16x16x32_bf16 v[48:51], v[204:207], v[92:95], v[48:51]
  buffer_store_dwordx4 v[116:119], v18, s[32:35], s62 offen offset:128 sc1
  v_mfma_f32_16x16x32_bf16 v[52:55], v[220:223], v[92:95], v[52:55]
  v_mfma_f32_16x16x32_bf16 v[56:59], v[204:207], v[108:111], v[56:59]
  v_mfma_f32_16x16x32_bf16 v[60:63], v[220:223], v[108:111], v[60:63]
  v_mfma_f32_16x16x32_bf16 v[64:67], v[224:227], v[80:83], 0
  v_mfma_f32_16x16x32_bf16 v[68:71], v[240:243], v[80:83], 0
  v_mfma_f32_16x16x32_bf16 v[72:75], v[224:227], v[96:99], 0
  s_nop 0
  v_cvt_pk_bf16_f32 v112, v48, v49
  v_mfma_f32_16x16x32_bf16 v[76:79], v[240:243], v[96:99], 0
  v_cvt_pk_bf16_f32 v113, v50, v51
  v_mfma_f32_16x16x32_bf16 v[64:67], v[228:231], v[84:87], v[64:67]
  v_cvt_pk_bf16_f32 v114, v52, v53
  v_mfma_f32_16x16x32_bf16 v[68:71], v[244:247], v[84:87], v[68:71]
  v_cvt_pk_bf16_f32 v115, v54, v55
  v_mfma_f32_16x16x32_bf16 v[72:75], v[228:231], v[100:103], v[72:75]
  buffer_store_dwordx4 v[112:115], v18, s[32:35], s78 offen offset:256 sc1
  v_mfma_f32_16x16x32_bf16 v[76:79], v[244:247], v[100:103], v[76:79]
  v_cvt_pk_bf16_f32 v116, v56, v57
  v_mfma_f32_16x16x32_bf16 v[64:67], v[232:235], v[88:91], v[64:67]
  v_cvt_pk_bf16_f32 v117, v58, v59
  v_mfma_f32_16x16x32_bf16 v[68:71], v[248:251], v[88:91], v[68:71]
  v_cvt_pk_bf16_f32 v118, v60, v61
  v_mfma_f32_16x16x32_bf16 v[72:75], v[232:235], v[104:107], v[72:75]
  v_cvt_pk_bf16_f32 v119, v62, v63
  v_mfma_f32_16x16x32_bf16 v[76:79], v[248:251], v[104:107], v[76:79]
  v_mfma_f32_16x16x32_bf16 v[64:67], v[236:239], v[92:95], v[64:67]
  buffer_store_dwordx4 v[116:119], v18, s[32:35], s62 offen offset:256 sc1
  v_mfma_f32_16x16x32_bf16 v[68:71], v[252:255], v[92:95], v[68:71]
  v_mfma_f32_16x16x32_bf16 v[72:75], v[236:239], v[108:111], v[72:75]
  v_mfma_f32_16x16x32_bf16 v[76:79], v[252:255], v[108:111], v[76:79]
  s_nop 3
  v_cvt_pk_bf16_f32 v112, v64, v65
  v_cvt_pk_bf16_f32 v113, v66, v67
  v_cvt_pk_bf16_f32 v114, v68, v69
  v_cvt_pk_bf16_f32 v115, v70, v71
  buffer_store_dwordx4 v[112:115], v18, s[32:35], s78 offen offset:384 sc1
  v_cvt_pk_bf16_f32 v116, v72, v73
  v_cvt_pk_bf16_f32 v117, v74, v75
  v_cvt_pk_bf16_f32 v118, v76, v77
  v_cvt_pk_bf16_f32 v119, v78, v79
  buffer_store_dwordx4 v[116:119], v18, s[32:35], s62 offen offset:384 sc1
  s_cmp_lg_u32 s56, 0
  s_cbranch_scc1 W0_181
  s_waitcnt vmcnt(8)
  v_cmp_ge_u32 vcc, v12, v14
  s_and_b32 s63, vcc_hi, 0xffff
  s_add_u32 s61, s85, 64
  s_cmp_lt_u32 s85, 64
  s_cselect_b32 s61, s61, 255
  s_cmp_eq_u32 vcc_lo, -1
  s_cselect_b32 s61, s61, 255
  s_cmp_lt_u32 s84, 64
  s_cselect_b32 s60, s84, 255
  s_cmp_eq_u32 vcc_hi, -1
  s_cselect_b32 s60, s60, 255
  s_cmp_lt_u32 s84, 64
  s_cselect_b32 s63, s63, 0
  s_cmp_lg_u32 s63, 0
  s_cselect_b32 s61, 255, s61
  s_lshl_b32 s62, s88, 1
  s_add_u32 s62, s62, s86
  s_cmp_lt_u32 s84, 64
  s_cselect_b32 s62, s62, 0
  s_cmp_eq_u32 s62, 3
  s_cselect_b32 s61, 255, s61
  s_min_u32 s60, s60, s61
  v_mov_b32 v12, s60
  v_mov_b32 v13, s90
  ds_write_b32 v13, v12
W0_181:
  s_mov_b32 s89, s79
  s_cmp_lg_u32 s88, 0
  s_cbranch_scc1 L_FFN_TOPS
  s_branch L_FFN_IDLES
L_ABORT:
  s_mov_b64 exec, 1
  s_lshl_b32 s60, s57, 8
  s_or_b32 s60, s60, s63
  v_mov_b32 v3, s60
  v_mov_b32 v6, 60
  buffer_store_dword v3, v6, s[36:39], 0 offen sc1
  s_waitcnt vmcnt(0)
L_END:
  s_endpgm
.section .rodata,"a"
.p2align 6
.amdhsa_kernel interleave_layers__memory_aug_recurrent_mem_tr__glu_gated_reglu__prompt_kernel
  .amdhsa_next_free_vgpr 512
  .amdhsa_next_free_sgpr 102
  .amdhsa_accum_offset 256
  .amdhsa_group_segment_fixed_size 0
  .amdhsa_kernarg_size 112
  .amdhsa_user_sgpr_count 2
  .amdhsa_user_sgpr_kernarg_segment_ptr 1
  .amdhsa_system_sgpr_workgroup_id_x 1
.end_amdhsa_kernel
```
